```python
import torch

def _softmax(x, axis=-1):
    return torch.softmax(x, dim=axis)

def _gelu(x):
    return torch.nn.functional.gelu(x, approximate='tanh')

def _silu(x):
    return torch.nn.functional.silu(x)

def _sigmoid(x):
    return torch.sigmoid(x)

def _layernorm(x, axis=-1, eps=1e-05):
    m = x.mean(dim=axis, keepdim=True)
    v = x.var(dim=axis, keepdim=True, unbiased=False)
    return (x - m) / torch.sqrt(v + eps)

def _scatter_add(tgt, idx, src, axis=0):
    return tgt.clone().index_add_(axis, idx, src)

def _segment_sum(src, seg, n):
    out = torch.zeros((n,) + src.shape[1:], dtype=src.dtype)
    return out.index_add_(0, seg, src)

def _pad(x, pw):
    flat = tuple((v for pair in reversed(pw) for v in pair))
    return torch.nn.functional.pad(x, flat)
kernel_name = 'sequential_preLN__memory_aug_recurrent_mem_tr__geglu_ffn__prompt'

def setup_inputs():

    _w = lambda a: (lambda t: t.to(torch.bfloat16) if t.is_floating_point() else t)(torch.as_tensor(a))

    def _A_setup():
        B, S, Dm = (1, 2048, 512)
        H, Dh = (32, 128)
        M, seg = (8, 32)
        seg = min(seg, S)
        S = S // seg * seg
        return {'x': _w((lambda *s: torch.randn(*s, dtype=torch.bfloat16) * 0.05)(B, S, Dm)), 'mem0': _w((lambda *s: torch.randn(*s, dtype=torch.bfloat16) * 0.2)(B, M, Dm)), 'Wq': _w((lambda *s: torch.randn(*s, dtype=torch.bfloat16) * 1.6)(Dm, H, Dh) * Dm ** (-0.5)), 'Wk': _w((lambda *s: torch.randn(*s, dtype=torch.bfloat16) * 1.6)(Dm, H, Dh) * Dm ** (-0.5)), 'Wv': _w((lambda *s: torch.randn(*s, dtype=torch.bfloat16) * 0.2)(Dm, H, Dh) * Dm ** (-0.5)), 'Wo': _w((lambda *s: torch.randn(*s, dtype=torch.bfloat16) * 0.2)(H, Dh, Dm) * (H * Dh) ** (-0.5)), 'seg_len': seg}
    _A_in = _A_setup()

    def _B_setup():
        B, S, D, F = (1, 2048, 512, 1792)
        return {'x': _w((lambda *s: torch.randn(*s, dtype=torch.bfloat16) * 0.05)(B, S, D)), 'w_gate': _w((lambda *s: torch.randn(*s, dtype=torch.bfloat16) * 0.05)(D, F)), 'w_up': _w((lambda *s: torch.randn(*s, dtype=torch.bfloat16) * 0.05)(D, F)), 'w_down': _w((lambda *s: torch.randn(*s, dtype=torch.bfloat16) * 0.05)(F, D))}
    _B_in = _B_setup()
    return {'A_x': _A_in['x'], 'A_mem0': _A_in['mem0'], 'A_Wq': _A_in['Wq'], 'A_Wk': _A_in['Wk'], 'A_Wv': _A_in['Wv'], 'A_Wo': _A_in['Wo'], 'A_seg_len': _A_in['seg_len'], 'B_x': _B_in['x'], 'B_w_gate': _B_in['w_gate'], 'B_w_up': _B_in['w_up'], 'B_w_down': _B_in['w_down']}

def reference(A_x, A_mem0, A_Wq, A_Wk, A_Wv, A_Wo, A_seg_len, B_x, B_w_gate, B_w_up, B_w_down):

    def _A_ref(x, mem0, Wq, Wk, Wv, Wo, seg_len):
        B, S, Dm = x.shape
        H, Dh = (Wq.shape[1], Wq.shape[2])
        M = mem0.shape[1]
        scale = Dh ** (-0.5)
        n_seg = S // seg_len
        L = M + seg_len
        idx = torch.arange(L)
        mask = (idx[:, None] < M) | (idx[:, None] >= idx[None, :])
        mem = mem0
        outs = []
        for s in range(n_seg):
            xs = x[:, s * seg_len:(s + 1) * seg_len, :].clone()
            h = torch.concatenate([mem, xs], axis=1)
            q = torch.einsum('btd,dhe->bhte', h, Wq)
            k = torch.einsum('btd,dhe->bhte', h, Wk)
            v = torch.einsum('btd,dhe->bhte', h, Wv)
            scores = torch.einsum('bhqe,bhke->bhqk', q, k) * scale
            scores = torch.where(mask[None, None], scores, -1000000000.0)
            p = _softmax(scores, axis=-1)
            o = torch.einsum('bhqk,bhke->bhqe', p, v)
            o = torch.einsum('bhte,hed->btd', o, Wo)
            mem = o[:, :M, :].clone()
            outs.append(o[:, M:, :])
        return torch.concatenate(outs, axis=1)

    def _B_ref(x, w_gate, w_up, w_down):
        return _gelu(x @ w_gate) * (x @ w_up) @ w_down
    x = A_x
    h = x + _A_ref(_layernorm(x, axis=-1), A_mem0, A_Wq, A_Wk, A_Wv, A_Wo, A_seg_len)
    h2 = h + _B_ref(_layernorm(h, axis=-1), B_w_gate, B_w_up, B_w_down)
    return h2
```

```asm
; @launch kernel=ln1_kernel grid=(512,1,1) block=(256,1,1) lds=0
; @launch kernel=chain_kernel grid=(256,1,1) block=(256,1,1) lds=162688
; @launch kernel=attn_kernel grid=(512,1,1) block=(256,1,1) lds=0
; @launch kernel=oproj_kernel grid=(256,1,1) block=(256,1,1) lds=81920
; @launch kernel=ln2_kernel grid=(512,1,1) block=(256,1,1) lds=0
; @launch kernel=ffn1_kernel grid=(448,1,1) block=(256,1,1) lds=81920
; @launch kernel=ffn2_kernel grid=(256,1,1) block=(256,1,1) lds=81920
; @launch kernel=fin_kernel grid=(512,1,1) block=(256,1,1) lds=0
.amdgcn_target "amdgcn-amd-amdhsa--gfx950"
.text
.globl ln1_kernel
.p2align 8
.type ln1_kernel,@function
ln1_kernel:
    s_cmp_ge_u32 s2, 512
    s_cbranch_scc1 ln1_kernel_done1
    s_load_dwordx2 s[8:9], s[0:1], 0
    s_waitcnt lgkmcnt(0)
    s_mov_b32 s10, 2097152
    s_mov_b32 s11, 0x00020000
    s_load_dwordx2 s[12:13], s[0:1], 104
    s_waitcnt lgkmcnt(0)
    s_mov_b32 s14, 268435456
    s_mov_b32 s15, 0x00020000
    v_lshrrev_b32 v1, 6, v0
    v_and_b32 v2, 63, v0
    s_lshl_b32 s3, s2, 2
    v_add_u32 v1, s3, v1
    v_lshlrev_b32 v1, 10, v1
    v_lshl_add_u32 v1, v2, 4, v1
    buffer_load_dwordx4 v[4:7], v1, s[8:11], 0 offen
    s_lshl_b32 s3, s2, 12
    v_lshl_add_u32 v20, v0, 4, s3
    v_mov_b32 v24, -1
    v_mov_b32 v25, -1
    v_mov_b32 v26, -1
    v_mov_b32 v27, -1
    s_mov_b32 s16, 117440512
    s_cmp_ge_u32 s2, 256
    s_cbranch_scc1 ln1_kernel_np2
    buffer_store_dwordx4 v[24:27], v20, s[12:15], s16 offen
ln1_kernel_np2:
    s_cmp_ge_u32 s2, 128
    s_cbranch_scc1 ln1_kernel_nz3
    s_cmp_lt_u32 s2, 64
    s_cbranch_scc1 ln1_kernel_nm4
    s_mov_b32 s16, 104857600
    buffer_store_dwordx4 v[24:27], v20, s[12:15], s16 offen
    s_branch ln1_kernel_nz3
ln1_kernel_nm4:
    s_load_dwordx2 s[24:25], s[0:1], 8
    s_waitcnt lgkmcnt(0)
    s_mov_b32 s26, 8192
    s_mov_b32 s27, 0x00020000
    v_and_b32 v21, 0x1fff, v20
    buffer_load_dwordx4 v[28:31], v21, s[24:27], 0 offen
    s_waitcnt vmcnt(0)
    s_mov_b32 s16, 104857600
    buffer_store_dwordx4 v[28:31], v20, s[12:15], s16 offen
ln1_kernel_nz3:
    s_cmp_lg_u32 s2, 300
    s_cbranch_scc1 ln1_kernel_nf5
    v_mov_b32 v24, 0
    v_mov_b32 v25, 0
    v_mov_b32 v26, 0
    v_mov_b32 v27, 0
    v_lshlrev_b32 v21, 4, v0
    s_mov_b32 s16, 105906176
    buffer_store_dwordx4 v[24:27], v21, s[12:15], s16 offen
ln1_kernel_nf5:
    s_waitcnt vmcnt(0)
    v_lshlrev_b32 v8, 16, v4
    v_and_b32 v9, 0xffff0000, v4
    v_lshlrev_b32 v10, 16, v5
    v_and_b32 v11, 0xffff0000, v5
    v_lshlrev_b32 v12, 16, v6
    v_and_b32 v13, 0xffff0000, v6
    v_lshlrev_b32 v14, 16, v7
    v_and_b32 v15, 0xffff0000, v7
    v_add_f32 v16, v8, v9
    v_add_f32 v16, v16, v10
    v_add_f32 v16, v16, v11
    v_add_f32 v16, v16, v12
    v_add_f32 v16, v16, v13
    v_add_f32 v16, v16, v14
    v_add_f32 v16, v16, v15
    ds_swizzle_b32 v17, v16 offset:0x41f
    s_waitcnt lgkmcnt(0)
    v_add_f32 v16, v16, v17
    ds_swizzle_b32 v17, v16 offset:0x81f
    s_waitcnt lgkmcnt(0)
    v_add_f32 v16, v16, v17
    ds_swizzle_b32 v17, v16 offset:0x101f
    s_waitcnt lgkmcnt(0)
    v_add_f32 v16, v16, v17
    ds_swizzle_b32 v17, v16 offset:0x201f
    s_waitcnt lgkmcnt(0)
    v_add_f32 v16, v16, v17
    ds_swizzle_b32 v17, v16 offset:0x401f
    s_waitcnt lgkmcnt(0)
    v_add_f32 v16, v16, v17
    s_nop 1
    v_readlane_b32 s20, v16, 0
    v_readlane_b32 s21, v16, 32
    s_nop 3
    v_mov_b32 v17, s20
    v_add_f32 v16, s21, v17
    v_mul_f32 v16, 0x3b000000, v16
    v_sub_f32 v18, v8, v16
    v_mul_f32 v19, v18, v18
    v_sub_f32 v18, v9, v16
    v_fmac_f32 v19, v18, v18
    v_sub_f32 v18, v10, v16
    v_fmac_f32 v19, v18, v18
    v_sub_f32 v18, v11, v16
    v_fmac_f32 v19, v18, v18
    v_sub_f32 v18, v12, v16
    v_fmac_f32 v19, v18, v18
    v_sub_f32 v18, v13, v16
    v_fmac_f32 v19, v18, v18
    v_sub_f32 v18, v14, v16
    v_fmac_f32 v19, v18, v18
    v_sub_f32 v18, v15, v16
    v_fmac_f32 v19, v18, v18
    ds_swizzle_b32 v17, v19 offset:0x41f
    s_waitcnt lgkmcnt(0)
    v_add_f32 v19, v19, v17
    ds_swizzle_b32 v17, v19 offset:0x81f
    s_waitcnt lgkmcnt(0)
    v_add_f32 v19, v19, v17
    ds_swizzle_b32 v17, v19 offset:0x101f
    s_waitcnt lgkmcnt(0)
    v_add_f32 v19, v19, v17
    ds_swizzle_b32 v17, v19 offset:0x201f
    s_waitcnt lgkmcnt(0)
    v_add_f32 v19, v19, v17
    ds_swizzle_b32 v17, v19 offset:0x401f
    s_waitcnt lgkmcnt(0)
    v_add_f32 v19, v19, v17
    s_nop 1
    v_readlane_b32 s20, v19, 0
    v_readlane_b32 s21, v19, 32
    s_nop 3
    v_mov_b32 v17, s20
    v_add_f32 v19, s21, v17
    v_mul_f32 v19, 0x3b000000, v19
    v_cvt_pk_bf16_f32 v16, v16, v16
    v_lshlrev_b32 v16, 16, v16
    v_cvt_pk_bf16_f32 v19, v19, v19
    v_lshlrev_b32 v19, 16, v19
    v_add_f32 v19, 0x3727c5ac, v19
    v_cvt_pk_bf16_f32 v19, v19, v19
    v_lshlrev_b32 v19, 16, v19
    v_sqrt_f32 v19, v19
    s_nop 0
    v_cvt_pk_bf16_f32 v19, v19, v19
    v_lshlrev_b32 v19, 16, v19
    v_rcp_f32 v19, v19
    s_nop 0
    v_sub_f32 v8, v8, v16
    v_cvt_pk_bf16_f32 v8, v8, v8
    v_lshlrev_b32 v8, 16, v8
    v_mul_f32 v8, v8, v19
    v_sub_f32 v9, v9, v16
    v_cvt_pk_bf16_f32 v9, v9, v9
    v_lshlrev_b32 v9, 16, v9
    v_mul_f32 v9, v9, v19
    v_sub_f32 v10, v10, v16
    v_cvt_pk_bf16_f32 v10, v10, v10
    v_lshlrev_b32 v10, 16, v10
    v_mul_f32 v10, v10, v19
    v_sub_f32 v11, v11, v16
    v_cvt_pk_bf16_f32 v11, v11, v11
    v_lshlrev_b32 v11, 16, v11
    v_mul_f32 v11, v11, v19
    v_sub_f32 v12, v12, v16
    v_cvt_pk_bf16_f32 v12, v12, v12
    v_lshlrev_b32 v12, 16, v12
    v_mul_f32 v12, v12, v19
    v_sub_f32 v13, v13, v16
    v_cvt_pk_bf16_f32 v13, v13, v13
    v_lshlrev_b32 v13, 16, v13
    v_mul_f32 v13, v13, v19
    v_sub_f32 v14, v14, v16
    v_cvt_pk_bf16_f32 v14, v14, v14
    v_lshlrev_b32 v14, 16, v14
    v_mul_f32 v14, v14, v19
    v_sub_f32 v15, v15, v16
    v_cvt_pk_bf16_f32 v15, v15, v15
    v_lshlrev_b32 v15, 16, v15
    v_mul_f32 v15, v15, v19
    v_cvt_pk_bf16_f32 v4, v8, v9
    v_cvt_pk_bf16_f32 v5, v10, v11
    v_cvt_pk_bf16_f32 v6, v12, v13
    v_cvt_pk_bf16_f32 v7, v14, v15
    s_mov_b32 s16, 0
    buffer_store_dwordx4 v[4:7], v1, s[12:15], s16 offen
ln1_kernel_done1:
    s_endpgm
.globl chain_kernel
.p2align 8
.type chain_kernel,@function
chain_kernel:
    s_load_dwordx2 s[8:9], s[0:1], 104
    s_waitcnt lgkmcnt(0)
    s_mov_b32 s10, 268435456
    s_mov_b32 s11, 0x00020000
    v_and_b32 v1, 63, v0
    v_lshrrev_b32 v2, 6, v0
    v_and_b32 v3, 15, v1
    v_lshrrev_b32 v4, 4, v1
    s_nop 0
    v_readfirstlane_b32 s18, v2
    s_cmp_lg_u32 s18, 0
    s_cbranch_scc1 chain_kernel_tf4
    s_load_dwordx2 s[12:13], s[0:1], 96
    s_waitcnt lgkmcnt(0)
    s_mov_b32 s14, 256
    s_mov_b32 s15, 0x00020000
    s_getreg_b32 s20, hwreg(HW_REG_XCC_ID)
    s_and_b32 s20, s20, 7
    s_mov_b64 exec, 1
    v_mov_b32 v5, 1
    s_lshl_b32 s21, s20, 2
    v_mov_b32 v6, s21
    buffer_atomic_add v5, v6, s[12:15], 0 offen sc0
    s_waitcnt vmcnt(0)
    v_readfirstlane_b32 s22, v5
    s_add_u32 s23, s20, 1
    v_mov_b32 v8, 64
    s_cmp_lg_u32 s22, 31
    s_cbranch_scc1 chain_kernel_nc5
    v_mov_b32 v6, s23
    v_mov_b32 v7, 0
    buffer_atomic_cmpswap v[6:7], v8, s[12:15], 0 offen
chain_kernel_nc5:
    s_mov_b32 s24, 0xffff
    s_mov_b32 s25, 0
chain_kernel_wd6:
    buffer_load_dword v5, v8, s[12:15], 0 offen sc1
    s_waitcnt vmcnt(0)
    v_readfirstlane_b32 s26, v5
    s_cmp_lg_u32 s26, 0
    s_cbranch_scc1 chain_kernel_gd7
    s_add_u32 s25, s25, 1
    s_cmp_lt_u32 s25, 4000
    s_cbranch_scc1 chain_kernel_wd6
    v_mov_b32 v6, 100
    v_mov_b32 v7, 0
    buffer_atomic_cmpswap v[6:7], v8, s[12:15], 0 offen
    s_branch chain_kernel_wd6
chain_kernel_gd7:
    s_cmp_eq_u32 s26, 100
    s_cbranch_scc1 chain_kernel_slow9
    s_cmp_lg_u32 s26, s23
    s_cbranch_scc1 chain_kernel_pub8
    s_cmp_ge_u32 s22, 32
    s_cbranch_scc1 chain_kernel_pub8
    s_mov_b32 s24, s22
    s_branch chain_kernel_pub8
chain_kernel_slow9:
    s_cmp_ge_u32 s2, 32
    s_cbranch_scc1 chain_kernel_pub8
    s_or_b32 s24, s2, 0x100
chain_kernel_pub8:
    v_mov_b32 v5, s24
    v_mov_b32 v6, 0
    ds_write_b32 v6, v5
    s_mov_b64 exec, -1
    s_waitcnt lgkmcnt(0)
chain_kernel_tf4:
    s_barrier
    v_mov_b32 v6, 0
    ds_read_b32 v5, v6
    s_waitcnt lgkmcnt(0)
    v_readfirstlane_b32 s24, v5
    s_nop 3
    s_cmp_eq_u32 s24, 0xffff
    s_cbranch_scc1 chain_kernel_worker3
    s_and_b32 s16, s24, 0xff
    s_lshr_b32 s58, s24, 8
    s_barrier
    v_lshrrev_b32 v5, 4, v0
    v_and_b32 v6, 15, v0
    v_lshlrev_b32 v7, 13, v5
    v_lshl_add_u32 v7, v6, 4, v7
    s_lshl_b32 s20, s16, 8
    v_add_u32 v7, s20, v7
    v_lshlrev_b32 v8, 8, v5
    v_lshl_add_u32 v8, v6, 4, v8
    v_lshrrev_b32 v9, 2, v3
    v_lshl_add_u32 v9, v4, 3, v9
    v_lshlrev_b32 v9, 8, v9
    v_and_b32 v10, 3, v1
    v_lshl_add_u32 v9, v10, 3, v9
    v_lshl_add_u32 v9, v2, 6, v9
    v_add_u32 v11, 65536, v8
    v_add_u32 v10, 65536, v9
    s_load_dwordx2 s[12:13], s[0:1], 16
    s_waitcnt lgkmcnt(0)
    s_mov_b32 s14, 4194304
    s_mov_b32 s15, 0x00020000
    s_mov_b32 s21, 0
    buffer_load_dwordx4 v[128:131], v7, s[12:15], s21 offen
    s_mov_b32 s21, 131072
    buffer_load_dwordx4 v[132:135], v7, s[12:15], s21 offen
    s_mov_b32 s21, 262144
    buffer_load_dwordx4 v[136:139], v7, s[12:15], s21 offen
    s_mov_b32 s21, 393216
    buffer_load_dwordx4 v[140:143], v7, s[12:15], s21 offen
    s_mov_b32 s21, 524288
    buffer_load_dwordx4 v[144:147], v7, s[12:15], s21 offen
    s_mov_b32 s21, 655360
    buffer_load_dwordx4 v[148:151], v7, s[12:15], s21 offen
    s_mov_b32 s21, 786432
    buffer_load_dwordx4 v[152:155], v7, s[12:15], s21 offen
    s_mov_b32 s21, 917504
    buffer_load_dwordx4 v[156:159], v7, s[12:15], s21 offen
    s_mov_b32 s21, 1048576
    buffer_load_dwordx4 v[160:163], v7, s[12:15], s21 offen
    s_mov_b32 s21, 1179648
    buffer_load_dwordx4 v[164:167], v7, s[12:15], s21 offen
    s_mov_b32 s21, 1310720
    buffer_load_dwordx4 v[168:171], v7, s[12:15], s21 offen
    s_mov_b32 s21, 1441792
    buffer_load_dwordx4 v[172:175], v7, s[12:15], s21 offen
    s_mov_b32 s21, 1572864
    buffer_load_dwordx4 v[176:179], v7, s[12:15], s21 offen
    s_mov_b32 s21, 1703936
    buffer_load_dwordx4 v[180:183], v7, s[12:15], s21 offen
    s_mov_b32 s21, 1835008
    buffer_load_dwordx4 v[184:187], v7, s[12:15], s21 offen
    s_mov_b32 s21, 1966080
    buffer_load_dwordx4 v[188:191], v7, s[12:15], s21 offen
    s_mov_b32 s21, 2097152
    buffer_load_dwordx4 v[192:195], v7, s[12:15], s21 offen
    s_mov_b32 s21, 2228224
    buffer_load_dwordx4 v[196:199], v7, s[12:15], s21 offen
    s_mov_b32 s21, 2359296
    buffer_load_dwordx4 v[200:203], v7, s[12:15], s21 offen
    s_mov_b32 s21, 2490368
    buffer_load_dwordx4 v[204:207], v7, s[12:15], s21 offen
    s_mov_b32 s21, 2621440
    buffer_load_dwordx4 v[208:211], v7, s[12:15], s21 offen
    s_mov_b32 s21, 2752512
    buffer_load_dwordx4 v[212:215], v7, s[12:15], s21 offen
    s_mov_b32 s21, 2883584
    buffer_load_dwordx4 v[216:219], v7, s[12:15], s21 offen
    s_mov_b32 s21, 3014656
    buffer_load_dwordx4 v[220:223], v7, s[12:15], s21 offen
    s_mov_b32 s21, 3145728
    buffer_load_dwordx4 v[224:227], v7, s[12:15], s21 offen
    s_mov_b32 s21, 3276800
    buffer_load_dwordx4 v[228:231], v7, s[12:15], s21 offen
    s_mov_b32 s21, 3407872
    buffer_load_dwordx4 v[232:235], v7, s[12:15], s21 offen
    s_mov_b32 s21, 3538944
    buffer_load_dwordx4 v[236:239], v7, s[12:15], s21 offen
    s_mov_b32 s21, 3670016
    buffer_load_dwordx4 v[240:243], v7, s[12:15], s21 offen
    s_mov_b32 s21, 3801088
    buffer_load_dwordx4 v[244:247], v7, s[12:15], s21 offen
    s_mov_b32 s21, 3932160
    buffer_load_dwordx4 v[248:251], v7, s[12:15], s21 offen
    s_mov_b32 s21, 4063232
    buffer_load_dwordx4 v[252:255], v7, s[12:15], s21 offen
    s_waitcnt vmcnt(31)
    ds_write_b128 v8, v[128:131] offset:0
    s_waitcnt vmcnt(30)
    ds_write_b128 v8, v[132:135] offset:4096
    s_waitcnt vmcnt(29)
    ds_write_b128 v8, v[136:139] offset:8192
    s_waitcnt vmcnt(28)
    ds_write_b128 v8, v[140:143] offset:12288
    s_waitcnt vmcnt(27)
    ds_write_b128 v8, v[144:147] offset:16384
    s_waitcnt vmcnt(26)
    ds_write_b128 v8, v[148:151] offset:20480
    s_waitcnt vmcnt(25)
    ds_write_b128 v8, v[152:155] offset:24576
    s_waitcnt vmcnt(24)
    ds_write_b128 v8, v[156:159] offset:28672
    s_waitcnt vmcnt(23)
    ds_write_b128 v8, v[160:163] offset:32768
    s_waitcnt vmcnt(22)
    ds_write_b128 v8, v[164:167] offset:36864
    s_waitcnt vmcnt(21)
    ds_write_b128 v8, v[168:171] offset:40960
    s_waitcnt vmcnt(20)
    ds_write_b128 v8, v[172:175] offset:45056
    s_waitcnt vmcnt(19)
    ds_write_b128 v8, v[176:179] offset:49152
    s_waitcnt vmcnt(18)
    ds_write_b128 v8, v[180:183] offset:53248
    s_waitcnt vmcnt(17)
    ds_write_b128 v8, v[184:187] offset:57344
    s_waitcnt vmcnt(16)
    ds_write_b128 v8, v[188:191] offset:61440
    s_waitcnt vmcnt(15)
    ds_write_b128 v11, v[192:195] offset:0
    s_waitcnt vmcnt(14)
    ds_write_b128 v11, v[196:199] offset:4096
    s_waitcnt vmcnt(13)
    ds_write_b128 v11, v[200:203] offset:8192
    s_waitcnt vmcnt(12)
    ds_write_b128 v11, v[204:207] offset:12288
    s_waitcnt vmcnt(11)
    ds_write_b128 v11, v[208:211] offset:16384
    s_waitcnt vmcnt(10)
    ds_write_b128 v11, v[212:215] offset:20480
    s_waitcnt vmcnt(9)
    ds_write_b128 v11, v[216:219] offset:24576
    s_waitcnt vmcnt(8)
    ds_write_b128 v11, v[220:223] offset:28672
    s_waitcnt vmcnt(7)
    ds_write_b128 v11, v[224:227] offset:32768
    s_waitcnt vmcnt(6)
    ds_write_b128 v11, v[228:231] offset:36864
    s_waitcnt vmcnt(5)
    ds_write_b128 v11, v[232:235] offset:40960
    s_waitcnt vmcnt(4)
    ds_write_b128 v11, v[236:239] offset:45056
    s_waitcnt vmcnt(3)
    ds_write_b128 v11, v[240:243] offset:49152
    s_waitcnt vmcnt(2)
    ds_write_b128 v11, v[244:247] offset:53248
    s_waitcnt vmcnt(1)
    ds_write_b128 v11, v[248:251] offset:57344
    s_waitcnt vmcnt(0)
    ds_write_b128 v11, v[252:255] offset:61440
    s_waitcnt lgkmcnt(0)
    s_load_dwordx2 s[12:13], s[0:1], 24
    s_waitcnt lgkmcnt(0)
    s_mov_b32 s14, 4194304
    s_mov_b32 s15, 0x00020000
    s_mov_b32 s21, 0
    buffer_load_dwordx4 v[128:131], v7, s[12:15], s21 offen
    s_mov_b32 s21, 131072
    buffer_load_dwordx4 v[132:135], v7, s[12:15], s21 offen
    s_mov_b32 s21, 262144
    buffer_load_dwordx4 v[136:139], v7, s[12:15], s21 offen
    s_mov_b32 s21, 393216
    buffer_load_dwordx4 v[140:143], v7, s[12:15], s21 offen
    s_mov_b32 s21, 524288
    buffer_load_dwordx4 v[144:147], v7, s[12:15], s21 offen
    s_mov_b32 s21, 655360
    buffer_load_dwordx4 v[148:151], v7, s[12:15], s21 offen
    s_mov_b32 s21, 786432
    buffer_load_dwordx4 v[152:155], v7, s[12:15], s21 offen
    s_mov_b32 s21, 917504
    buffer_load_dwordx4 v[156:159], v7, s[12:15], s21 offen
    s_mov_b32 s21, 1048576
    buffer_load_dwordx4 v[160:163], v7, s[12:15], s21 offen
    s_mov_b32 s21, 1179648
    buffer_load_dwordx4 v[164:167], v7, s[12:15], s21 offen
    s_mov_b32 s21, 1310720
    buffer_load_dwordx4 v[168:171], v7, s[12:15], s21 offen
    s_mov_b32 s21, 1441792
    buffer_load_dwordx4 v[172:175], v7, s[12:15], s21 offen
    s_mov_b32 s21, 1572864
    buffer_load_dwordx4 v[176:179], v7, s[12:15], s21 offen
    s_mov_b32 s21, 1703936
    buffer_load_dwordx4 v[180:183], v7, s[12:15], s21 offen
    s_mov_b32 s21, 1835008
    buffer_load_dwordx4 v[184:187], v7, s[12:15], s21 offen
    s_mov_b32 s21, 1966080
    buffer_load_dwordx4 v[188:191], v7, s[12:15], s21 offen
    s_mov_b32 s21, 2097152
    buffer_load_dwordx4 v[192:195], v7, s[12:15], s21 offen
    s_mov_b32 s21, 2228224
    buffer_load_dwordx4 v[196:199], v7, s[12:15], s21 offen
    s_mov_b32 s21, 2359296
    buffer_load_dwordx4 v[200:203], v7, s[12:15], s21 offen
    s_mov_b32 s21, 2490368
    buffer_load_dwordx4 v[204:207], v7, s[12:15], s21 offen
    s_mov_b32 s21, 2621440
    buffer_load_dwordx4 v[208:211], v7, s[12:15], s21 offen
    s_mov_b32 s21, 2752512
    buffer_load_dwordx4 v[212:215], v7, s[12:15], s21 offen
    s_mov_b32 s21, 2883584
    buffer_load_dwordx4 v[216:219], v7, s[12:15], s21 offen
    s_mov_b32 s21, 3014656
    buffer_load_dwordx4 v[220:223], v7, s[12:15], s21 offen
    s_mov_b32 s21, 3145728
    buffer_load_dwordx4 v[224:227], v7, s[12:15], s21 offen
    s_mov_b32 s21, 3276800
    buffer_load_dwordx4 v[228:231], v7, s[12:15], s21 offen
    s_mov_b32 s21, 3407872
    buffer_load_dwordx4 v[232:235], v7, s[12:15], s21 offen
    s_mov_b32 s21, 3538944
    buffer_load_dwordx4 v[236:239], v7, s[12:15], s21 offen
    s_mov_b32 s21, 3670016
    buffer_load_dwordx4 v[240:243], v7, s[12:15], s21 offen
    s_mov_b32 s21, 3801088
    buffer_load_dwordx4 v[244:247], v7, s[12:15], s21 offen
    s_mov_b32 s21, 3932160
    buffer_load_dwordx4 v[248:251], v7, s[12:15], s21 offen
    s_mov_b32 s21, 4063232
    buffer_load_dwordx4 v[252:255], v7, s[12:15], s21 offen
    s_barrier
    ds_read_b64_tr_b16 v[64:65], v9 offset:0
    ds_read_b64_tr_b16 v[66:67], v9 offset:1024
    ds_read_b64_tr_b16 v[68:69], v9 offset:8192
    ds_read_b64_tr_b16 v[70:71], v9 offset:9216
    ds_read_b64_tr_b16 v[72:73], v9 offset:16384
    ds_read_b64_tr_b16 v[74:75], v9 offset:17408
    ds_read_b64_tr_b16 v[76:77], v9 offset:24576
    ds_read_b64_tr_b16 v[78:79], v9 offset:25600
    ds_read_b64_tr_b16 v[80:81], v9 offset:32768
    ds_read_b64_tr_b16 v[82:83], v9 offset:33792
    ds_read_b64_tr_b16 v[84:85], v9 offset:40960
    ds_read_b64_tr_b16 v[86:87], v9 offset:41984
    ds_read_b64_tr_b16 v[88:89], v9 offset:49152
    ds_read_b64_tr_b16 v[90:91], v9 offset:50176
    ds_read_b64_tr_b16 v[92:93], v9 offset:57344
    ds_read_b64_tr_b16 v[94:95], v9 offset:58368
    s_waitcnt lgkmcnt(0)
    v_accvgpr_write_b32 a0, v64
    v_accvgpr_write_b32 a1, v65
    v_accvgpr_write_b32 a2, v66
    v_accvgpr_write_b32 a3, v67
    v_accvgpr_write_b32 a4, v68
    v_accvgpr_write_b32 a5, v69
    v_accvgpr_write_b32 a6, v70
    v_accvgpr_write_b32 a7, v71
    v_accvgpr_write_b32 a8, v72
    v_accvgpr_write_b32 a9, v73
    v_accvgpr_write_b32 a10, v74
    v_accvgpr_write_b32 a11, v75
    v_accvgpr_write_b32 a12, v76
    v_accvgpr_write_b32 a13, v77
    v_accvgpr_write_b32 a14, v78
    v_accvgpr_write_b32 a15, v79
    v_accvgpr_write_b32 a16, v80
    v_accvgpr_write_b32 a17, v81
    v_accvgpr_write_b32 a18, v82
    v_accvgpr_write_b32 a19, v83
    v_accvgpr_write_b32 a20, v84
    v_accvgpr_write_b32 a21, v85
    v_accvgpr_write_b32 a22, v86
    v_accvgpr_write_b32 a23, v87
    v_accvgpr_write_b32 a24, v88
    v_accvgpr_write_b32 a25, v89
    v_accvgpr_write_b32 a26, v90
    v_accvgpr_write_b32 a27, v91
    v_accvgpr_write_b32 a28, v92
    v_accvgpr_write_b32 a29, v93
    v_accvgpr_write_b32 a30, v94
    v_accvgpr_write_b32 a31, v95
    ds_read_b64_tr_b16 v[64:65], v10 offset:0
    ds_read_b64_tr_b16 v[66:67], v10 offset:1024
    ds_read_b64_tr_b16 v[68:69], v10 offset:8192
    ds_read_b64_tr_b16 v[70:71], v10 offset:9216
    ds_read_b64_tr_b16 v[72:73], v10 offset:16384
    ds_read_b64_tr_b16 v[74:75], v10 offset:17408
    ds_read_b64_tr_b16 v[76:77], v10 offset:24576
    ds_read_b64_tr_b16 v[78:79], v10 offset:25600
    ds_read_b64_tr_b16 v[80:81], v10 offset:32768
    ds_read_b64_tr_b16 v[82:83], v10 offset:33792
    ds_read_b64_tr_b16 v[84:85], v10 offset:40960
    ds_read_b64_tr_b16 v[86:87], v10 offset:41984
    ds_read_b64_tr_b16 v[88:89], v10 offset:49152
    ds_read_b64_tr_b16 v[90:91], v10 offset:50176
    ds_read_b64_tr_b16 v[92:93], v10 offset:57344
    ds_read_b64_tr_b16 v[94:95], v10 offset:58368
    s_waitcnt lgkmcnt(0)
    v_accvgpr_write_b32 a32, v64
    v_accvgpr_write_b32 a33, v65
    v_accvgpr_write_b32 a34, v66
    v_accvgpr_write_b32 a35, v67
    v_accvgpr_write_b32 a36, v68
    v_accvgpr_write_b32 a37, v69
    v_accvgpr_write_b32 a38, v70
    v_accvgpr_write_b32 a39, v71
    v_accvgpr_write_b32 a40, v72
    v_accvgpr_write_b32 a41, v73
    v_accvgpr_write_b32 a42, v74
    v_accvgpr_write_b32 a43, v75
    v_accvgpr_write_b32 a44, v76
    v_accvgpr_write_b32 a45, v77
    v_accvgpr_write_b32 a46, v78
    v_accvgpr_write_b32 a47, v79
    v_accvgpr_write_b32 a48, v80
    v_accvgpr_write_b32 a49, v81
    v_accvgpr_write_b32 a50, v82
    v_accvgpr_write_b32 a51, v83
    v_accvgpr_write_b32 a52, v84
    v_accvgpr_write_b32 a53, v85
    v_accvgpr_write_b32 a54, v86
    v_accvgpr_write_b32 a55, v87
    v_accvgpr_write_b32 a56, v88
    v_accvgpr_write_b32 a57, v89
    v_accvgpr_write_b32 a58, v90
    v_accvgpr_write_b32 a59, v91
    v_accvgpr_write_b32 a60, v92
    v_accvgpr_write_b32 a61, v93
    v_accvgpr_write_b32 a62, v94
    v_accvgpr_write_b32 a63, v95
    ds_read_b64_tr_b16 v[64:65], v9 offset:32
    ds_read_b64_tr_b16 v[66:67], v9 offset:1056
    ds_read_b64_tr_b16 v[68:69], v9 offset:8224
    ds_read_b64_tr_b16 v[70:71], v9 offset:9248
    ds_read_b64_tr_b16 v[72:73], v9 offset:16416
    ds_read_b64_tr_b16 v[74:75], v9 offset:17440
    ds_read_b64_tr_b16 v[76:77], v9 offset:24608
    ds_read_b64_tr_b16 v[78:79], v9 offset:25632
    ds_read_b64_tr_b16 v[80:81], v9 offset:32800
    ds_read_b64_tr_b16 v[82:83], v9 offset:33824
    ds_read_b64_tr_b16 v[84:85], v9 offset:40992
    ds_read_b64_tr_b16 v[86:87], v9 offset:42016
    ds_read_b64_tr_b16 v[88:89], v9 offset:49184
    ds_read_b64_tr_b16 v[90:91], v9 offset:50208
    ds_read_b64_tr_b16 v[92:93], v9 offset:57376
    ds_read_b64_tr_b16 v[94:95], v9 offset:58400
    s_waitcnt lgkmcnt(0)
    v_accvgpr_write_b32 a64, v64
    v_accvgpr_write_b32 a65, v65
    v_accvgpr_write_b32 a66, v66
    v_accvgpr_write_b32 a67, v67
    v_accvgpr_write_b32 a68, v68
    v_accvgpr_write_b32 a69, v69
    v_accvgpr_write_b32 a70, v70
    v_accvgpr_write_b32 a71, v71
    v_accvgpr_write_b32 a72, v72
    v_accvgpr_write_b32 a73, v73
    v_accvgpr_write_b32 a74, v74
    v_accvgpr_write_b32 a75, v75
    v_accvgpr_write_b32 a76, v76
    v_accvgpr_write_b32 a77, v77
    v_accvgpr_write_b32 a78, v78
    v_accvgpr_write_b32 a79, v79
    v_accvgpr_write_b32 a80, v80
    v_accvgpr_write_b32 a81, v81
    v_accvgpr_write_b32 a82, v82
    v_accvgpr_write_b32 a83, v83
    v_accvgpr_write_b32 a84, v84
    v_accvgpr_write_b32 a85, v85
    v_accvgpr_write_b32 a86, v86
    v_accvgpr_write_b32 a87, v87
    v_accvgpr_write_b32 a88, v88
    v_accvgpr_write_b32 a89, v89
    v_accvgpr_write_b32 a90, v90
    v_accvgpr_write_b32 a91, v91
    v_accvgpr_write_b32 a92, v92
    v_accvgpr_write_b32 a93, v93
    v_accvgpr_write_b32 a94, v94
    v_accvgpr_write_b32 a95, v95
    ds_read_b64_tr_b16 v[64:65], v10 offset:32
    ds_read_b64_tr_b16 v[66:67], v10 offset:1056
    ds_read_b64_tr_b16 v[68:69], v10 offset:8224
    ds_read_b64_tr_b16 v[70:71], v10 offset:9248
    ds_read_b64_tr_b16 v[72:73], v10 offset:16416
    ds_read_b64_tr_b16 v[74:75], v10 offset:17440
    ds_read_b64_tr_b16 v[76:77], v10 offset:24608
    ds_read_b64_tr_b16 v[78:79], v10 offset:25632
    ds_read_b64_tr_b16 v[80:81], v10 offset:32800
    ds_read_b64_tr_b16 v[82:83], v10 offset:33824
    ds_read_b64_tr_b16 v[84:85], v10 offset:40992
    ds_read_b64_tr_b16 v[86:87], v10 offset:42016
    ds_read_b64_tr_b16 v[88:89], v10 offset:49184
    ds_read_b64_tr_b16 v[90:91], v10 offset:50208
    ds_read_b64_tr_b16 v[92:93], v10 offset:57376
    ds_read_b64_tr_b16 v[94:95], v10 offset:58400
    s_waitcnt lgkmcnt(0)
    v_accvgpr_write_b32 a96, v64
    v_accvgpr_write_b32 a97, v65
    v_accvgpr_write_b32 a98, v66
    v_accvgpr_write_b32 a99, v67
    v_accvgpr_write_b32 a100, v68
    v_accvgpr_write_b32 a101, v69
    v_accvgpr_write_b32 a102, v70
    v_accvgpr_write_b32 a103, v71
    v_accvgpr_write_b32 a104, v72
    v_accvgpr_write_b32 a105, v73
    v_accvgpr_write_b32 a106, v74
    v_accvgpr_write_b32 a107, v75
    v_accvgpr_write_b32 a108, v76
    v_accvgpr_write_b32 a109, v77
    v_accvgpr_write_b32 a110, v78
    v_accvgpr_write_b32 a111, v79
    v_accvgpr_write_b32 a112, v80
    v_accvgpr_write_b32 a113, v81
    v_accvgpr_write_b32 a114, v82
    v_accvgpr_write_b32 a115, v83
    v_accvgpr_write_b32 a116, v84
    v_accvgpr_write_b32 a117, v85
    v_accvgpr_write_b32 a118, v86
    v_accvgpr_write_b32 a119, v87
    v_accvgpr_write_b32 a120, v88
    v_accvgpr_write_b32 a121, v89
    v_accvgpr_write_b32 a122, v90
    v_accvgpr_write_b32 a123, v91
    v_accvgpr_write_b32 a124, v92
    v_accvgpr_write_b32 a125, v93
    v_accvgpr_write_b32 a126, v94
    v_accvgpr_write_b32 a127, v95
    s_barrier
    s_waitcnt vmcnt(31)
    ds_write_b128 v8, v[128:131] offset:0
    s_waitcnt vmcnt(30)
    ds_write_b128 v8, v[132:135] offset:4096
    s_waitcnt vmcnt(29)
    ds_write_b128 v8, v[136:139] offset:8192
    s_waitcnt vmcnt(28)
    ds_write_b128 v8, v[140:143] offset:12288
    s_waitcnt vmcnt(27)
    ds_write_b128 v8, v[144:147] offset:16384
    s_waitcnt vmcnt(26)
    ds_write_b128 v8, v[148:151] offset:20480
    s_waitcnt vmcnt(25)
    ds_write_b128 v8, v[152:155] offset:24576
    s_waitcnt vmcnt(24)
    ds_write_b128 v8, v[156:159] offset:28672
    s_waitcnt vmcnt(23)
    ds_write_b128 v8, v[160:163] offset:32768
    s_waitcnt vmcnt(22)
    ds_write_b128 v8, v[164:167] offset:36864
    s_waitcnt vmcnt(21)
    ds_write_b128 v8, v[168:171] offset:40960
    s_waitcnt vmcnt(20)
    ds_write_b128 v8, v[172:175] offset:45056
    s_waitcnt vmcnt(19)
    ds_write_b128 v8, v[176:179] offset:49152
    s_waitcnt vmcnt(18)
    ds_write_b128 v8, v[180:183] offset:53248
    s_waitcnt vmcnt(17)
    ds_write_b128 v8, v[184:187] offset:57344
    s_waitcnt vmcnt(16)
    ds_write_b128 v8, v[188:191] offset:61440
    s_waitcnt vmcnt(15)
    ds_write_b128 v11, v[192:195] offset:0
    s_waitcnt vmcnt(14)
    ds_write_b128 v11, v[196:199] offset:4096
    s_waitcnt vmcnt(13)
    ds_write_b128 v11, v[200:203] offset:8192
    s_waitcnt vmcnt(12)
    ds_write_b128 v11, v[204:207] offset:12288
    s_waitcnt vmcnt(11)
    ds_write_b128 v11, v[208:211] offset:16384
    s_waitcnt vmcnt(10)
    ds_write_b128 v11, v[212:215] offset:20480
    s_waitcnt vmcnt(9)
    ds_write_b128 v11, v[216:219] offset:24576
    s_waitcnt vmcnt(8)
    ds_write_b128 v11, v[220:223] offset:28672
    s_waitcnt vmcnt(7)
    ds_write_b128 v11, v[224:227] offset:32768
    s_waitcnt vmcnt(6)
    ds_write_b128 v11, v[228:231] offset:36864
    s_waitcnt vmcnt(5)
    ds_write_b128 v11, v[232:235] offset:40960
    s_waitcnt vmcnt(4)
    ds_write_b128 v11, v[236:239] offset:45056
    s_waitcnt vmcnt(3)
    ds_write_b128 v11, v[240:243] offset:49152
    s_waitcnt vmcnt(2)
    ds_write_b128 v11, v[244:247] offset:53248
    s_waitcnt vmcnt(1)
    ds_write_b128 v11, v[248:251] offset:57344
    s_waitcnt vmcnt(0)
    ds_write_b128 v11, v[252:255] offset:61440
    s_waitcnt lgkmcnt(0)
    s_load_dwordx2 s[12:13], s[0:1], 32
    s_waitcnt lgkmcnt(0)
    s_mov_b32 s14, 4194304
    s_mov_b32 s15, 0x00020000
    s_mov_b32 s21, 0
    buffer_load_dwordx4 v[128:131], v7, s[12:15], s21 offen
    s_mov_b32 s21, 131072
    buffer_load_dwordx4 v[132:135], v7, s[12:15], s21 offen
    s_mov_b32 s21, 262144
    buffer_load_dwordx4 v[136:139], v7, s[12:15], s21 offen
    s_mov_b32 s21, 393216
    buffer_load_dwordx4 v[140:143], v7, s[12:15], s21 offen
    s_mov_b32 s21, 524288
    buffer_load_dwordx4 v[144:147], v7, s[12:15], s21 offen
    s_mov_b32 s21, 655360
    buffer_load_dwordx4 v[148:151], v7, s[12:15], s21 offen
    s_mov_b32 s21, 786432
    buffer_load_dwordx4 v[152:155], v7, s[12:15], s21 offen
    s_mov_b32 s21, 917504
    buffer_load_dwordx4 v[156:159], v7, s[12:15], s21 offen
    s_mov_b32 s21, 1048576
    buffer_load_dwordx4 v[160:163], v7, s[12:15], s21 offen
    s_mov_b32 s21, 1179648
    buffer_load_dwordx4 v[164:167], v7, s[12:15], s21 offen
    s_mov_b32 s21, 1310720
    buffer_load_dwordx4 v[168:171], v7, s[12:15], s21 offen
    s_mov_b32 s21, 1441792
    buffer_load_dwordx4 v[172:175], v7, s[12:15], s21 offen
    s_mov_b32 s21, 1572864
    buffer_load_dwordx4 v[176:179], v7, s[12:15], s21 offen
    s_mov_b32 s21, 1703936
    buffer_load_dwordx4 v[180:183], v7, s[12:15], s21 offen
    s_mov_b32 s21, 1835008
    buffer_load_dwordx4 v[184:187], v7, s[12:15], s21 offen
    s_mov_b32 s21, 1966080
    buffer_load_dwordx4 v[188:191], v7, s[12:15], s21 offen
    s_mov_b32 s21, 2097152
    buffer_load_dwordx4 v[192:195], v7, s[12:15], s21 offen
    s_mov_b32 s21, 2228224
    buffer_load_dwordx4 v[196:199], v7, s[12:15], s21 offen
    s_mov_b32 s21, 2359296
    buffer_load_dwordx4 v[200:203], v7, s[12:15], s21 offen
    s_mov_b32 s21, 2490368
    buffer_load_dwordx4 v[204:207], v7, s[12:15], s21 offen
    s_mov_b32 s21, 2621440
    buffer_load_dwordx4 v[208:211], v7, s[12:15], s21 offen
    s_mov_b32 s21, 2752512
    buffer_load_dwordx4 v[212:215], v7, s[12:15], s21 offen
    s_mov_b32 s21, 2883584
    buffer_load_dwordx4 v[216:219], v7, s[12:15], s21 offen
    s_mov_b32 s21, 3014656
    buffer_load_dwordx4 v[220:223], v7, s[12:15], s21 offen
    s_mov_b32 s21, 3145728
    buffer_load_dwordx4 v[224:227], v7, s[12:15], s21 offen
    s_mov_b32 s21, 3276800
    buffer_load_dwordx4 v[228:231], v7, s[12:15], s21 offen
    s_mov_b32 s21, 3407872
    buffer_load_dwordx4 v[232:235], v7, s[12:15], s21 offen
    s_mov_b32 s21, 3538944
    buffer_load_dwordx4 v[236:239], v7, s[12:15], s21 offen
    s_mov_b32 s21, 3670016
    buffer_load_dwordx4 v[240:243], v7, s[12:15], s21 offen
    s_mov_b32 s21, 3801088
    buffer_load_dwordx4 v[244:247], v7, s[12:15], s21 offen
    s_mov_b32 s21, 3932160
    buffer_load_dwordx4 v[248:251], v7, s[12:15], s21 offen
    s_mov_b32 s21, 4063232
    buffer_load_dwordx4 v[252:255], v7, s[12:15], s21 offen
    s_barrier
    ds_read_b64_tr_b16 v[64:65], v9 offset:0
    ds_read_b64_tr_b16 v[66:67], v9 offset:1024
    ds_read_b64_tr_b16 v[68:69], v9 offset:8192
    ds_read_b64_tr_b16 v[70:71], v9 offset:9216
    ds_read_b64_tr_b16 v[72:73], v9 offset:16384
    ds_read_b64_tr_b16 v[74:75], v9 offset:17408
    ds_read_b64_tr_b16 v[76:77], v9 offset:24576
    ds_read_b64_tr_b16 v[78:79], v9 offset:25600
    ds_read_b64_tr_b16 v[80:81], v9 offset:32768
    ds_read_b64_tr_b16 v[82:83], v9 offset:33792
    ds_read_b64_tr_b16 v[84:85], v9 offset:40960
    ds_read_b64_tr_b16 v[86:87], v9 offset:41984
    ds_read_b64_tr_b16 v[88:89], v9 offset:49152
    ds_read_b64_tr_b16 v[90:91], v9 offset:50176
    ds_read_b64_tr_b16 v[92:93], v9 offset:57344
    ds_read_b64_tr_b16 v[94:95], v9 offset:58368
    s_waitcnt lgkmcnt(0)
    v_accvgpr_write_b32 a128, v64
    v_accvgpr_write_b32 a129, v65
    v_accvgpr_write_b32 a130, v66
    v_accvgpr_write_b32 a131, v67
    v_accvgpr_write_b32 a132, v68
    v_accvgpr_write_b32 a133, v69
    v_accvgpr_write_b32 a134, v70
    v_accvgpr_write_b32 a135, v71
    v_accvgpr_write_b32 a136, v72
    v_accvgpr_write_b32 a137, v73
    v_accvgpr_write_b32 a138, v74
    v_accvgpr_write_b32 a139, v75
    v_accvgpr_write_b32 a140, v76
    v_accvgpr_write_b32 a141, v77
    v_accvgpr_write_b32 a142, v78
    v_accvgpr_write_b32 a143, v79
    v_accvgpr_write_b32 a144, v80
    v_accvgpr_write_b32 a145, v81
    v_accvgpr_write_b32 a146, v82
    v_accvgpr_write_b32 a147, v83
    v_accvgpr_write_b32 a148, v84
    v_accvgpr_write_b32 a149, v85
    v_accvgpr_write_b32 a150, v86
    v_accvgpr_write_b32 a151, v87
    v_accvgpr_write_b32 a152, v88
    v_accvgpr_write_b32 a153, v89
    v_accvgpr_write_b32 a154, v90
    v_accvgpr_write_b32 a155, v91
    v_accvgpr_write_b32 a156, v92
    v_accvgpr_write_b32 a157, v93
    v_accvgpr_write_b32 a158, v94
    v_accvgpr_write_b32 a159, v95
    ds_read_b64_tr_b16 v[64:65], v10 offset:0
    ds_read_b64_tr_b16 v[66:67], v10 offset:1024
    ds_read_b64_tr_b16 v[68:69], v10 offset:8192
    ds_read_b64_tr_b16 v[70:71], v10 offset:9216
    ds_read_b64_tr_b16 v[72:73], v10 offset:16384
    ds_read_b64_tr_b16 v[74:75], v10 offset:17408
    ds_read_b64_tr_b16 v[76:77], v10 offset:24576
    ds_read_b64_tr_b16 v[78:79], v10 offset:25600
    ds_read_b64_tr_b16 v[80:81], v10 offset:32768
    ds_read_b64_tr_b16 v[82:83], v10 offset:33792
    ds_read_b64_tr_b16 v[84:85], v10 offset:40960
    ds_read_b64_tr_b16 v[86:87], v10 offset:41984
    ds_read_b64_tr_b16 v[88:89], v10 offset:49152
    ds_read_b64_tr_b16 v[90:91], v10 offset:50176
    ds_read_b64_tr_b16 v[92:93], v10 offset:57344
    ds_read_b64_tr_b16 v[94:95], v10 offset:58368
    s_waitcnt lgkmcnt(0)
    v_accvgpr_write_b32 a160, v64
    v_accvgpr_write_b32 a161, v65
    v_accvgpr_write_b32 a162, v66
    v_accvgpr_write_b32 a163, v67
    v_accvgpr_write_b32 a164, v68
    v_accvgpr_write_b32 a165, v69
    v_accvgpr_write_b32 a166, v70
    v_accvgpr_write_b32 a167, v71
    v_accvgpr_write_b32 a168, v72
    v_accvgpr_write_b32 a169, v73
    v_accvgpr_write_b32 a170, v74
    v_accvgpr_write_b32 a171, v75
    v_accvgpr_write_b32 a172, v76
    v_accvgpr_write_b32 a173, v77
    v_accvgpr_write_b32 a174, v78
    v_accvgpr_write_b32 a175, v79
    v_accvgpr_write_b32 a176, v80
    v_accvgpr_write_b32 a177, v81
    v_accvgpr_write_b32 a178, v82
    v_accvgpr_write_b32 a179, v83
    v_accvgpr_write_b32 a180, v84
    v_accvgpr_write_b32 a181, v85
    v_accvgpr_write_b32 a182, v86
    v_accvgpr_write_b32 a183, v87
    v_accvgpr_write_b32 a184, v88
    v_accvgpr_write_b32 a185, v89
    v_accvgpr_write_b32 a186, v90
    v_accvgpr_write_b32 a187, v91
    v_accvgpr_write_b32 a188, v92
    v_accvgpr_write_b32 a189, v93
    v_accvgpr_write_b32 a190, v94
    v_accvgpr_write_b32 a191, v95
    ds_read_b64_tr_b16 v[64:65], v9 offset:32
    ds_read_b64_tr_b16 v[66:67], v9 offset:1056
    ds_read_b64_tr_b16 v[68:69], v9 offset:8224
    ds_read_b64_tr_b16 v[70:71], v9 offset:9248
    ds_read_b64_tr_b16 v[72:73], v9 offset:16416
    ds_read_b64_tr_b16 v[74:75], v9 offset:17440
    ds_read_b64_tr_b16 v[76:77], v9 offset:24608
    ds_read_b64_tr_b16 v[78:79], v9 offset:25632
    ds_read_b64_tr_b16 v[80:81], v9 offset:32800
    ds_read_b64_tr_b16 v[82:83], v9 offset:33824
    ds_read_b64_tr_b16 v[84:85], v9 offset:40992
    ds_read_b64_tr_b16 v[86:87], v9 offset:42016
    ds_read_b64_tr_b16 v[88:89], v9 offset:49184
    ds_read_b64_tr_b16 v[90:91], v9 offset:50208
    ds_read_b64_tr_b16 v[92:93], v9 offset:57376
    ds_read_b64_tr_b16 v[94:95], v9 offset:58400
    s_waitcnt lgkmcnt(0)
    v_accvgpr_write_b32 a192, v64
    v_accvgpr_write_b32 a193, v65
    v_accvgpr_write_b32 a194, v66
    v_accvgpr_write_b32 a195, v67
    v_accvgpr_write_b32 a196, v68
    v_accvgpr_write_b32 a197, v69
    v_accvgpr_write_b32 a198, v70
    v_accvgpr_write_b32 a199, v71
    v_accvgpr_write_b32 a200, v72
    v_accvgpr_write_b32 a201, v73
    v_accvgpr_write_b32 a202, v74
    v_accvgpr_write_b32 a203, v75
    v_accvgpr_write_b32 a204, v76
    v_accvgpr_write_b32 a205, v77
    v_accvgpr_write_b32 a206, v78
    v_accvgpr_write_b32 a207, v79
    v_accvgpr_write_b32 a208, v80
    v_accvgpr_write_b32 a209, v81
    v_accvgpr_write_b32 a210, v82
    v_accvgpr_write_b32 a211, v83
    v_accvgpr_write_b32 a212, v84
    v_accvgpr_write_b32 a213, v85
    v_accvgpr_write_b32 a214, v86
    v_accvgpr_write_b32 a215, v87
    v_accvgpr_write_b32 a216, v88
    v_accvgpr_write_b32 a217, v89
    v_accvgpr_write_b32 a218, v90
    v_accvgpr_write_b32 a219, v91
    v_accvgpr_write_b32 a220, v92
    v_accvgpr_write_b32 a221, v93
    v_accvgpr_write_b32 a222, v94
    v_accvgpr_write_b32 a223, v95
    ds_read_b64_tr_b16 v[64:65], v10 offset:32
    ds_read_b64_tr_b16 v[66:67], v10 offset:1056
    ds_read_b64_tr_b16 v[68:69], v10 offset:8224
    ds_read_b64_tr_b16 v[70:71], v10 offset:9248
    ds_read_b64_tr_b16 v[72:73], v10 offset:16416
    ds_read_b64_tr_b16 v[74:75], v10 offset:17440
    ds_read_b64_tr_b16 v[76:77], v10 offset:24608
    ds_read_b64_tr_b16 v[78:79], v10 offset:25632
    ds_read_b64_tr_b16 v[80:81], v10 offset:32800
    ds_read_b64_tr_b16 v[82:83], v10 offset:33824
    ds_read_b64_tr_b16 v[84:85], v10 offset:40992
    ds_read_b64_tr_b16 v[86:87], v10 offset:42016
    ds_read_b64_tr_b16 v[88:89], v10 offset:49184
    ds_read_b64_tr_b16 v[90:91], v10 offset:50208
    ds_read_b64_tr_b16 v[92:93], v10 offset:57376
    ds_read_b64_tr_b16 v[94:95], v10 offset:58400
    s_waitcnt lgkmcnt(0)
    v_accvgpr_write_b32 a224, v64
    v_accvgpr_write_b32 a225, v65
    v_accvgpr_write_b32 a226, v66
    v_accvgpr_write_b32 a227, v67
    v_accvgpr_write_b32 a228, v68
    v_accvgpr_write_b32 a229, v69
    v_accvgpr_write_b32 a230, v70
    v_accvgpr_write_b32 a231, v71
    v_accvgpr_write_b32 a232, v72
    v_accvgpr_write_b32 a233, v73
    v_accvgpr_write_b32 a234, v74
    v_accvgpr_write_b32 a235, v75
    v_accvgpr_write_b32 a236, v76
    v_accvgpr_write_b32 a237, v77
    v_accvgpr_write_b32 a238, v78
    v_accvgpr_write_b32 a239, v79
    v_accvgpr_write_b32 a240, v80
    v_accvgpr_write_b32 a241, v81
    v_accvgpr_write_b32 a242, v82
    v_accvgpr_write_b32 a243, v83
    v_accvgpr_write_b32 a244, v84
    v_accvgpr_write_b32 a245, v85
    v_accvgpr_write_b32 a246, v86
    v_accvgpr_write_b32 a247, v87
    v_accvgpr_write_b32 a248, v88
    v_accvgpr_write_b32 a249, v89
    v_accvgpr_write_b32 a250, v90
    v_accvgpr_write_b32 a251, v91
    v_accvgpr_write_b32 a252, v92
    v_accvgpr_write_b32 a253, v93
    v_accvgpr_write_b32 a254, v94
    v_accvgpr_write_b32 a255, v95
    s_barrier
    s_waitcnt vmcnt(31)
    ds_write_b128 v8, v[128:131] offset:0
    s_waitcnt vmcnt(30)
    ds_write_b128 v8, v[132:135] offset:4096
    s_waitcnt vmcnt(29)
    ds_write_b128 v8, v[136:139] offset:8192
    s_waitcnt vmcnt(28)
    ds_write_b128 v8, v[140:143] offset:12288
    s_waitcnt vmcnt(27)
    ds_write_b128 v8, v[144:147] offset:16384
    s_waitcnt vmcnt(26)
    ds_write_b128 v8, v[148:151] offset:20480
    s_waitcnt vmcnt(25)
    ds_write_b128 v8, v[152:155] offset:24576
    s_waitcnt vmcnt(24)
    ds_write_b128 v8, v[156:159] offset:28672
    s_waitcnt vmcnt(23)
    ds_write_b128 v8, v[160:163] offset:32768
    s_waitcnt vmcnt(22)
    ds_write_b128 v8, v[164:167] offset:36864
    s_waitcnt vmcnt(21)
    ds_write_b128 v8, v[168:171] offset:40960
    s_waitcnt vmcnt(20)
    ds_write_b128 v8, v[172:175] offset:45056
    s_waitcnt vmcnt(19)
    ds_write_b128 v8, v[176:179] offset:49152
    s_waitcnt vmcnt(18)
    ds_write_b128 v8, v[180:183] offset:53248
    s_waitcnt vmcnt(17)
    ds_write_b128 v8, v[184:187] offset:57344
    s_waitcnt vmcnt(16)
    ds_write_b128 v8, v[188:191] offset:61440
    s_waitcnt vmcnt(15)
    ds_write_b128 v11, v[192:195] offset:0
    s_waitcnt vmcnt(14)
    ds_write_b128 v11, v[196:199] offset:4096
    s_waitcnt vmcnt(13)
    ds_write_b128 v11, v[200:203] offset:8192
    s_waitcnt vmcnt(12)
    ds_write_b128 v11, v[204:207] offset:12288
    s_waitcnt vmcnt(11)
    ds_write_b128 v11, v[208:211] offset:16384
    s_waitcnt vmcnt(10)
    ds_write_b128 v11, v[212:215] offset:20480
    s_waitcnt vmcnt(9)
    ds_write_b128 v11, v[216:219] offset:24576
    s_waitcnt vmcnt(8)
    ds_write_b128 v11, v[220:223] offset:28672
    s_waitcnt vmcnt(7)
    ds_write_b128 v11, v[224:227] offset:32768
    s_waitcnt vmcnt(6)
    ds_write_b128 v11, v[228:231] offset:36864
    s_waitcnt vmcnt(5)
    ds_write_b128 v11, v[232:235] offset:40960
    s_waitcnt vmcnt(4)
    ds_write_b128 v11, v[236:239] offset:45056
    s_waitcnt vmcnt(3)
    ds_write_b128 v11, v[240:243] offset:49152
    s_waitcnt vmcnt(2)
    ds_write_b128 v11, v[244:247] offset:53248
    s_waitcnt vmcnt(1)
    ds_write_b128 v11, v[248:251] offset:57344
    s_waitcnt vmcnt(0)
    ds_write_b128 v11, v[252:255] offset:61440
    s_waitcnt lgkmcnt(0)
    s_barrier
    ds_read_b64_tr_b16 v[128:129], v9 offset:0
    ds_read_b64_tr_b16 v[130:131], v9 offset:1024
    ds_read_b64_tr_b16 v[132:133], v9 offset:8192
    ds_read_b64_tr_b16 v[134:135], v9 offset:9216
    ds_read_b64_tr_b16 v[136:137], v9 offset:16384
    ds_read_b64_tr_b16 v[138:139], v9 offset:17408
    ds_read_b64_tr_b16 v[140:141], v9 offset:24576
    ds_read_b64_tr_b16 v[142:143], v9 offset:25600
    ds_read_b64_tr_b16 v[144:145], v9 offset:32768
    ds_read_b64_tr_b16 v[146:147], v9 offset:33792
    ds_read_b64_tr_b16 v[148:149], v9 offset:40960
    ds_read_b64_tr_b16 v[150:151], v9 offset:41984
    ds_read_b64_tr_b16 v[152:153], v9 offset:49152
    ds_read_b64_tr_b16 v[154:155], v9 offset:50176
    ds_read_b64_tr_b16 v[156:157], v9 offset:57344
    ds_read_b64_tr_b16 v[158:159], v9 offset:58368
    s_waitcnt lgkmcnt(0)
    ds_read_b64_tr_b16 v[160:161], v10 offset:0
    ds_read_b64_tr_b16 v[162:163], v10 offset:1024
    ds_read_b64_tr_b16 v[164:165], v10 offset:8192
    ds_read_b64_tr_b16 v[166:167], v10 offset:9216
    ds_read_b64_tr_b16 v[168:169], v10 offset:16384
    ds_read_b64_tr_b16 v[170:171], v10 offset:17408
    ds_read_b64_tr_b16 v[172:173], v10 offset:24576
    ds_read_b64_tr_b16 v[174:175], v10 offset:25600
    ds_read_b64_tr_b16 v[176:177], v10 offset:32768
    ds_read_b64_tr_b16 v[178:179], v10 offset:33792
    ds_read_b64_tr_b16 v[180:181], v10 offset:40960
    ds_read_b64_tr_b16 v[182:183], v10 offset:41984
    ds_read_b64_tr_b16 v[184:185], v10 offset:49152
    ds_read_b64_tr_b16 v[186:187], v10 offset:50176
    ds_read_b64_tr_b16 v[188:189], v10 offset:57344
    ds_read_b64_tr_b16 v[190:191], v10 offset:58368
    s_waitcnt lgkmcnt(0)
    ds_read_b64_tr_b16 v[192:193], v9 offset:32
    ds_read_b64_tr_b16 v[194:195], v9 offset:1056
    ds_read_b64_tr_b16 v[196:197], v9 offset:8224
    ds_read_b64_tr_b16 v[198:199], v9 offset:9248
    ds_read_b64_tr_b16 v[200:201], v9 offset:16416
    ds_read_b64_tr_b16 v[202:203], v9 offset:17440
    ds_read_b64_tr_b16 v[204:205], v9 offset:24608
    ds_read_b64_tr_b16 v[206:207], v9 offset:25632
    ds_read_b64_tr_b16 v[208:209], v9 offset:32800
    ds_read_b64_tr_b16 v[210:211], v9 offset:33824
    ds_read_b64_tr_b16 v[212:213], v9 offset:40992
    ds_read_b64_tr_b16 v[214:215], v9 offset:42016
    ds_read_b64_tr_b16 v[216:217], v9 offset:49184
    ds_read_b64_tr_b16 v[218:219], v9 offset:50208
    ds_read_b64_tr_b16 v[220:221], v9 offset:57376
    ds_read_b64_tr_b16 v[222:223], v9 offset:58400
    s_waitcnt lgkmcnt(0)
    ds_read_b64_tr_b16 v[224:225], v10 offset:32
    ds_read_b64_tr_b16 v[226:227], v10 offset:1056
    ds_read_b64_tr_b16 v[228:229], v10 offset:8224
    ds_read_b64_tr_b16 v[230:231], v10 offset:9248
    ds_read_b64_tr_b16 v[232:233], v10 offset:16416
    ds_read_b64_tr_b16 v[234:235], v10 offset:17440
    ds_read_b64_tr_b16 v[236:237], v10 offset:24608
    ds_read_b64_tr_b16 v[238:239], v10 offset:25632
    ds_read_b64_tr_b16 v[240:241], v10 offset:32800
    ds_read_b64_tr_b16 v[242:243], v10 offset:33824
    ds_read_b64_tr_b16 v[244:245], v10 offset:40992
    ds_read_b64_tr_b16 v[246:247], v10 offset:42016
    ds_read_b64_tr_b16 v[248:249], v10 offset:49184
    ds_read_b64_tr_b16 v[250:251], v10 offset:50208
    ds_read_b64_tr_b16 v[252:253], v10 offset:57376
    ds_read_b64_tr_b16 v[254:255], v10 offset:58400
    s_waitcnt lgkmcnt(0)
    s_barrier
    s_load_dwordx2 s[12:13], s[0:1], 40
    s_waitcnt lgkmcnt(0)
    s_mov_b32 s14, 4194304
    s_mov_b32 s15, 0x00020000
    v_lshlrev_b32 v7, 4, v0
    s_lshl_b32 s20, s16, 17
    v_add_u32 v10, s20, v7
    s_mov_b32 s21, 0
    buffer_load_dwordx4 v[64:67], v10, s[12:15], s21 offen
    s_mov_b32 s21, 4096
    buffer_load_dwordx4 v[68:71], v10, s[12:15], s21 offen
    s_mov_b32 s21, 8192
    buffer_load_dwordx4 v[72:75], v10, s[12:15], s21 offen
    s_mov_b32 s21, 12288
    buffer_load_dwordx4 v[76:79], v10, s[12:15], s21 offen
    s_mov_b32 s21, 16384
    buffer_load_dwordx4 v[80:83], v10, s[12:15], s21 offen
    s_mov_b32 s21, 20480
    buffer_load_dwordx4 v[84:87], v10, s[12:15], s21 offen
    s_mov_b32 s21, 24576
    buffer_load_dwordx4 v[88:91], v10, s[12:15], s21 offen
    s_mov_b32 s21, 28672
    buffer_load_dwordx4 v[92:95], v10, s[12:15], s21 offen
    s_mov_b32 s21, 32768
    buffer_load_dwordx4 v[96:99], v10, s[12:15], s21 offen
    s_mov_b32 s21, 36864
    buffer_load_dwordx4 v[100:103], v10, s[12:15], s21 offen
    s_mov_b32 s21, 40960
    buffer_load_dwordx4 v[104:107], v10, s[12:15], s21 offen
    s_mov_b32 s21, 45056
    buffer_load_dwordx4 v[108:111], v10, s[12:15], s21 offen
    s_mov_b32 s21, 49152
    buffer_load_dwordx4 v[112:115], v10, s[12:15], s21 offen
    s_mov_b32 s21, 53248
    buffer_load_dwordx4 v[116:119], v10, s[12:15], s21 offen
    s_mov_b32 s21, 57344
    buffer_load_dwordx4 v[120:123], v10, s[12:15], s21 offen
    s_mov_b32 s21, 61440
    buffer_load_dwordx4 v[124:127], v10, s[12:15], s21 offen
    s_waitcnt vmcnt(0)
    ds_write_b128 v7, v[64:67] offset:0
    ds_write_b128 v7, v[68:71] offset:4096
    ds_write_b128 v7, v[72:75] offset:8192
    ds_write_b128 v7, v[76:79] offset:12288
    ds_write_b128 v7, v[80:83] offset:16384
    ds_write_b128 v7, v[84:87] offset:20480
    ds_write_b128 v7, v[88:91] offset:24576
    ds_write_b128 v7, v[92:95] offset:28672
    ds_write_b128 v7, v[96:99] offset:32768
    ds_write_b128 v7, v[100:103] offset:36864
    ds_write_b128 v7, v[104:107] offset:40960
    ds_write_b128 v7, v[108:111] offset:45056
    ds_write_b128 v7, v[112:115] offset:49152
    ds_write_b128 v7, v[116:119] offset:53248
    ds_write_b128 v7, v[120:123] offset:57344
    ds_write_b128 v7, v[124:127] offset:61440
    s_mov_b32 s21, 65536
    buffer_load_dwordx4 v[64:67], v10, s[12:15], s21 offen
    s_mov_b32 s21, 69632
    buffer_load_dwordx4 v[68:71], v10, s[12:15], s21 offen
    s_mov_b32 s21, 73728
    buffer_load_dwordx4 v[72:75], v10, s[12:15], s21 offen
    s_mov_b32 s21, 77824
    buffer_load_dwordx4 v[76:79], v10, s[12:15], s21 offen
    s_mov_b32 s21, 81920
    buffer_load_dwordx4 v[80:83], v10, s[12:15], s21 offen
    s_mov_b32 s21, 86016
    buffer_load_dwordx4 v[84:87], v10, s[12:15], s21 offen
    s_mov_b32 s21, 90112
    buffer_load_dwordx4 v[88:91], v10, s[12:15], s21 offen
    s_mov_b32 s21, 94208
    buffer_load_dwordx4 v[92:95], v10, s[12:15], s21 offen
    s_mov_b32 s21, 98304
    buffer_load_dwordx4 v[96:99], v10, s[12:15], s21 offen
    s_mov_b32 s21, 102400
    buffer_load_dwordx4 v[100:103], v10, s[12:15], s21 offen
    s_mov_b32 s21, 106496
    buffer_load_dwordx4 v[104:107], v10, s[12:15], s21 offen
    s_mov_b32 s21, 110592
    buffer_load_dwordx4 v[108:111], v10, s[12:15], s21 offen
    s_mov_b32 s21, 114688
    buffer_load_dwordx4 v[112:115], v10, s[12:15], s21 offen
    s_mov_b32 s21, 118784
    buffer_load_dwordx4 v[116:119], v10, s[12:15], s21 offen
    s_mov_b32 s21, 122880
    buffer_load_dwordx4 v[120:123], v10, s[12:15], s21 offen
    s_mov_b32 s21, 126976
    buffer_load_dwordx4 v[124:127], v10, s[12:15], s21 offen
    s_waitcnt vmcnt(0)
    v_add_u32 v11, 65536, v7
    ds_write_b128 v11, v[64:67] offset:0
    v_add_u32 v11, 65536, v7
    ds_write_b128 v11, v[68:71] offset:4096
    v_add_u32 v11, 65536, v7
    ds_write_b128 v11, v[72:75] offset:8192
    v_add_u32 v11, 65536, v7
    ds_write_b128 v11, v[76:79] offset:12288
    v_add_u32 v11, 65536, v7
    ds_write_b128 v11, v[80:83] offset:16384
    v_add_u32 v11, 65536, v7
    ds_write_b128 v11, v[84:87] offset:20480
    v_add_u32 v11, 65536, v7
    ds_write_b128 v11, v[88:91] offset:24576
    v_add_u32 v11, 65536, v7
    ds_write_b128 v11, v[92:95] offset:28672
    v_add_u32 v11, 65536, v7
    ds_write_b128 v11, v[96:99] offset:32768
    v_add_u32 v11, 65536, v7
    ds_write_b128 v11, v[100:103] offset:36864
    v_add_u32 v11, 65536, v7
    ds_write_b128 v11, v[104:107] offset:40960
    v_add_u32 v11, 65536, v7
    ds_write_b128 v11, v[108:111] offset:45056
    v_add_u32 v11, 65536, v7
    ds_write_b128 v11, v[112:115] offset:49152
    v_add_u32 v11, 65536, v7
    ds_write_b128 v11, v[116:119] offset:53248
    v_add_u32 v11, 65536, v7
    ds_write_b128 v11, v[120:123] offset:57344
    v_add_u32 v11, 65536, v7
    ds_write_b128 v11, v[124:127] offset:61440
    s_waitcnt lgkmcnt(0)
    s_barrier
    v_lshrrev_b32 v9, 2, v3
    v_lshl_add_u32 v9, v4, 2, v9
    v_lshlrev_b32 v9, 10, v9
    v_and_b32 v10, 3, v1
    v_lshl_add_u32 v9, v10, 3, v9
    v_lshl_add_u32 v9, v2, 8, v9
    v_add_u32 v10, 65536, v9
    ds_read_b64_tr_b16 v[64:65], v9 offset:0
    ds_read_b64_tr_b16 v[66:67], v9 offset:16384
    ds_read_b64_tr_b16 v[68:69], v9 offset:32768
    ds_read_b64_tr_b16 v[70:71], v9 offset:49152
    ds_read_b64_tr_b16 v[72:73], v10 offset:0
    ds_read_b64_tr_b16 v[74:75], v10 offset:16384
    ds_read_b64_tr_b16 v[76:77], v10 offset:32768
    ds_read_b64_tr_b16 v[78:79], v10 offset:49152
    ds_read_b64_tr_b16 v[80:81], v9 offset:32
    ds_read_b64_tr_b16 v[82:83], v9 offset:16416
    ds_read_b64_tr_b16 v[84:85], v9 offset:32800
    ds_read_b64_tr_b16 v[86:87], v9 offset:49184
    ds_read_b64_tr_b16 v[88:89], v10 offset:32
    ds_read_b64_tr_b16 v[90:91], v10 offset:16416
    ds_read_b64_tr_b16 v[92:93], v10 offset:32800
    ds_read_b64_tr_b16 v[94:95], v10 offset:49184
    ds_read_b64_tr_b16 v[96:97], v9 offset:64
    ds_read_b64_tr_b16 v[98:99], v9 offset:16448
    ds_read_b64_tr_b16 v[100:101], v9 offset:32832
    ds_read_b64_tr_b16 v[102:103], v9 offset:49216
    ds_read_b64_tr_b16 v[104:105], v10 offset:64
    ds_read_b64_tr_b16 v[106:107], v10 offset:16448
    ds_read_b64_tr_b16 v[108:109], v10 offset:32832
    ds_read_b64_tr_b16 v[110:111], v10 offset:49216
    ds_read_b64_tr_b16 v[112:113], v9 offset:96
    ds_read_b64_tr_b16 v[114:115], v9 offset:16480
    ds_read_b64_tr_b16 v[116:117], v9 offset:32864
    ds_read_b64_tr_b16 v[118:119], v9 offset:49248
    ds_read_b64_tr_b16 v[120:121], v10 offset:96
    ds_read_b64_tr_b16 v[122:123], v10 offset:16480
    ds_read_b64_tr_b16 v[124:125], v10 offset:32864
    ds_read_b64_tr_b16 v[126:127], v10 offset:49248
    s_waitcnt lgkmcnt(0)
    v_lshrrev_b32 v11, 3, v1
    v_lshlrev_b32 v11, 10, v11
    v_and_b32 v12, 7, v1
    v_lshl_add_u32 v11, v12, 4, v11
    v_lshl_add_u32 v11, v2, 8, v11
    v_add_u32 v12, 65536, v11
    ds_write_b128 v11, v[64:67] offset:0
    ds_write_b128 v11, v[68:71] offset:8192
    ds_write_b128 v11, v[72:75] offset:16384
    ds_write_b128 v11, v[76:79] offset:24576
    ds_write_b128 v11, v[80:83] offset:32768
    ds_write_b128 v11, v[84:87] offset:40960
    ds_write_b128 v11, v[88:91] offset:49152
    ds_write_b128 v11, v[92:95] offset:57344
    ds_write_b128 v12, v[96:99] offset:0
    ds_write_b128 v12, v[100:103] offset:8192
    ds_write_b128 v12, v[104:107] offset:16384
    ds_write_b128 v12, v[108:111] offset:24576
    ds_write_b128 v12, v[112:115] offset:32768
    ds_write_b128 v12, v[116:119] offset:40960
    ds_write_b128 v12, v[120:123] offset:49152
    ds_write_b128 v12, v[124:127] offset:57344
    s_waitcnt lgkmcnt(0)
    ds_read_b64_tr_b16 v[64:65], v9 offset:128
    ds_read_b64_tr_b16 v[66:67], v9 offset:16512
    ds_read_b64_tr_b16 v[68:69], v9 offset:32896
    ds_read_b64_tr_b16 v[70:71], v9 offset:49280
    ds_read_b64_tr_b16 v[72:73], v10 offset:128
    ds_read_b64_tr_b16 v[74:75], v10 offset:16512
    ds_read_b64_tr_b16 v[76:77], v10 offset:32896
    ds_read_b64_tr_b16 v[78:79], v10 offset:49280
    ds_read_b64_tr_b16 v[80:81], v9 offset:160
    ds_read_b64_tr_b16 v[82:83], v9 offset:16544
    ds_read_b64_tr_b16 v[84:85], v9 offset:32928
    ds_read_b64_tr_b16 v[86:87], v9 offset:49312
    ds_read_b64_tr_b16 v[88:89], v10 offset:160
    ds_read_b64_tr_b16 v[90:91], v10 offset:16544
    ds_read_b64_tr_b16 v[92:93], v10 offset:32928
    ds_read_b64_tr_b16 v[94:95], v10 offset:49312
    ds_read_b64_tr_b16 v[96:97], v9 offset:192
    ds_read_b64_tr_b16 v[98:99], v9 offset:16576
    ds_read_b64_tr_b16 v[100:101], v9 offset:32960
    ds_read_b64_tr_b16 v[102:103], v9 offset:49344
    ds_read_b64_tr_b16 v[104:105], v10 offset:192
    ds_read_b64_tr_b16 v[106:107], v10 offset:16576
    ds_read_b64_tr_b16 v[108:109], v10 offset:32960
    ds_read_b64_tr_b16 v[110:111], v10 offset:49344
    ds_read_b64_tr_b16 v[112:113], v9 offset:224
    ds_read_b64_tr_b16 v[114:115], v9 offset:16608
    ds_read_b64_tr_b16 v[116:117], v9 offset:32992
    ds_read_b64_tr_b16 v[118:119], v9 offset:49376
    ds_read_b64_tr_b16 v[120:121], v10 offset:224
    ds_read_b64_tr_b16 v[122:123], v10 offset:16608
    ds_read_b64_tr_b16 v[124:125], v10 offset:32992
    ds_read_b64_tr_b16 v[126:127], v10 offset:49376
    s_waitcnt lgkmcnt(0)
    ds_write_b128 v11, v[64:67] offset:128
    ds_write_b128 v11, v[68:71] offset:8320
    ds_write_b128 v11, v[72:75] offset:16512
    ds_write_b128 v11, v[76:79] offset:24704
    ds_write_b128 v11, v[80:83] offset:32896
    ds_write_b128 v11, v[84:87] offset:41088
    ds_write_b128 v11, v[88:91] offset:49280
    ds_write_b128 v11, v[92:95] offset:57472
    ds_write_b128 v12, v[96:99] offset:128
    ds_write_b128 v12, v[100:103] offset:8320
    ds_write_b128 v12, v[104:107] offset:16512
    ds_write_b128 v12, v[108:111] offset:24704
    ds_write_b128 v12, v[112:115] offset:32896
    ds_write_b128 v12, v[116:119] offset:41088
    ds_write_b128 v12, v[120:123] offset:49280
    ds_write_b128 v12, v[124:127] offset:57472
    s_waitcnt lgkmcnt(0)
    v_lshlrev_b32 v13, 13, v5
    v_lshl_add_u32 v13, v6, 4, v13
    s_lshl_b32 s20, s16, 8
    v_add_u32 v13, s20, v13
    v_mul_u32_u24 v14, 272, v5
    v_lshl_add_u32 v14, v6, 4, v14
    v_add_u32 v14, 145792, v14
    v_lshlrev_b32 v15, 4, v0
    s_mov_b32 s22, 0
    s_mov_b32 s60, 0
    s_mov_b32 s57, 0
    s_add_u32 s25, s22, s57
    s_and_b32 s23, s25, 3
    s_cmp_lg_u32 s23, 0
    s_cbranch_scc1 chain_kernel_nf10
    s_cmp_ge_u32 s25, 64
    s_cbranch_scc1 chain_kernel_nf10
    s_lshr_b32 s23, s25, 2
    s_lshl_b32 s23, s23, 8
    s_lshl_b32 s24, s16, 2
    s_add_u32 s23, s23, s24
    s_add_u32 s23, s23, 105906176
    v_mov_b32 v44, 0
chain_kernel_pf11:
    buffer_load_dword v45, v44, s[8:11], s23 offen sc1
    buffer_load_dword v46, v44, s[8:11], s23 offen offset:128 sc1
    s_waitcnt vmcnt(0)
    v_and_b32 v45, v45, v46
    s_nop 0
    v_readfirstlane_b32 s24, v45
    s_add_u32 s60, s60, 1
    s_cmp_gt_u32 s60, 0x400000
    s_cbranch_scc1 chain_kernel_done1
    s_cmp_eq_u32 s24, 0
    s_cbranch_scc1 chain_kernel_pf11
chain_kernel_nf10:
    s_lshl_b32 s23, s22, 18
    s_add_u32 s23, s23, 20971520
    s_add_u32 s24, s23, 131072
    s_lshl_b32 s25, s22, 5
    s_add_u32 s25, s25, s16
    s_lshl_b32 s25, s25, 13
    s_add_u32 s25, s25, 37748736
    buffer_load_dwordx4 v[40:43], v13, s[8:11], s23 offen
    buffer_load_dwordx4 v[44:47], v13, s[8:11], s24 offen
    buffer_load_dwordx4 v[120:123], v15, s[8:11], s25 offen
    s_add_u32 s25, s25, 4096
    buffer_load_dwordx4 v[124:127], v15, s[8:11], s25 offen
    s_mov_b32 s57, 1
    s_waitcnt vmcnt(0)
    ds_write_b128 v14, v[40:43]
    ds_write_b128 v14, v[44:47] offset:4352
    v_add_u32 v16, 154496, v15
    ds_write_b128 v16, v[120:123]
    ds_write_b128 v16, v[124:127] offset:4096
    s_waitcnt lgkmcnt(0)
    s_barrier
    v_and_b32 v16, 7, v3
    v_mul_u32_u24 v5, 1040, v16
    v_lshl_add_u32 v5, v4, 4, v5
    v_add_u32 v5, 131072, v5
    v_mul_u32_u24 v6, 272, v16
    v_lshl_add_u32 v6, v4, 4, v6
    v_add_u32 v6, 139392, v6
    v_mul_u32_u24 v7, 272, v3
    v_lshl_add_u32 v7, v4, 4, v7
    v_add_u32 v7, 145792, v7
    v_mul_u32_u24 v8, 272, v3
    v_lshl_add_u32 v8, v4, 3, v8
    v_lshl_add_u32 v8, v2, 6, v8
    v_add_u32 v8, 139392, v8
    v_lshl_add_u32 v9, v2, 5, v3
    v_lshlrev_b32 v9, 4, v9
    v_lshl_add_u32 v9, v4, 3, v9
    v_add_u32 v9, 143744, v9
    v_lshlrev_b32 v10, 4, v3
    v_and_b32 v16, 1, v4
    v_lshl_add_u32 v10, v16, 3, v10
    v_add_u32 v10, 143744, v10
    v_and_b32 v24, 7, v3
    v_mul_u32_u24 v8, 272, v24
    v_lshl_add_u32 v8, v4, 3, v8
    v_lshl_add_u32 v8, v2, 6, v8
    v_add_u32 v8, 139392, v8
    v_lshl_add_u32 v9, v2, 5, v3
    v_lshlrev_b32 v9, 4, v9
    v_and_b32 v25, 1, v4
    v_lshl_add_u32 v9, v25, 3, v9
    v_add_u32 v9, 143744, v9
    v_lshlrev_b32 v16, 8, v24
    v_lshl_add_u32 v16, v4, 3, v16
    v_lshl_add_u32 v16, v2, 6, v16
    v_subrev_u32 v17, 143744, v9
    v_lshlrev_b32 v18, 6, v3
    v_lshl_add_u32 v18, v4, 3, v18
    v_add_u32 v18, 154496, v18
    v_lshlrev_b32 v19, 6, v24
    v_lshl_add_u32 v19, v4, 4, v19
    v_lshl_add_u32 v19, v2, 17, v19
    v_and_b32 v25, 8, v1
    v_lshl_add_u32 v19, v25, 11, v19
    s_lshl_b32 s35, s16, 9
    v_add_u32 v19, s35, v19
    v_and_b32 v25, 7, v1
    v_lshlrev_b32 v20, 4, v25
    v_lshl_add_u32 v20, v2, 7, v20
    v_lshrrev_b32 v26, 3, v1
    v_lshl_add_u32 v20, v26, 11, v20
    s_lshl_b32 s35, s16, 14
    v_add_u32 v20, s35, v20
    v_lshrrev_b32 v26, 2, v25
    v_lshl_add_u32 v26, v2, 1, v26
    v_lshlrev_b32 v22, 10, v26
    v_and_b32 v26, 3, v1
    v_lshl_add_u32 v22, v26, 3, v22
    s_lshl_b32 s35, s16, 5
    v_add_u32 v22, s35, v22
    v_lshrrev_b32 v21, 1, v1
    v_lshlrev_b32 v21, 13, v21
    v_and_b32 v25, 1, v1
    v_lshl_add_u32 v21, v25, 7, v21
    s_lshl_b32 s20, s16, 8
    v_add_u32 v21, s20, v21
    v_lshlrev_b32 v25, 7, v1
    s_lshl_b32 s20, s16, 13
    s_add_u32 s20, s20, 16777216
    v_add_u32 v25, s20, v25
    v_and_b32 v26, 1, v2
    v_cmp_eq_u32 vcc, 1, v26
    s_nop 1
    v_cndmask_b32 v21, v21, v25, vcc
    v_mul_u32_u24 v23, 1040, v2
    v_lshl_add_u32 v23, v1, 4, v23
    v_add_u32 v23, 131072, v23
    v_cmp_gt_u32 s[28:29], 2, v4
    v_cmp_gt_u32 s[26:27], 8, v3
    s_nop 3
    s_andn2_b64 s[42:43], s[26:27], s[28:29]
    s_mov_b32 s30, 0x3db504f3
    s_mov_b32 s31, 0xce6e6b28
    s_mov_b32 s32, 0x3fb8aa3b
    s_mov_b32 s17, 0
    s_mov_b32 s60, 0
    s_mov_b32 s59, 0xffff0000
    s_cmp_lg_u32 s58, 0
    s_cbranch_scc1 chain_kernel_slowloop12
chain_kernel_step13:
    s_lshl_b32 s22, s17, 5
    s_add_u32 s22, s22, s16
    s_lshl_b32 s22, s22, 11
    s_add_u32 s23, s22, 83886080
    s_add_u32 s24, s22, 88080384
    s_and_b32 s33, s17, 1
    s_lshl_b32 s34, s33, 19
    s_add_u32 s34, s34, 117440512
    s_lshl_b32 s35, s33, 18
    s_add_u32 s35, s35, 104857600
    s_xor_b32 s36, s35, 0x40000
    s_add_u32 s37, s35, 4096
    s_lshr_b32 s19, s17, 1
    s_and_b32 s19, s19, 1
    s_add_u32 s40, s17, 1
    s_lshl_b32 s40, s40, 18
    s_add_u32 s40, s40, 20971520
chain_kernel_pm14:
    buffer_load_dwordx4 v[64:67], v15, s[8:11], s35 offen sc1
    buffer_load_dwordx4 v[68:71], v15, s[8:11], s37 offen sc1
    s_waitcnt vmcnt(0)
    v_max3_u32 v24, v64, v65, v66
    v_max3_u32 v25, v67, v68, v69
    v_max3_u32 v24, v24, v70, v71
    v_max_u32 v24, v24, v25
    v_cmp_eq_u32 vcc, -1, v24
    s_mov_b64 exec, vcc
    s_cbranch_execz chain_kernel_okm15
    s_add_u32 s60, s60, 1
    s_cmp_gt_u32 s60, 0x200000
    s_cbranch_scc1 chain_kernel_done1
    s_branch chain_kernel_pm14
chain_kernel_okm15:
    s_mov_b64 exec, -1
    ds_write_b128 v23, v[64:67]
    ds_write_b128 v23, v[68:71] offset:4160
    s_waitcnt lgkmcnt(0)
    s_barrier
    ds_write_b128 v14, v[40:43]
    ds_write_b128 v14, v[44:47] offset:4352
    v_add_u32 v52, 154496, v15
    ds_write_b128 v52, v[120:123]
    ds_write_b128 v52, v[124:127] offset:4096
    buffer_load_dword v0, v21, s[8:11], s40 offen
    ds_read_b128 v[64:67], v5 offset:0
    ds_read_b128 v[68:71], v5 offset:64
    ds_read_b128 v[72:75], v5 offset:128
    ds_read_b128 v[76:79], v5 offset:192
    ds_read_b128 v[80:83], v5 offset:256
    ds_read_b128 v[84:87], v5 offset:320
    ds_read_b128 v[88:91], v5 offset:384
    ds_read_b128 v[92:95], v5 offset:448
    ds_read_b128 v[96:99], v5 offset:512
    ds_read_b128 v[100:103], v5 offset:576
    ds_read_b128 v[104:107], v5 offset:640
    ds_read_b128 v[108:111], v5 offset:704
    ds_read_b128 v[112:115], v5 offset:768
    ds_read_b128 v[116:119], v5 offset:832
    ds_read_b128 v[120:123], v5 offset:896
    ds_read_b128 v[124:127], v5 offset:960
    s_waitcnt lgkmcnt(15)
    v_mfma_f32_16x16x32_bf16 v[40:43], v[64:67], v[128:131], 0
    v_mfma_f32_16x16x32_bf16 v[44:47], v[64:67], v[192:195], 0
    s_waitcnt lgkmcnt(14)
    v_mfma_f32_16x16x32_bf16 v[40:43], v[68:71], v[132:135], v[40:43]
    v_mfma_f32_16x16x32_bf16 v[44:47], v[68:71], v[196:199], v[44:47]
    s_waitcnt lgkmcnt(13)
    v_mfma_f32_16x16x32_bf16 v[40:43], v[72:75], v[136:139], v[40:43]
    v_mfma_f32_16x16x32_bf16 v[44:47], v[72:75], v[200:203], v[44:47]
    s_waitcnt lgkmcnt(12)
    v_mfma_f32_16x16x32_bf16 v[40:43], v[76:79], v[140:143], v[40:43]
    v_mfma_f32_16x16x32_bf16 v[44:47], v[76:79], v[204:207], v[44:47]
    s_waitcnt lgkmcnt(11)
    v_mfma_f32_16x16x32_bf16 v[40:43], v[80:83], v[144:147], v[40:43]
    v_mfma_f32_16x16x32_bf16 v[44:47], v[80:83], v[208:211], v[44:47]
    s_waitcnt lgkmcnt(10)
    v_mfma_f32_16x16x32_bf16 v[40:43], v[84:87], v[148:151], v[40:43]
    v_mfma_f32_16x16x32_bf16 v[44:47], v[84:87], v[212:215], v[44:47]
    s_waitcnt lgkmcnt(9)
    v_mfma_f32_16x16x32_bf16 v[40:43], v[88:91], v[152:155], v[40:43]
    v_mfma_f32_16x16x32_bf16 v[44:47], v[88:91], v[216:219], v[44:47]
    s_waitcnt lgkmcnt(8)
    v_mfma_f32_16x16x32_bf16 v[40:43], v[92:95], v[156:159], v[40:43]
    v_mfma_f32_16x16x32_bf16 v[44:47], v[92:95], v[220:223], v[44:47]
    s_waitcnt lgkmcnt(7)
    v_mfma_f32_16x16x32_bf16 v[40:43], v[96:99], v[160:163], v[40:43]
    v_mfma_f32_16x16x32_bf16 v[44:47], v[96:99], v[224:227], v[44:47]
    s_waitcnt lgkmcnt(6)
    v_mfma_f32_16x16x32_bf16 v[40:43], v[100:103], v[164:167], v[40:43]
    v_mfma_f32_16x16x32_bf16 v[44:47], v[100:103], v[228:231], v[44:47]
    s_waitcnt lgkmcnt(5)
    v_mfma_f32_16x16x32_bf16 v[40:43], v[104:107], v[168:171], v[40:43]
    v_mfma_f32_16x16x32_bf16 v[44:47], v[104:107], v[232:235], v[44:47]
    s_waitcnt lgkmcnt(4)
    v_mfma_f32_16x16x32_bf16 v[40:43], v[108:111], v[172:175], v[40:43]
    v_mfma_f32_16x16x32_bf16 v[44:47], v[108:111], v[236:239], v[44:47]
    s_waitcnt lgkmcnt(3)
    v_mfma_f32_16x16x32_bf16 v[40:43], v[112:115], v[176:179], v[40:43]
    v_mfma_f32_16x16x32_bf16 v[44:47], v[112:115], v[240:243], v[44:47]
    s_waitcnt lgkmcnt(2)
    v_mfma_f32_16x16x32_bf16 v[40:43], v[116:119], v[180:183], v[40:43]
    v_mfma_f32_16x16x32_bf16 v[44:47], v[116:119], v[244:247], v[44:47]
    s_waitcnt lgkmcnt(1)
    v_mfma_f32_16x16x32_bf16 v[40:43], v[120:123], v[184:187], v[40:43]
    v_mfma_f32_16x16x32_bf16 v[44:47], v[120:123], v[248:251], v[44:47]
    s_waitcnt lgkmcnt(0)
    v_mfma_f32_16x16x32_bf16 v[40:43], v[124:127], v[188:191], v[40:43]
    v_mfma_f32_16x16x32_bf16 v[44:47], v[124:127], v[252:255], v[44:47]
    v_mfma_f32_16x16x32_bf16 v[24:27], a[0:3], v[64:67], 0
    v_mfma_f32_16x16x32_bf16 v[28:31], a[64:67], v[64:67], 0
    v_mfma_f32_16x16x32_bf16 v[32:35], a[128:131], v[64:67], 0
    v_mfma_f32_16x16x32_bf16 v[36:39], a[192:195], v[64:67], 0
    v_mfma_f32_16x16x32_bf16 v[24:27], a[4:7], v[68:71], v[24:27]
    v_mfma_f32_16x16x32_bf16 v[28:31], a[68:71], v[68:71], v[28:31]
    v_mfma_f32_16x16x32_bf16 v[32:35], a[132:135], v[68:71], v[32:35]
    v_mfma_f32_16x16x32_bf16 v[36:39], a[196:199], v[68:71], v[36:39]
    v_mfma_f32_16x16x32_bf16 v[24:27], a[8:11], v[72:75], v[24:27]
    v_mfma_f32_16x16x32_bf16 v[28:31], a[72:75], v[72:75], v[28:31]
    v_mfma_f32_16x16x32_bf16 v[32:35], a[136:139], v[72:75], v[32:35]
    v_mfma_f32_16x16x32_bf16 v[36:39], a[200:203], v[72:75], v[36:39]
    v_mfma_f32_16x16x32_bf16 v[24:27], a[12:15], v[76:79], v[24:27]
    v_mfma_f32_16x16x32_bf16 v[28:31], a[76:79], v[76:79], v[28:31]
    v_mfma_f32_16x16x32_bf16 v[32:35], a[140:143], v[76:79], v[32:35]
    v_mfma_f32_16x16x32_bf16 v[36:39], a[204:207], v[76:79], v[36:39]
    v_cvt_pk_bf16_f32 v40, v40, v41
    v_cvt_pk_bf16_f32 v41, v42, v43
    ds_write_b64 v9, v[40:41] offset:0
    buffer_store_dwordx2 v[40:41], v17, s[8:11], s24 offen offset:0
    v_cvt_pk_bf16_f32 v44, v44, v45
    v_cvt_pk_bf16_f32 v45, v46, v47
    ds_write_b64 v9, v[44:45] offset:256
    buffer_store_dwordx2 v[44:45], v17, s[8:11], s24 offen offset:256
    v_mfma_f32_16x16x32_bf16 v[24:27], a[16:19], v[80:83], v[24:27]
    v_mfma_f32_16x16x32_bf16 v[28:31], a[80:83], v[80:83], v[28:31]
    v_mfma_f32_16x16x32_bf16 v[32:35], a[144:147], v[80:83], v[32:35]
    v_mfma_f32_16x16x32_bf16 v[36:39], a[208:211], v[80:83], v[36:39]
    v_mfma_f32_16x16x32_bf16 v[24:27], a[20:23], v[84:87], v[24:27]
    v_mfma_f32_16x16x32_bf16 v[28:31], a[84:87], v[84:87], v[28:31]
    v_mfma_f32_16x16x32_bf16 v[32:35], a[148:151], v[84:87], v[32:35]
    v_mfma_f32_16x16x32_bf16 v[36:39], a[212:215], v[84:87], v[36:39]
    v_mfma_f32_16x16x32_bf16 v[24:27], a[24:27], v[88:91], v[24:27]
    v_mfma_f32_16x16x32_bf16 v[28:31], a[88:91], v[88:91], v[28:31]
    v_mfma_f32_16x16x32_bf16 v[32:35], a[152:155], v[88:91], v[32:35]
    v_mfma_f32_16x16x32_bf16 v[36:39], a[216:219], v[88:91], v[36:39]
    v_mfma_f32_16x16x32_bf16 v[24:27], a[28:31], v[92:95], v[24:27]
    v_mfma_f32_16x16x32_bf16 v[28:31], a[92:95], v[92:95], v[28:31]
    v_mfma_f32_16x16x32_bf16 v[32:35], a[156:159], v[92:95], v[32:35]
    v_mfma_f32_16x16x32_bf16 v[36:39], a[220:223], v[92:95], v[36:39]
    v_mfma_f32_16x16x32_bf16 v[24:27], a[32:35], v[96:99], v[24:27]
    v_mfma_f32_16x16x32_bf16 v[28:31], a[96:99], v[96:99], v[28:31]
    v_mfma_f32_16x16x32_bf16 v[32:35], a[160:163], v[96:99], v[32:35]
    v_mfma_f32_16x16x32_bf16 v[36:39], a[224:227], v[96:99], v[36:39]
    v_mfma_f32_16x16x32_bf16 v[24:27], a[36:39], v[100:103], v[24:27]
    v_mfma_f32_16x16x32_bf16 v[28:31], a[100:103], v[100:103], v[28:31]
    v_mfma_f32_16x16x32_bf16 v[32:35], a[164:167], v[100:103], v[32:35]
    v_mfma_f32_16x16x32_bf16 v[36:39], a[228:231], v[100:103], v[36:39]
    v_mfma_f32_16x16x32_bf16 v[24:27], a[40:43], v[104:107], v[24:27]
    v_mfma_f32_16x16x32_bf16 v[28:31], a[104:107], v[104:107], v[28:31]
    v_mfma_f32_16x16x32_bf16 v[32:35], a[168:171], v[104:107], v[32:35]
    v_mfma_f32_16x16x32_bf16 v[36:39], a[232:235], v[104:107], v[36:39]
    v_mfma_f32_16x16x32_bf16 v[24:27], a[44:47], v[108:111], v[24:27]
    v_mfma_f32_16x16x32_bf16 v[28:31], a[108:111], v[108:111], v[28:31]
    v_mfma_f32_16x16x32_bf16 v[32:35], a[172:175], v[108:111], v[32:35]
    v_mfma_f32_16x16x32_bf16 v[36:39], a[236:239], v[108:111], v[36:39]
    v_mfma_f32_16x16x32_bf16 v[24:27], a[48:51], v[112:115], v[24:27]
    v_mfma_f32_16x16x32_bf16 v[28:31], a[112:115], v[112:115], v[28:31]
    v_mfma_f32_16x16x32_bf16 v[32:35], a[176:179], v[112:115], v[32:35]
    v_mfma_f32_16x16x32_bf16 v[36:39], a[240:243], v[112:115], v[36:39]
    v_mfma_f32_16x16x32_bf16 v[24:27], a[52:55], v[116:119], v[24:27]
    v_mfma_f32_16x16x32_bf16 v[28:31], a[116:119], v[116:119], v[28:31]
    v_mfma_f32_16x16x32_bf16 v[32:35], a[180:183], v[116:119], v[32:35]
    v_mfma_f32_16x16x32_bf16 v[36:39], a[244:247], v[116:119], v[36:39]
    v_mfma_f32_16x16x32_bf16 v[24:27], a[56:59], v[120:123], v[24:27]
    v_mfma_f32_16x16x32_bf16 v[28:31], a[120:123], v[120:123], v[28:31]
    v_mfma_f32_16x16x32_bf16 v[32:35], a[184:187], v[120:123], v[32:35]
    v_mfma_f32_16x16x32_bf16 v[36:39], a[248:251], v[120:123], v[36:39]
    v_mfma_f32_16x16x32_bf16 v[24:27], a[60:63], v[124:127], v[24:27]
    v_mfma_f32_16x16x32_bf16 v[28:31], a[124:127], v[124:127], v[28:31]
    v_mfma_f32_16x16x32_bf16 v[32:35], a[188:191], v[124:127], v[32:35]
    v_mfma_f32_16x16x32_bf16 v[36:39], a[252:255], v[124:127], v[36:39]
    s_nop 7
    v_cvt_pk_bf16_f32 v24, v24, v25
    v_cvt_pk_bf16_f32 v25, v26, v27
    v_cvt_pk_bf16_f32 v28, v28, v29
    v_cvt_pk_bf16_f32 v29, v30, v31
    v_cvt_pk_bf16_f32 v32, v32, v33
    v_cvt_pk_bf16_f32 v33, v34, v35
    v_cvt_pk_bf16_f32 v36, v36, v37
    v_cvt_pk_bf16_f32 v37, v38, v39
    ds_write_b64 v8, v[24:25] offset:0
    ds_write_b64 v8, v[32:33] offset:2176
    buffer_store_dwordx2 v[32:33], v16, s[8:11], s23 offen offset:0
    ds_write_b64 v8, v[28:29] offset:32
    ds_write_b64 v8, v[36:37] offset:2208
    buffer_store_dwordx2 v[36:37], v16, s[8:11], s23 offen offset:32
    s_cmp_ge_u32 s17, 63
    s_cbranch_scc1 chain_kernel_done1
    s_waitcnt lgkmcnt(0)
    s_barrier
    ds_read_b128 v[64:67], v6 offset:0
    ds_read_b128 v[80:83], v6 offset:2176
    ds_read_b128 v[96:99], v7 offset:0
    ds_read_b128 v[112:115], v7 offset:4352
    ds_read_b128 v[68:71], v6 offset:64
    ds_read_b128 v[84:87], v6 offset:2240
    ds_read_b128 v[100:103], v7 offset:64
    ds_read_b128 v[116:119], v7 offset:4416
    ds_read_b128 v[72:75], v6 offset:128
    ds_read_b128 v[88:91], v6 offset:2304
    ds_read_b128 v[104:107], v7 offset:128
    ds_read_b128 v[120:123], v7 offset:4480
    ds_read_b128 v[76:79], v6 offset:192
    ds_read_b128 v[92:95], v6 offset:2368
    ds_read_b128 v[108:111], v7 offset:192
    ds_read_b128 v[124:127], v7 offset:4544
    s_waitcnt lgkmcnt(12)
    v_mfma_f32_16x16x32_bf16 v[24:27], v[80:83], v[64:67], 0
    v_mfma_f32_16x16x32_bf16 v[28:31], v[96:99], v[64:67], 0
    v_mfma_f32_16x16x32_bf16 v[32:35], v[112:115], v[64:67], 0
    s_waitcnt lgkmcnt(8)
    v_mfma_f32_16x16x32_bf16 v[24:27], v[84:87], v[68:71], v[24:27]
    v_mfma_f32_16x16x32_bf16 v[28:31], v[100:103], v[68:71], v[28:31]
    v_mfma_f32_16x16x32_bf16 v[32:35], v[116:119], v[68:71], v[32:35]
    s_waitcnt lgkmcnt(4)
    v_mfma_f32_16x16x32_bf16 v[24:27], v[88:91], v[72:75], v[24:27]
    v_mfma_f32_16x16x32_bf16 v[28:31], v[104:107], v[72:75], v[28:31]
    v_mfma_f32_16x16x32_bf16 v[32:35], v[120:123], v[72:75], v[32:35]
    s_waitcnt lgkmcnt(0)
    v_mfma_f32_16x16x32_bf16 v[24:27], v[92:95], v[76:79], v[24:27]
    v_mfma_f32_16x16x32_bf16 v[28:31], v[108:111], v[76:79], v[28:31]
    v_mfma_f32_16x16x32_bf16 v[32:35], v[124:127], v[76:79], v[32:35]
    ds_read_b64 v[64:65], v10 offset:0
    ds_read_b64 v[66:67], v18 offset:0
    ds_read_b64 v[68:69], v18 offset:32
    ds_read_b64 v[70:71], v10 offset:256
    ds_read_b64 v[72:73], v18 offset:1024
    ds_read_b64 v[74:75], v18 offset:1056
    ds_read_b64 v[76:77], v10 offset:512
    ds_read_b64 v[78:79], v18 offset:2048
    ds_read_b64 v[80:81], v18 offset:2080
    ds_read_b64 v[82:83], v10 offset:768
    ds_read_b64 v[84:85], v18 offset:3072
    ds_read_b64 v[86:87], v18 offset:3104
    ds_read_b64 v[88:89], v10 offset:1024
    ds_read_b64 v[90:91], v18 offset:4096
    ds_read_b64 v[92:93], v18 offset:4128
    ds_read_b64 v[94:95], v10 offset:1280
    ds_read_b64 v[96:97], v18 offset:5120
    ds_read_b64 v[98:99], v18 offset:5152
    ds_read_b64 v[100:101], v10 offset:1536
    ds_read_b64 v[102:103], v18 offset:6144
    ds_read_b64 v[104:105], v18 offset:6176
    ds_read_b64 v[106:107], v10 offset:1792
    ds_read_b64 v[108:109], v18 offset:7168
    ds_read_b64 v[110:111], v18 offset:7200
    v_mov_b32 v112, 0
    v_mov_b32 v113, 0
    v_mov_b32 v48, s31
    s_nop 1
    v_cndmask_b32 v24, v30, v24, s[26:27]
    v_cndmask_b32 v25, v31, v25, s[26:27]
    v_cndmask_b32 v26, v32, v26, s[26:27]
    v_cndmask_b32 v27, v33, v27, s[26:27]
    v_cndmask_b32 v28, v34, v28, s[26:27]
    v_cndmask_b32 v29, v35, v29, s[26:27]
    v_cvt_pk_bf16_f32 v50, v24, v25
    v_cvt_pk_bf16_f32 v51, v26, v27
    v_cvt_pk_bf16_f32 v52, v28, v29
    v_lshlrev_b32 v24, 16, v50
    v_and_b32 v25, s59, v50
    v_lshlrev_b32 v26, 16, v51
    v_and_b32 v27, s59, v51
    v_lshlrev_b32 v28, 16, v52
    v_and_b32 v29, s59, v52
    v_mul_f32 v24, s30, v24
    v_mul_f32 v25, s30, v25
    v_mul_f32 v26, s30, v26
    v_mul_f32 v27, s30, v27
    v_mul_f32 v28, s30, v28
    v_mul_f32 v29, s30, v29
    v_cvt_pk_bf16_f32 v50, v24, v25
    v_cvt_pk_bf16_f32 v51, v26, v27
    v_cvt_pk_bf16_f32 v52, v28, v29
    v_lshlrev_b32 v24, 16, v50
    v_and_b32 v25, s59, v50
    v_lshlrev_b32 v26, 16, v51
    v_and_b32 v27, s59, v51
    v_lshlrev_b32 v28, 16, v52
    v_and_b32 v29, s59, v52
    v_cndmask_b32 v24, v24, v48, s[42:43]
    v_cndmask_b32 v25, v25, v48, s[42:43]
    v_cndmask_b32 v26, v26, v48, s[42:43]
    v_cndmask_b32 v27, v27, v48, s[42:43]
    v_max3_f32 v48, v24, v25, v26
    v_max3_f32 v49, v27, v28, v29
    v_max_f32 v48, v48, v49
    s_nop 1
    v_max_f32_dpp v48, v48, v48 row_ror:8 row_mask:0xf bank_mask:0xf
    v_mov_b32 v49, v48
    s_nop 1
    v_permlane16_swap_b32 v48, v49
    s_nop 1
    v_max_f32 v48, v48, v49
    v_mov_b32 v49, v48
    s_nop 1
    v_permlane32_swap_b32 v48, v49
    s_nop 1
    v_max_f32 v48, v48, v49
    v_mul_f32 v48, s32, v48
    v_fma_f32 v24, v24, s32, -v48
    v_fma_f32 v25, v25, s32, -v48
    v_fma_f32 v26, v26, s32, -v48
    v_fma_f32 v27, v27, s32, -v48
    v_fma_f32 v28, v28, s32, -v48
    v_fma_f32 v29, v29, s32, -v48
    v_exp_f32 v24, v24
    v_exp_f32 v25, v25
    v_exp_f32 v26, v26
    v_exp_f32 v27, v27
    v_exp_f32 v28, v28
    v_exp_f32 v29, v29
    s_nop 0
    v_add_f32 v48, v24, v25
    v_add_f32 v49, v26, v27
    v_add_f32 v50, v28, v29
    v_add_f32 v48, v48, v49
    v_add_f32 v48, v48, v50
    s_nop 1
    v_add_f32_dpp v48, v48, v48 row_ror:8 row_mask:0xf bank_mask:0xf
    v_mov_b32 v49, v48
    s_nop 1
    v_permlane16_swap_b32 v48, v49
    s_nop 1
    v_add_f32 v48, v48, v49
    v_mov_b32 v49, v48
    s_nop 1
    v_permlane32_swap_b32 v48, v49
    s_nop 1
    v_add_f32 v48, v48, v49
    v_rcp_f32 v48, v48
    s_nop 0
    v_mul_f32 v24, v24, v48
    v_mul_f32 v25, v25, v48
    v_mul_f32 v26, v26, v48
    v_mul_f32 v27, v27, v48
    v_mul_f32 v28, v28, v48
    v_mul_f32 v29, v29, v48
    v_cvt_pk_bf16_f32 v36, v24, v25
    v_cvt_pk_bf16_f32 v37, v26, v27
    v_cvt_pk_bf16_f32 v38, v28, v29
    s_nop 1
    v_mov_b32_dpp v39, v36 row_ror:8 row_mask:0xf bank_mask:0xf
    v_mov_b32_dpp v40, v37 row_ror:8 row_mask:0xf bank_mask:0xf
    v_mov_b32_dpp v41, v38 row_ror:8 row_mask:0xf bank_mask:0xf
    v_mov_b32 v42, 0
    v_mov_b32 v43, 0
    s_waitcnt lgkmcnt(0)
    s_nop 1
    v_mfma_f32_16x16x32_bf16 v[24:27], v[64:67], v[36:39], 0
    v_mfma_f32_16x16x32_bf16 v[28:31], v[70:73], v[36:39], 0
    v_mfma_f32_16x16x32_bf16 v[32:35], v[76:79], v[36:39], 0
    v_mfma_f32_16x16x32_bf16 v[48:51], v[82:85], v[36:39], 0
    v_mfma_f32_16x16x32_bf16 v[52:55], v[88:91], v[36:39], 0
    v_mfma_f32_16x16x32_bf16 v[56:59], v[94:97], v[36:39], 0
    v_mfma_f32_16x16x32_bf16 v[60:63], v[100:103], v[36:39], 0
    v_mfma_f32_16x16x32_bf16 v[116:119], v[106:109], v[36:39], 0
    v_mfma_f32_16x16x32_bf16 v[24:27], v[68:71], v[40:43], v[24:27]
    v_mfma_f32_16x16x32_bf16 v[28:31], v[74:77], v[40:43], v[28:31]
    v_mfma_f32_16x16x32_bf16 v[32:35], v[80:83], v[40:43], v[32:35]
    v_mfma_f32_16x16x32_bf16 v[48:51], v[86:89], v[40:43], v[48:51]
    v_mfma_f32_16x16x32_bf16 v[52:55], v[92:95], v[40:43], v[52:55]
    v_mfma_f32_16x16x32_bf16 v[56:59], v[98:101], v[40:43], v[56:59]
    v_mfma_f32_16x16x32_bf16 v[60:63], v[104:107], v[40:43], v[60:63]
    v_mfma_f32_16x16x32_bf16 v[116:119], v[110:113], v[40:43], v[116:119]
    ds_read_b128 v[80:83], v11 offset:0
    ds_read_b128 v[84:87], v11 offset:8192
    ds_read_b128 v[88:91], v11 offset:16384
    ds_read_b128 v[92:95], v11 offset:24576
    ds_read_b128 v[96:99], v11 offset:32768
    ds_read_b128 v[100:103], v11 offset:40960
    ds_read_b128 v[104:107], v11 offset:49152
    ds_read_b128 v[108:111], v11 offset:57344
    ds_read_b128 v[112:115], v12 offset:0
    s_nop 3
    v_cvt_pk_bf16_f32 v64, v24, v25
    v_cvt_pk_bf16_f32 v65, v26, v27
    v_cvt_pk_bf16_f32 v66, v28, v29
    v_cvt_pk_bf16_f32 v67, v30, v31
    v_cvt_pk_bf16_f32 v68, v32, v33
    v_cvt_pk_bf16_f32 v69, v34, v35
    v_cvt_pk_bf16_f32 v70, v48, v49
    v_cvt_pk_bf16_f32 v71, v50, v51
    v_cvt_pk_bf16_f32 v72, v52, v53
    v_cvt_pk_bf16_f32 v73, v54, v55
    v_cvt_pk_bf16_f32 v74, v56, v57
    v_cvt_pk_bf16_f32 v75, v58, v59
    v_cvt_pk_bf16_f32 v76, v60, v61
    v_cvt_pk_bf16_f32 v77, v62, v63
    v_cvt_pk_bf16_f32 v78, v116, v117
    v_cvt_pk_bf16_f32 v79, v118, v119
    s_add_u32 s22, s17, 1
    s_add_u32 s25, s22, s57
    s_and_b32 s23, s25, 3
    s_cmp_lg_u32 s23, 0
    s_cbranch_scc1 chain_kernel_nf16
    s_cmp_ge_u32 s25, 64
    s_cbranch_scc1 chain_kernel_nf16
    s_lshr_b32 s23, s25, 2
    s_lshl_b32 s23, s23, 8
    s_lshl_b32 s24, s16, 2
    s_add_u32 s23, s23, s24
    s_add_u32 s23, s23, 105906176
    v_mov_b32 v44, 0
chain_kernel_pf17:
    buffer_load_dword v45, v44, s[8:11], s23 offen sc1
    buffer_load_dword v46, v44, s[8:11], s23 offen offset:128 sc1
    s_waitcnt vmcnt(0)
    v_and_b32 v45, v45, v46
    s_nop 0
    v_readfirstlane_b32 s24, v45
    s_add_u32 s60, s60, 1
    s_cmp_gt_u32 s60, 0x400000
    s_cbranch_scc1 chain_kernel_done1
    s_cmp_eq_u32 s24, 0
    s_cbranch_scc1 chain_kernel_pf17
chain_kernel_nf16:
    s_lshl_b32 s23, s22, 18
    s_add_u32 s23, s23, 20971520
    s_add_u32 s24, s23, 131072
    s_lshl_b32 s25, s22, 5
    s_add_u32 s25, s25, s16
    s_lshl_b32 s25, s25, 13
    s_add_u32 s25, s25, 37748736
    buffer_load_dwordx4 v[40:43], v13, s[8:11], s23 offen
    buffer_load_dwordx4 v[44:47], v13, s[8:11], s24 offen
    buffer_load_dwordx4 v[120:123], v15, s[8:11], s25 offen
    s_add_u32 s25, s25, 4096
    buffer_load_dwordx4 v[124:127], v15, s[8:11], s25 offen
    s_waitcnt lgkmcnt(8)
    v_mfma_f32_16x16x32_bf16 v[24:27], v[80:83], v[64:67], 0
    ds_read_b128 v[80:83], v12 offset:8192
    s_waitcnt lgkmcnt(8)
    v_mfma_f32_16x16x32_bf16 v[24:27], v[84:87], v[68:71], v[24:27]
    ds_read_b128 v[84:87], v12 offset:16384
    s_waitcnt lgkmcnt(8)
    v_mfma_f32_16x16x32_bf16 v[24:27], v[88:91], v[72:75], v[24:27]
    ds_read_b128 v[88:91], v12 offset:24576
    s_waitcnt lgkmcnt(8)
    v_mfma_f32_16x16x32_bf16 v[24:27], v[92:95], v[76:79], v[24:27]
    ds_read_b128 v[92:95], v12 offset:32768
    s_waitcnt lgkmcnt(8)
    v_mfma_f32_16x16x32_bf16 v[28:31], v[96:99], v[64:67], 0
    ds_read_b128 v[96:99], v12 offset:40960
    s_waitcnt lgkmcnt(8)
    v_mfma_f32_16x16x32_bf16 v[28:31], v[100:103], v[68:71], v[28:31]
    ds_read_b128 v[100:103], v12 offset:49152
    s_waitcnt lgkmcnt(8)
    v_mfma_f32_16x16x32_bf16 v[28:31], v[104:107], v[72:75], v[28:31]
    ds_read_b128 v[104:107], v12 offset:57344
    s_waitcnt lgkmcnt(8)
    v_mfma_f32_16x16x32_bf16 v[28:31], v[108:111], v[76:79], v[28:31]
    ds_read_b128 v[108:111], v11 offset:128
    s_waitcnt lgkmcnt(8)
    v_mfma_f32_16x16x32_bf16 v[32:35], v[112:115], v[64:67], 0
    ds_read_b128 v[112:115], v11 offset:8320
    s_waitcnt lgkmcnt(8)
    v_mfma_f32_16x16x32_bf16 v[32:35], v[80:83], v[68:71], v[32:35]
    ds_read_b128 v[80:83], v11 offset:16512
    s_waitcnt lgkmcnt(8)
    v_mfma_f32_16x16x32_bf16 v[32:35], v[84:87], v[72:75], v[32:35]
    ds_read_b128 v[84:87], v11 offset:24704
    s_waitcnt lgkmcnt(8)
    v_mfma_f32_16x16x32_bf16 v[32:35], v[88:91], v[76:79], v[32:35]
    ds_read_b128 v[88:91], v11 offset:32896
    s_waitcnt lgkmcnt(8)
    v_mfma_f32_16x16x32_bf16 v[36:39], v[92:95], v[64:67], 0
    ds_read_b128 v[92:95], v11 offset:41088
    s_waitcnt lgkmcnt(8)
    v_mfma_f32_16x16x32_bf16 v[36:39], v[96:99], v[68:71], v[36:39]
    ds_read_b128 v[96:99], v11 offset:49280
    s_waitcnt lgkmcnt(8)
    v_mfma_f32_16x16x32_bf16 v[36:39], v[100:103], v[72:75], v[36:39]
    ds_read_b128 v[100:103], v11 offset:57472
    s_waitcnt lgkmcnt(8)
    v_mfma_f32_16x16x32_bf16 v[36:39], v[104:107], v[76:79], v[36:39]
    ds_read_b128 v[104:107], v12 offset:128
    v_mov_b32_dpp v24, v28 row_shr:8 row_mask:0xf bank_mask:0xc
    v_mov_b32_dpp v25, v29 row_shr:8 row_mask:0xf bank_mask:0xc
    v_mov_b32_dpp v26, v30 row_shr:8 row_mask:0xf bank_mask:0xc
    v_mov_b32_dpp v27, v31 row_shr:8 row_mask:0xf bank_mask:0xc
    v_and_or_b32 v24, v24, -2, s19
    v_and_or_b32 v25, v25, -2, s19
    v_and_or_b32 v26, v26, -2, s19
    v_and_or_b32 v27, v27, -2, s19
    v_add_u32 v116, 0, v19
    buffer_store_dwordx4 v[24:27], v116, s[8:11], s34 offen
    s_waitcnt lgkmcnt(8)
    v_mfma_f32_16x16x32_bf16 v[48:51], v[108:111], v[64:67], 0
    ds_read_b128 v[108:111], v12 offset:8320
    s_waitcnt lgkmcnt(8)
    v_mfma_f32_16x16x32_bf16 v[48:51], v[112:115], v[68:71], v[48:51]
    ds_read_b128 v[112:115], v12 offset:16512
    s_waitcnt lgkmcnt(8)
    v_mfma_f32_16x16x32_bf16 v[48:51], v[80:83], v[72:75], v[48:51]
    ds_read_b128 v[80:83], v12 offset:24704
    s_waitcnt lgkmcnt(8)
    v_mfma_f32_16x16x32_bf16 v[48:51], v[84:87], v[76:79], v[48:51]
    ds_read_b128 v[84:87], v12 offset:32896
    s_waitcnt lgkmcnt(8)
    v_mfma_f32_16x16x32_bf16 v[52:55], v[88:91], v[64:67], 0
    ds_read_b128 v[88:91], v12 offset:41088
    s_waitcnt lgkmcnt(8)
    v_mfma_f32_16x16x32_bf16 v[52:55], v[92:95], v[68:71], v[52:55]
    ds_read_b128 v[92:95], v12 offset:49280
    s_waitcnt lgkmcnt(8)
    v_mfma_f32_16x16x32_bf16 v[52:55], v[96:99], v[72:75], v[52:55]
    ds_read_b128 v[96:99], v12 offset:57472
    s_waitcnt lgkmcnt(8)
    v_mfma_f32_16x16x32_bf16 v[52:55], v[100:103], v[76:79], v[52:55]
    v_mov_b32_dpp v32, v36 row_shr:8 row_mask:0xf bank_mask:0xc
    v_mov_b32_dpp v33, v37 row_shr:8 row_mask:0xf bank_mask:0xc
    v_mov_b32_dpp v34, v38 row_shr:8 row_mask:0xf bank_mask:0xc
    v_mov_b32_dpp v35, v39 row_shr:8 row_mask:0xf bank_mask:0xc
    v_and_or_b32 v32, v32, -2, s19
    v_and_or_b32 v33, v33, -2, s19
    v_and_or_b32 v34, v34, -2, s19
    v_and_or_b32 v35, v35, -2, s19
    v_add_u32 v116, 32768, v19
    buffer_store_dwordx4 v[32:35], v116, s[8:11], s34 offen
    s_waitcnt lgkmcnt(7)
    v_mfma_f32_16x16x32_bf16 v[56:59], v[104:107], v[64:67], 0
    s_waitcnt lgkmcnt(6)
    v_mfma_f32_16x16x32_bf16 v[56:59], v[108:111], v[68:71], v[56:59]
    s_waitcnt lgkmcnt(5)
    v_mfma_f32_16x16x32_bf16 v[56:59], v[112:115], v[72:75], v[56:59]
    s_waitcnt lgkmcnt(4)
    v_mfma_f32_16x16x32_bf16 v[56:59], v[80:83], v[76:79], v[56:59]
    s_waitcnt lgkmcnt(3)
    v_mfma_f32_16x16x32_bf16 v[60:63], v[84:87], v[64:67], 0
    s_waitcnt lgkmcnt(2)
    v_mfma_f32_16x16x32_bf16 v[60:63], v[88:91], v[68:71], v[60:63]
    s_waitcnt lgkmcnt(1)
    v_mfma_f32_16x16x32_bf16 v[60:63], v[92:95], v[72:75], v[60:63]
    s_waitcnt lgkmcnt(0)
    v_mfma_f32_16x16x32_bf16 v[60:63], v[96:99], v[76:79], v[60:63]
    v_mov_b32_dpp v48, v52 row_shr:8 row_mask:0xf bank_mask:0xc
    v_mov_b32_dpp v49, v53 row_shr:8 row_mask:0xf bank_mask:0xc
    v_mov_b32_dpp v50, v54 row_shr:8 row_mask:0xf bank_mask:0xc
    v_mov_b32_dpp v51, v55 row_shr:8 row_mask:0xf bank_mask:0xc
    v_and_or_b32 v48, v48, -2, s19
    v_and_or_b32 v49, v49, -2, s19
    v_and_or_b32 v50, v50, -2, s19
    v_and_or_b32 v51, v51, -2, s19
    v_add_u32 v116, 65536, v19
    buffer_store_dwordx4 v[48:51], v116, s[8:11], s34 offen
    s_nop 7
    v_mov_b32_dpp v56, v60 row_shr:8 row_mask:0xf bank_mask:0xc
    v_mov_b32_dpp v57, v61 row_shr:8 row_mask:0xf bank_mask:0xc
    v_mov_b32_dpp v58, v62 row_shr:8 row_mask:0xf bank_mask:0xc
    v_mov_b32_dpp v59, v63 row_shr:8 row_mask:0xf bank_mask:0xc
    v_and_or_b32 v56, v56, -2, s19
    v_and_or_b32 v57, v57, -2, s19
    v_and_or_b32 v58, v58, -2, s19
    v_and_or_b32 v59, v59, -2, s19
    v_add_u32 v116, 98304, v19
    buffer_store_dwordx4 v[56:59], v116, s[8:11], s34 offen
    buffer_load_dwordx4 v[64:67], v20, s[8:11], s34 offen offset:0 sc1
    buffer_load_dwordx4 v[68:71], v20, s[8:11], s34 offen offset:512 sc1
    buffer_load_dwordx4 v[72:75], v20, s[8:11], s34 offen offset:1024 sc1
    buffer_load_dwordx4 v[76:79], v20, s[8:11], s34 offen offset:1536 sc1
    s_waitcnt vmcnt(0)
    v_or3_b32 v48, v64, v65, v66
    v_or3_b32 v49, v67, v68, v69
    v_or3_b32 v48, v48, v70, v71
    v_or3_b32 v49, v49, v72, v73
    v_or3_b32 v48, v48, v74, v75
    v_or3_b32 v49, v49, v76, v77
    v_or3_b32 v48, v48, v78, v79
    v_or_b32 v48, v48, v49
    v_and_b32 v50, v64, v65
    v_and_b32 v51, v66, v67
    v_and_b32 v50, v50, v68
    v_and_b32 v51, v51, v69
    v_and_b32 v50, v50, v70
    v_and_b32 v51, v51, v71
    v_and_b32 v50, v50, v72
    v_and_b32 v51, v51, v73
    v_and_b32 v50, v50, v74
    v_and_b32 v51, v51, v75
    v_and_b32 v50, v50, v76
    v_and_b32 v51, v51, v77
    v_and_b32 v50, v50, v78
    v_and_b32 v51, v51, v79
    v_and_b32 v50, v50, v51
    v_xor_b32 v48, s19, v48
    v_xor_b32 v50, s19, v50
    v_or_b32 v48, v48, v50
    v_and_b32 v48, 1, v48
    v_cmp_ne_u32 vcc, 0, v48
    s_mov_b64 exec, vcc
    s_cbranch_execz chain_kernel_ok119
    s_add_u32 s60, s60, 1
    s_cmp_gt_u32 s60, 0x200000
    s_cbranch_scc1 chain_kernel_done1
chain_kernel_poll118:
    buffer_load_dwordx4 v[64:67], v20, s[8:11], s34 offen offset:0 sc1
    buffer_load_dwordx4 v[68:71], v20, s[8:11], s34 offen offset:512 sc1
    buffer_load_dwordx4 v[72:75], v20, s[8:11], s34 offen offset:1024 sc1
    buffer_load_dwordx4 v[76:79], v20, s[8:11], s34 offen offset:1536 sc1
    s_waitcnt vmcnt(0)
    v_or3_b32 v48, v64, v65, v66
    v_or3_b32 v49, v67, v68, v69
    v_or3_b32 v48, v48, v70, v71
    v_or3_b32 v49, v49, v72, v73
    v_or3_b32 v48, v48, v74, v75
    v_or3_b32 v49, v49, v76, v77
    v_or3_b32 v48, v48, v78, v79
    v_or_b32 v48, v48, v49
    v_and_b32 v50, v64, v65
    v_and_b32 v51, v66, v67
    v_and_b32 v50, v50, v68
    v_and_b32 v51, v51, v69
    v_and_b32 v50, v50, v70
    v_and_b32 v51, v51, v71
    v_and_b32 v50, v50, v72
    v_and_b32 v51, v51, v73
    v_and_b32 v50, v50, v74
    v_and_b32 v51, v51, v75
    v_and_b32 v50, v50, v76
    v_and_b32 v51, v51, v77
    v_and_b32 v50, v50, v78
    v_and_b32 v51, v51, v79
    v_and_b32 v50, v50, v51
    v_xor_b32 v48, s19, v48
    v_xor_b32 v50, s19, v50
    v_or_b32 v48, v48, v50
    v_and_b32 v48, 1, v48
    v_cmp_ne_u32 vcc, 0, v48
    s_mov_b64 exec, vcc
    s_cbranch_execz chain_kernel_ok119
    s_add_u32 s60, s60, 1
    s_cmp_gt_u32 s60, 0x200000
    s_cbranch_scc1 chain_kernel_done1
    s_branch chain_kernel_poll118
chain_kernel_ok119:
    s_mov_b64 exec, -1
    v_add_f32 v64, v64, v68
    v_add_f32 v72, v72, v76
    v_add_f32 v65, v65, v69
    v_add_f32 v73, v73, v77
    v_add_f32 v66, v66, v70
    v_add_f32 v74, v74, v78
    v_add_f32 v67, v67, v71
    v_add_f32 v75, v75, v79
    v_add_f32 v64, v64, v72
    v_add_f32 v65, v65, v73
    v_add_f32 v66, v66, v74
    v_add_f32 v67, v67, v75
    s_nop 1
    v_add_f32_dpp v68, v64, v64 row_ror:8 row_mask:0xf bank_mask:0xf
    v_add_f32_dpp v69, v65, v65 row_ror:8 row_mask:0xf bank_mask:0xf
    v_add_f32_dpp v70, v66, v66 row_ror:8 row_mask:0xf bank_mask:0xf
    v_add_f32_dpp v71, v67, v67 row_ror:8 row_mask:0xf bank_mask:0xf
    v_mov_b32 v72, v68
    v_mov_b32 v73, v69
    v_mov_b32 v74, v70
    v_mov_b32 v75, v71
    s_nop 1
    v_permlane16_swap_b32 v68, v72
    v_permlane16_swap_b32 v69, v73
    v_permlane16_swap_b32 v70, v74
    v_permlane16_swap_b32 v71, v75
    s_nop 1
    v_add_f32 v68, v68, v72
    v_add_f32 v69, v69, v73
    v_add_f32 v70, v70, v74
    v_add_f32 v71, v71, v75
    v_mov_b32 v72, v68
    v_mov_b32 v73, v69
    v_mov_b32 v74, v70
    v_mov_b32 v75, v71
    s_nop 1
    v_permlane32_swap_b32 v68, v72
    v_permlane32_swap_b32 v69, v73
    v_permlane32_swap_b32 v70, v74
    v_permlane32_swap_b32 v71, v75
    s_nop 1
    v_add_f32 v68, v68, v72
    v_add_f32 v69, v69, v73
    v_add_f32 v70, v70, v74
    v_add_f32 v71, v71, v75
    v_cvt_pk_bf16_f32 v64, v68, v69
    v_cvt_pk_bf16_f32 v65, v70, v71
    buffer_store_dwordx2 v[64:65], v22, s[8:11], s36 offen
    v_mov_b32 v66, -1
    v_mov_b32 v67, -1
    buffer_store_dwordx2 v[66:67], v22, s[8:11], s35 offen
    s_add_u32 s17, s17, 1
    s_branch chain_kernel_step13
chain_kernel_slowloop12:
chain_kernel_step20:
    s_lshl_b32 s22, s17, 5
    s_add_u32 s22, s22, s16
    s_lshl_b32 s22, s22, 11
    s_add_u32 s23, s22, 83886080
    s_add_u32 s24, s22, 88080384
    s_and_b32 s33, s17, 1
    s_lshl_b32 s34, s33, 19
    s_add_u32 s34, s34, 117440512
    s_lshl_b32 s35, s33, 18
    s_add_u32 s35, s35, 104857600
    s_xor_b32 s36, s35, 0x40000
    s_add_u32 s37, s35, 4096
    s_lshr_b32 s19, s17, 1
    s_and_b32 s19, s19, 1
    s_add_u32 s40, s17, 1
    s_lshl_b32 s40, s40, 18
    s_add_u32 s40, s40, 20971520
chain_kernel_pm21:
    buffer_load_dwordx4 v[64:67], v15, s[8:11], s35 offen sc1
    buffer_load_dwordx4 v[68:71], v15, s[8:11], s37 offen sc1
    s_waitcnt vmcnt(0)
    v_max3_u32 v24, v64, v65, v66
    v_max3_u32 v25, v67, v68, v69
    v_max3_u32 v24, v24, v70, v71
    v_max_u32 v24, v24, v25
    v_cmp_eq_u32 vcc, -1, v24
    s_mov_b64 exec, vcc
    s_cbranch_execz chain_kernel_okm22
    s_add_u32 s60, s60, 1
    s_cmp_gt_u32 s60, 0x200000
    s_cbranch_scc1 chain_kernel_done1
    s_branch chain_kernel_pm21
chain_kernel_okm22:
    s_mov_b64 exec, -1
    ds_write_b128 v23, v[64:67]
    ds_write_b128 v23, v[68:71] offset:4160
    s_waitcnt lgkmcnt(0)
    s_barrier
    ds_write_b128 v14, v[40:43]
    ds_write_b128 v14, v[44:47] offset:4352
    v_add_u32 v52, 154496, v15
    ds_write_b128 v52, v[120:123]
    ds_write_b128 v52, v[124:127] offset:4096
    buffer_load_dword v0, v21, s[8:11], s40 offen
    ds_read_b128 v[64:67], v5 offset:0
    ds_read_b128 v[68:71], v5 offset:64
    ds_read_b128 v[72:75], v5 offset:128
    ds_read_b128 v[76:79], v5 offset:192
    ds_read_b128 v[80:83], v5 offset:256
    ds_read_b128 v[84:87], v5 offset:320
    ds_read_b128 v[88:91], v5 offset:384
    ds_read_b128 v[92:95], v5 offset:448
    ds_read_b128 v[96:99], v5 offset:512
    ds_read_b128 v[100:103], v5 offset:576
    ds_read_b128 v[104:107], v5 offset:640
    ds_read_b128 v[108:111], v5 offset:704
    ds_read_b128 v[112:115], v5 offset:768
    ds_read_b128 v[116:119], v5 offset:832
    ds_read_b128 v[120:123], v5 offset:896
    ds_read_b128 v[124:127], v5 offset:960
    s_waitcnt lgkmcnt(15)
    v_mfma_f32_16x16x32_bf16 v[40:43], v[64:67], v[128:131], 0
    v_mfma_f32_16x16x32_bf16 v[44:47], v[64:67], v[192:195], 0
    s_waitcnt lgkmcnt(14)
    v_mfma_f32_16x16x32_bf16 v[40:43], v[68:71], v[132:135], v[40:43]
    v_mfma_f32_16x16x32_bf16 v[44:47], v[68:71], v[196:199], v[44:47]
    s_waitcnt lgkmcnt(13)
    v_mfma_f32_16x16x32_bf16 v[40:43], v[72:75], v[136:139], v[40:43]
    v_mfma_f32_16x16x32_bf16 v[44:47], v[72:75], v[200:203], v[44:47]
    s_waitcnt lgkmcnt(12)
    v_mfma_f32_16x16x32_bf16 v[40:43], v[76:79], v[140:143], v[40:43]
    v_mfma_f32_16x16x32_bf16 v[44:47], v[76:79], v[204:207], v[44:47]
    s_waitcnt lgkmcnt(11)
    v_mfma_f32_16x16x32_bf16 v[40:43], v[80:83], v[144:147], v[40:43]
    v_mfma_f32_16x16x32_bf16 v[44:47], v[80:83], v[208:211], v[44:47]
    s_waitcnt lgkmcnt(10)
    v_mfma_f32_16x16x32_bf16 v[40:43], v[84:87], v[148:151], v[40:43]
    v_mfma_f32_16x16x32_bf16 v[44:47], v[84:87], v[212:215], v[44:47]
    s_waitcnt lgkmcnt(9)
    v_mfma_f32_16x16x32_bf16 v[40:43], v[88:91], v[152:155], v[40:43]
    v_mfma_f32_16x16x32_bf16 v[44:47], v[88:91], v[216:219], v[44:47]
    s_waitcnt lgkmcnt(8)
    v_mfma_f32_16x16x32_bf16 v[40:43], v[92:95], v[156:159], v[40:43]
    v_mfma_f32_16x16x32_bf16 v[44:47], v[92:95], v[220:223], v[44:47]
    s_waitcnt lgkmcnt(7)
    v_mfma_f32_16x16x32_bf16 v[40:43], v[96:99], v[160:163], v[40:43]
    v_mfma_f32_16x16x32_bf16 v[44:47], v[96:99], v[224:227], v[44:47]
    s_waitcnt lgkmcnt(6)
    v_mfma_f32_16x16x32_bf16 v[40:43], v[100:103], v[164:167], v[40:43]
    v_mfma_f32_16x16x32_bf16 v[44:47], v[100:103], v[228:231], v[44:47]
    s_waitcnt lgkmcnt(5)
    v_mfma_f32_16x16x32_bf16 v[40:43], v[104:107], v[168:171], v[40:43]
    v_mfma_f32_16x16x32_bf16 v[44:47], v[104:107], v[232:235], v[44:47]
    s_waitcnt lgkmcnt(4)
    v_mfma_f32_16x16x32_bf16 v[40:43], v[108:111], v[172:175], v[40:43]
    v_mfma_f32_16x16x32_bf16 v[44:47], v[108:111], v[236:239], v[44:47]
    s_waitcnt lgkmcnt(3)
    v_mfma_f32_16x16x32_bf16 v[40:43], v[112:115], v[176:179], v[40:43]
    v_mfma_f32_16x16x32_bf16 v[44:47], v[112:115], v[240:243], v[44:47]
    s_waitcnt lgkmcnt(2)
    v_mfma_f32_16x16x32_bf16 v[40:43], v[116:119], v[180:183], v[40:43]
    v_mfma_f32_16x16x32_bf16 v[44:47], v[116:119], v[244:247], v[44:47]
    s_waitcnt lgkmcnt(1)
    v_mfma_f32_16x16x32_bf16 v[40:43], v[120:123], v[184:187], v[40:43]
    v_mfma_f32_16x16x32_bf16 v[44:47], v[120:123], v[248:251], v[44:47]
    s_waitcnt lgkmcnt(0)
    v_mfma_f32_16x16x32_bf16 v[40:43], v[124:127], v[188:191], v[40:43]
    v_mfma_f32_16x16x32_bf16 v[44:47], v[124:127], v[252:255], v[44:47]
    v_mfma_f32_16x16x32_bf16 v[24:27], a[0:3], v[64:67], 0
    v_mfma_f32_16x16x32_bf16 v[28:31], a[64:67], v[64:67], 0
    v_mfma_f32_16x16x32_bf16 v[32:35], a[128:131], v[64:67], 0
    v_mfma_f32_16x16x32_bf16 v[36:39], a[192:195], v[64:67], 0
    v_mfma_f32_16x16x32_bf16 v[24:27], a[4:7], v[68:71], v[24:27]
    v_mfma_f32_16x16x32_bf16 v[28:31], a[68:71], v[68:71], v[28:31]
    v_mfma_f32_16x16x32_bf16 v[32:35], a[132:135], v[68:71], v[32:35]
    v_mfma_f32_16x16x32_bf16 v[36:39], a[196:199], v[68:71], v[36:39]
    v_mfma_f32_16x16x32_bf16 v[24:27], a[8:11], v[72:75], v[24:27]
    v_mfma_f32_16x16x32_bf16 v[28:31], a[72:75], v[72:75], v[28:31]
    v_mfma_f32_16x16x32_bf16 v[32:35], a[136:139], v[72:75], v[32:35]
    v_mfma_f32_16x16x32_bf16 v[36:39], a[200:203], v[72:75], v[36:39]
    v_mfma_f32_16x16x32_bf16 v[24:27], a[12:15], v[76:79], v[24:27]
    v_mfma_f32_16x16x32_bf16 v[28:31], a[76:79], v[76:79], v[28:31]
    v_mfma_f32_16x16x32_bf16 v[32:35], a[140:143], v[76:79], v[32:35]
    v_mfma_f32_16x16x32_bf16 v[36:39], a[204:207], v[76:79], v[36:39]
    v_cvt_pk_bf16_f32 v40, v40, v41
    v_cvt_pk_bf16_f32 v41, v42, v43
    ds_write_b64 v9, v[40:41] offset:0
    buffer_store_dwordx2 v[40:41], v17, s[8:11], s24 offen offset:0
    v_cvt_pk_bf16_f32 v44, v44, v45
    v_cvt_pk_bf16_f32 v45, v46, v47
    ds_write_b64 v9, v[44:45] offset:256
    buffer_store_dwordx2 v[44:45], v17, s[8:11], s24 offen offset:256
    v_mfma_f32_16x16x32_bf16 v[24:27], a[16:19], v[80:83], v[24:27]
    v_mfma_f32_16x16x32_bf16 v[28:31], a[80:83], v[80:83], v[28:31]
    v_mfma_f32_16x16x32_bf16 v[32:35], a[144:147], v[80:83], v[32:35]
    v_mfma_f32_16x16x32_bf16 v[36:39], a[208:211], v[80:83], v[36:39]
    v_mfma_f32_16x16x32_bf16 v[24:27], a[20:23], v[84:87], v[24:27]
    v_mfma_f32_16x16x32_bf16 v[28:31], a[84:87], v[84:87], v[28:31]
    v_mfma_f32_16x16x32_bf16 v[32:35], a[148:151], v[84:87], v[32:35]
    v_mfma_f32_16x16x32_bf16 v[36:39], a[212:215], v[84:87], v[36:39]
    v_mfma_f32_16x16x32_bf16 v[24:27], a[24:27], v[88:91], v[24:27]
    v_mfma_f32_16x16x32_bf16 v[28:31], a[88:91], v[88:91], v[28:31]
    v_mfma_f32_16x16x32_bf16 v[32:35], a[152:155], v[88:91], v[32:35]
    v_mfma_f32_16x16x32_bf16 v[36:39], a[216:219], v[88:91], v[36:39]
    v_mfma_f32_16x16x32_bf16 v[24:27], a[28:31], v[92:95], v[24:27]
    v_mfma_f32_16x16x32_bf16 v[28:31], a[92:95], v[92:95], v[28:31]
    v_mfma_f32_16x16x32_bf16 v[32:35], a[156:159], v[92:95], v[32:35]
    v_mfma_f32_16x16x32_bf16 v[36:39], a[220:223], v[92:95], v[36:39]
    v_mfma_f32_16x16x32_bf16 v[24:27], a[32:35], v[96:99], v[24:27]
    v_mfma_f32_16x16x32_bf16 v[28:31], a[96:99], v[96:99], v[28:31]
    v_mfma_f32_16x16x32_bf16 v[32:35], a[160:163], v[96:99], v[32:35]
    v_mfma_f32_16x16x32_bf16 v[36:39], a[224:227], v[96:99], v[36:39]
    v_mfma_f32_16x16x32_bf16 v[24:27], a[36:39], v[100:103], v[24:27]
    v_mfma_f32_16x16x32_bf16 v[28:31], a[100:103], v[100:103], v[28:31]
    v_mfma_f32_16x16x32_bf16 v[32:35], a[164:167], v[100:103], v[32:35]
    v_mfma_f32_16x16x32_bf16 v[36:39], a[228:231], v[100:103], v[36:39]
    v_mfma_f32_16x16x32_bf16 v[24:27], a[40:43], v[104:107], v[24:27]
    v_mfma_f32_16x16x32_bf16 v[28:31], a[104:107], v[104:107], v[28:31]
    v_mfma_f32_16x16x32_bf16 v[32:35], a[168:171], v[104:107], v[32:35]
    v_mfma_f32_16x16x32_bf16 v[36:39], a[232:235], v[104:107], v[36:39]
    v_mfma_f32_16x16x32_bf16 v[24:27], a[44:47], v[108:111], v[24:27]
    v_mfma_f32_16x16x32_bf16 v[28:31], a[108:111], v[108:111], v[28:31]
    v_mfma_f32_16x16x32_bf16 v[32:35], a[172:175], v[108:111], v[32:35]
    v_mfma_f32_16x16x32_bf16 v[36:39], a[236:239], v[108:111], v[36:39]
    v_mfma_f32_16x16x32_bf16 v[24:27], a[48:51], v[112:115], v[24:27]
    v_mfma_f32_16x16x32_bf16 v[28:31], a[112:115], v[112:115], v[28:31]
    v_mfma_f32_16x16x32_bf16 v[32:35], a[176:179], v[112:115], v[32:35]
    v_mfma_f32_16x16x32_bf16 v[36:39], a[240:243], v[112:115], v[36:39]
    v_mfma_f32_16x16x32_bf16 v[24:27], a[52:55], v[116:119], v[24:27]
    v_mfma_f32_16x16x32_bf16 v[28:31], a[116:119], v[116:119], v[28:31]
    v_mfma_f32_16x16x32_bf16 v[32:35], a[180:183], v[116:119], v[32:35]
    v_mfma_f32_16x16x32_bf16 v[36:39], a[244:247], v[116:119], v[36:39]
    v_mfma_f32_16x16x32_bf16 v[24:27], a[56:59], v[120:123], v[24:27]
    v_mfma_f32_16x16x32_bf16 v[28:31], a[120:123], v[120:123], v[28:31]
    v_mfma_f32_16x16x32_bf16 v[32:35], a[184:187], v[120:123], v[32:35]
    v_mfma_f32_16x16x32_bf16 v[36:39], a[248:251], v[120:123], v[36:39]
    v_mfma_f32_16x16x32_bf16 v[24:27], a[60:63], v[124:127], v[24:27]
    v_mfma_f32_16x16x32_bf16 v[28:31], a[124:127], v[124:127], v[28:31]
    v_mfma_f32_16x16x32_bf16 v[32:35], a[188:191], v[124:127], v[32:35]
    v_mfma_f32_16x16x32_bf16 v[36:39], a[252:255], v[124:127], v[36:39]
    s_nop 7
    v_cvt_pk_bf16_f32 v24, v24, v25
    v_cvt_pk_bf16_f32 v25, v26, v27
    v_cvt_pk_bf16_f32 v28, v28, v29
    v_cvt_pk_bf16_f32 v29, v30, v31
    v_cvt_pk_bf16_f32 v32, v32, v33
    v_cvt_pk_bf16_f32 v33, v34, v35
    v_cvt_pk_bf16_f32 v36, v36, v37
    v_cvt_pk_bf16_f32 v37, v38, v39
    ds_write_b64 v8, v[24:25] offset:0
    ds_write_b64 v8, v[32:33] offset:2176
    buffer_store_dwordx2 v[32:33], v16, s[8:11], s23 offen offset:0
    ds_write_b64 v8, v[28:29] offset:32
    ds_write_b64 v8, v[36:37] offset:2208
    buffer_store_dwordx2 v[36:37], v16, s[8:11], s23 offen offset:32
    s_cmp_ge_u32 s17, 63
    s_cbranch_scc1 chain_kernel_done1
    s_waitcnt lgkmcnt(0)
    s_barrier
    ds_read_b128 v[64:67], v6 offset:0
    ds_read_b128 v[80:83], v6 offset:2176
    ds_read_b128 v[96:99], v7 offset:0
    ds_read_b128 v[112:115], v7 offset:4352
    ds_read_b128 v[68:71], v6 offset:64
    ds_read_b128 v[84:87], v6 offset:2240
    ds_read_b128 v[100:103], v7 offset:64
    ds_read_b128 v[116:119], v7 offset:4416
    ds_read_b128 v[72:75], v6 offset:128
    ds_read_b128 v[88:91], v6 offset:2304
    ds_read_b128 v[104:107], v7 offset:128
    ds_read_b128 v[120:123], v7 offset:4480
    ds_read_b128 v[76:79], v6 offset:192
    ds_read_b128 v[92:95], v6 offset:2368
    ds_read_b128 v[108:111], v7 offset:192
    ds_read_b128 v[124:127], v7 offset:4544
    s_waitcnt lgkmcnt(12)
    v_mfma_f32_16x16x32_bf16 v[24:27], v[80:83], v[64:67], 0
    v_mfma_f32_16x16x32_bf16 v[28:31], v[96:99], v[64:67], 0
    v_mfma_f32_16x16x32_bf16 v[32:35], v[112:115], v[64:67], 0
    s_waitcnt lgkmcnt(8)
    v_mfma_f32_16x16x32_bf16 v[24:27], v[84:87], v[68:71], v[24:27]
    v_mfma_f32_16x16x32_bf16 v[28:31], v[100:103], v[68:71], v[28:31]
    v_mfma_f32_16x16x32_bf16 v[32:35], v[116:119], v[68:71], v[32:35]
    s_waitcnt lgkmcnt(4)
    v_mfma_f32_16x16x32_bf16 v[24:27], v[88:91], v[72:75], v[24:27]
    v_mfma_f32_16x16x32_bf16 v[28:31], v[104:107], v[72:75], v[28:31]
    v_mfma_f32_16x16x32_bf16 v[32:35], v[120:123], v[72:75], v[32:35]
    s_waitcnt lgkmcnt(0)
    v_mfma_f32_16x16x32_bf16 v[24:27], v[92:95], v[76:79], v[24:27]
    v_mfma_f32_16x16x32_bf16 v[28:31], v[108:111], v[76:79], v[28:31]
    v_mfma_f32_16x16x32_bf16 v[32:35], v[124:127], v[76:79], v[32:35]
    ds_read_b64 v[64:65], v10 offset:0
    ds_read_b64 v[66:67], v18 offset:0
    ds_read_b64 v[68:69], v18 offset:32
    ds_read_b64 v[70:71], v10 offset:256
    ds_read_b64 v[72:73], v18 offset:1024
    ds_read_b64 v[74:75], v18 offset:1056
    ds_read_b64 v[76:77], v10 offset:512
    ds_read_b64 v[78:79], v18 offset:2048
    ds_read_b64 v[80:81], v18 offset:2080
    ds_read_b64 v[82:83], v10 offset:768
    ds_read_b64 v[84:85], v18 offset:3072
    ds_read_b64 v[86:87], v18 offset:3104
    ds_read_b64 v[88:89], v10 offset:1024
    ds_read_b64 v[90:91], v18 offset:4096
    ds_read_b64 v[92:93], v18 offset:4128
    ds_read_b64 v[94:95], v10 offset:1280
    ds_read_b64 v[96:97], v18 offset:5120
    ds_read_b64 v[98:99], v18 offset:5152
    ds_read_b64 v[100:101], v10 offset:1536
    ds_read_b64 v[102:103], v18 offset:6144
    ds_read_b64 v[104:105], v18 offset:6176
    ds_read_b64 v[106:107], v10 offset:1792
    ds_read_b64 v[108:109], v18 offset:7168
    ds_read_b64 v[110:111], v18 offset:7200
    v_mov_b32 v112, 0
    v_mov_b32 v113, 0
    v_mov_b32 v48, s31
    s_nop 1
    v_cndmask_b32 v24, v30, v24, s[26:27]
    v_cndmask_b32 v25, v31, v25, s[26:27]
    v_cndmask_b32 v26, v32, v26, s[26:27]
    v_cndmask_b32 v27, v33, v27, s[26:27]
    v_cndmask_b32 v28, v34, v28, s[26:27]
    v_cndmask_b32 v29, v35, v29, s[26:27]
    v_cvt_pk_bf16_f32 v50, v24, v25
    v_cvt_pk_bf16_f32 v51, v26, v27
    v_cvt_pk_bf16_f32 v52, v28, v29
    v_lshlrev_b32 v24, 16, v50
    v_and_b32 v25, s59, v50
    v_lshlrev_b32 v26, 16, v51
    v_and_b32 v27, s59, v51
    v_lshlrev_b32 v28, 16, v52
    v_and_b32 v29, s59, v52
    v_mul_f32 v24, s30, v24
    v_mul_f32 v25, s30, v25
    v_mul_f32 v26, s30, v26
    v_mul_f32 v27, s30, v27
    v_mul_f32 v28, s30, v28
    v_mul_f32 v29, s30, v29
    v_cvt_pk_bf16_f32 v50, v24, v25
    v_cvt_pk_bf16_f32 v51, v26, v27
    v_cvt_pk_bf16_f32 v52, v28, v29
    v_lshlrev_b32 v24, 16, v50
    v_and_b32 v25, s59, v50
    v_lshlrev_b32 v26, 16, v51
    v_and_b32 v27, s59, v51
    v_lshlrev_b32 v28, 16, v52
    v_and_b32 v29, s59, v52
    v_cndmask_b32 v24, v24, v48, s[42:43]
    v_cndmask_b32 v25, v25, v48, s[42:43]
    v_cndmask_b32 v26, v26, v48, s[42:43]
    v_cndmask_b32 v27, v27, v48, s[42:43]
    v_max3_f32 v48, v24, v25, v26
    v_max3_f32 v49, v27, v28, v29
    v_max_f32 v48, v48, v49
    s_nop 1
    v_max_f32_dpp v48, v48, v48 row_ror:8 row_mask:0xf bank_mask:0xf
    v_mov_b32 v49, v48
    s_nop 1
    v_permlane16_swap_b32 v48, v49
    s_nop 1
    v_max_f32 v48, v48, v49
    v_mov_b32 v49, v48
    s_nop 1
    v_permlane32_swap_b32 v48, v49
    s_nop 1
    v_max_f32 v48, v48, v49
    v_mul_f32 v48, s32, v48
    v_fma_f32 v24, v24, s32, -v48
    v_fma_f32 v25, v25, s32, -v48
    v_fma_f32 v26, v26, s32, -v48
    v_fma_f32 v27, v27, s32, -v48
    v_fma_f32 v28, v28, s32, -v48
    v_fma_f32 v29, v29, s32, -v48
    v_exp_f32 v24, v24
    v_exp_f32 v25, v25
    v_exp_f32 v26, v26
    v_exp_f32 v27, v27
    v_exp_f32 v28, v28
    v_exp_f32 v29, v29
    s_nop 0
    v_add_f32 v48, v24, v25
    v_add_f32 v49, v26, v27
    v_add_f32 v50, v28, v29
    v_add_f32 v48, v48, v49
    v_add_f32 v48, v48, v50
    s_nop 1
    v_add_f32_dpp v48, v48, v48 row_ror:8 row_mask:0xf bank_mask:0xf
    v_mov_b32 v49, v48
    s_nop 1
    v_permlane16_swap_b32 v48, v49
    s_nop 1
    v_add_f32 v48, v48, v49
    v_mov_b32 v49, v48
    s_nop 1
    v_permlane32_swap_b32 v48, v49
    s_nop 1
    v_add_f32 v48, v48, v49
    v_rcp_f32 v48, v48
    s_nop 0
    v_mul_f32 v24, v24, v48
    v_mul_f32 v25, v25, v48
    v_mul_f32 v26, v26, v48
    v_mul_f32 v27, v27, v48
    v_mul_f32 v28, v28, v48
    v_mul_f32 v29, v29, v48
    v_cvt_pk_bf16_f32 v36, v24, v25
    v_cvt_pk_bf16_f32 v37, v26, v27
    v_cvt_pk_bf16_f32 v38, v28, v29
    s_nop 1
    v_mov_b32_dpp v39, v36 row_ror:8 row_mask:0xf bank_mask:0xf
    v_mov_b32_dpp v40, v37 row_ror:8 row_mask:0xf bank_mask:0xf
    v_mov_b32_dpp v41, v38 row_ror:8 row_mask:0xf bank_mask:0xf
    v_mov_b32 v42, 0
    v_mov_b32 v43, 0
    s_waitcnt lgkmcnt(0)
    s_nop 1
    v_mfma_f32_16x16x32_bf16 v[24:27], v[64:67], v[36:39], 0
    v_mfma_f32_16x16x32_bf16 v[28:31], v[70:73], v[36:39], 0
    v_mfma_f32_16x16x32_bf16 v[32:35], v[76:79], v[36:39], 0
    v_mfma_f32_16x16x32_bf16 v[48:51], v[82:85], v[36:39], 0
    v_mfma_f32_16x16x32_bf16 v[52:55], v[88:91], v[36:39], 0
    v_mfma_f32_16x16x32_bf16 v[56:59], v[94:97], v[36:39], 0
    v_mfma_f32_16x16x32_bf16 v[60:63], v[100:103], v[36:39], 0
    v_mfma_f32_16x16x32_bf16 v[116:119], v[106:109], v[36:39], 0
    v_mfma_f32_16x16x32_bf16 v[24:27], v[68:71], v[40:43], v[24:27]
    v_mfma_f32_16x16x32_bf16 v[28:31], v[74:77], v[40:43], v[28:31]
    v_mfma_f32_16x16x32_bf16 v[32:35], v[80:83], v[40:43], v[32:35]
    v_mfma_f32_16x16x32_bf16 v[48:51], v[86:89], v[40:43], v[48:51]
    v_mfma_f32_16x16x32_bf16 v[52:55], v[92:95], v[40:43], v[52:55]
    v_mfma_f32_16x16x32_bf16 v[56:59], v[98:101], v[40:43], v[56:59]
    v_mfma_f32_16x16x32_bf16 v[60:63], v[104:107], v[40:43], v[60:63]
    v_mfma_f32_16x16x32_bf16 v[116:119], v[110:113], v[40:43], v[116:119]
    ds_read_b128 v[80:83], v11 offset:0
    ds_read_b128 v[84:87], v11 offset:8192
    ds_read_b128 v[88:91], v11 offset:16384
    ds_read_b128 v[92:95], v11 offset:24576
    ds_read_b128 v[96:99], v11 offset:32768
    ds_read_b128 v[100:103], v11 offset:40960
    ds_read_b128 v[104:107], v11 offset:49152
    ds_read_b128 v[108:111], v11 offset:57344
    ds_read_b128 v[112:115], v12 offset:0
    s_nop 3
    v_cvt_pk_bf16_f32 v64, v24, v25
    v_cvt_pk_bf16_f32 v65, v26, v27
    v_cvt_pk_bf16_f32 v66, v28, v29
    v_cvt_pk_bf16_f32 v67, v30, v31
    v_cvt_pk_bf16_f32 v68, v32, v33
    v_cvt_pk_bf16_f32 v69, v34, v35
    v_cvt_pk_bf16_f32 v70, v48, v49
    v_cvt_pk_bf16_f32 v71, v50, v51
    v_cvt_pk_bf16_f32 v72, v52, v53
    v_cvt_pk_bf16_f32 v73, v54, v55
    v_cvt_pk_bf16_f32 v74, v56, v57
    v_cvt_pk_bf16_f32 v75, v58, v59
    v_cvt_pk_bf16_f32 v76, v60, v61
    v_cvt_pk_bf16_f32 v77, v62, v63
    v_cvt_pk_bf16_f32 v78, v116, v117
    v_cvt_pk_bf16_f32 v79, v118, v119
    s_add_u32 s22, s17, 1
    s_add_u32 s25, s22, s57
    s_and_b32 s23, s25, 3
    s_cmp_lg_u32 s23, 0
    s_cbranch_scc1 chain_kernel_nf23
    s_cmp_ge_u32 s25, 64
    s_cbranch_scc1 chain_kernel_nf23
    s_lshr_b32 s23, s25, 2
    s_lshl_b32 s23, s23, 8
    s_lshl_b32 s24, s16, 2
    s_add_u32 s23, s23, s24
    s_add_u32 s23, s23, 105906176
    v_mov_b32 v44, 0
chain_kernel_pf24:
    buffer_load_dword v45, v44, s[8:11], s23 offen sc1
    buffer_load_dword v46, v44, s[8:11], s23 offen offset:128 sc1
    s_waitcnt vmcnt(0)
    v_and_b32 v45, v45, v46
    s_nop 0
    v_readfirstlane_b32 s24, v45
    s_add_u32 s60, s60, 1
    s_cmp_gt_u32 s60, 0x400000
    s_cbranch_scc1 chain_kernel_done1
    s_cmp_eq_u32 s24, 0
    s_cbranch_scc1 chain_kernel_pf24
chain_kernel_nf23:
    s_lshl_b32 s23, s22, 18
    s_add_u32 s23, s23, 20971520
    s_add_u32 s24, s23, 131072
    s_lshl_b32 s25, s22, 5
    s_add_u32 s25, s25, s16
    s_lshl_b32 s25, s25, 13
    s_add_u32 s25, s25, 37748736
    buffer_load_dwordx4 v[40:43], v13, s[8:11], s23 offen
    buffer_load_dwordx4 v[44:47], v13, s[8:11], s24 offen
    buffer_load_dwordx4 v[120:123], v15, s[8:11], s25 offen
    s_add_u32 s25, s25, 4096
    buffer_load_dwordx4 v[124:127], v15, s[8:11], s25 offen
    s_waitcnt lgkmcnt(8)
    v_mfma_f32_16x16x32_bf16 v[24:27], v[80:83], v[64:67], 0
    ds_read_b128 v[80:83], v12 offset:8192
    s_waitcnt lgkmcnt(8)
    v_mfma_f32_16x16x32_bf16 v[24:27], v[84:87], v[68:71], v[24:27]
    ds_read_b128 v[84:87], v12 offset:16384
    s_waitcnt lgkmcnt(8)
    v_mfma_f32_16x16x32_bf16 v[24:27], v[88:91], v[72:75], v[24:27]
    ds_read_b128 v[88:91], v12 offset:24576
    s_waitcnt lgkmcnt(8)
    v_mfma_f32_16x16x32_bf16 v[24:27], v[92:95], v[76:79], v[24:27]
    ds_read_b128 v[92:95], v12 offset:32768
    s_waitcnt lgkmcnt(8)
    v_mfma_f32_16x16x32_bf16 v[28:31], v[96:99], v[64:67], 0
    ds_read_b128 v[96:99], v12 offset:40960
    s_waitcnt lgkmcnt(8)
    v_mfma_f32_16x16x32_bf16 v[28:31], v[100:103], v[68:71], v[28:31]
    ds_read_b128 v[100:103], v12 offset:49152
    s_waitcnt lgkmcnt(8)
    v_mfma_f32_16x16x32_bf16 v[28:31], v[104:107], v[72:75], v[28:31]
    ds_read_b128 v[104:107], v12 offset:57344
    s_waitcnt lgkmcnt(8)
    v_mfma_f32_16x16x32_bf16 v[28:31], v[108:111], v[76:79], v[28:31]
    ds_read_b128 v[108:111], v11 offset:128
    s_waitcnt lgkmcnt(8)
    v_mfma_f32_16x16x32_bf16 v[32:35], v[112:115], v[64:67], 0
    ds_read_b128 v[112:115], v11 offset:8320
    s_waitcnt lgkmcnt(8)
    v_mfma_f32_16x16x32_bf16 v[32:35], v[80:83], v[68:71], v[32:35]
    ds_read_b128 v[80:83], v11 offset:16512
    s_waitcnt lgkmcnt(8)
    v_mfma_f32_16x16x32_bf16 v[32:35], v[84:87], v[72:75], v[32:35]
    ds_read_b128 v[84:87], v11 offset:24704
    s_waitcnt lgkmcnt(8)
    v_mfma_f32_16x16x32_bf16 v[32:35], v[88:91], v[76:79], v[32:35]
    ds_read_b128 v[88:91], v11 offset:32896
    s_waitcnt lgkmcnt(8)
    v_mfma_f32_16x16x32_bf16 v[36:39], v[92:95], v[64:67], 0
    ds_read_b128 v[92:95], v11 offset:41088
    s_waitcnt lgkmcnt(8)
    v_mfma_f32_16x16x32_bf16 v[36:39], v[96:99], v[68:71], v[36:39]
    ds_read_b128 v[96:99], v11 offset:49280
    s_waitcnt lgkmcnt(8)
    v_mfma_f32_16x16x32_bf16 v[36:39], v[100:103], v[72:75], v[36:39]
    ds_read_b128 v[100:103], v11 offset:57472
    s_waitcnt lgkmcnt(8)
    v_mfma_f32_16x16x32_bf16 v[36:39], v[104:107], v[76:79], v[36:39]
    ds_read_b128 v[104:107], v12 offset:128
    v_mov_b32_dpp v24, v28 row_shr:8 row_mask:0xf bank_mask:0xc
    v_mov_b32_dpp v25, v29 row_shr:8 row_mask:0xf bank_mask:0xc
    v_mov_b32_dpp v26, v30 row_shr:8 row_mask:0xf bank_mask:0xc
    v_mov_b32_dpp v27, v31 row_shr:8 row_mask:0xf bank_mask:0xc
    v_and_or_b32 v24, v24, -2, s19
    v_and_or_b32 v25, v25, -2, s19
    v_and_or_b32 v26, v26, -2, s19
    v_and_or_b32 v27, v27, -2, s19
    v_add_u32 v116, 0, v19
    buffer_store_dwordx4 v[24:27], v116, s[8:11], s34 offen sc1
    s_waitcnt lgkmcnt(8)
    v_mfma_f32_16x16x32_bf16 v[48:51], v[108:111], v[64:67], 0
    ds_read_b128 v[108:111], v12 offset:8320
    s_waitcnt lgkmcnt(8)
    v_mfma_f32_16x16x32_bf16 v[48:51], v[112:115], v[68:71], v[48:51]
    ds_read_b128 v[112:115], v12 offset:16512
    s_waitcnt lgkmcnt(8)
    v_mfma_f32_16x16x32_bf16 v[48:51], v[80:83], v[72:75], v[48:51]
    ds_read_b128 v[80:83], v12 offset:24704
    s_waitcnt lgkmcnt(8)
    v_mfma_f32_16x16x32_bf16 v[48:51], v[84:87], v[76:79], v[48:51]
    ds_read_b128 v[84:87], v12 offset:32896
    s_waitcnt lgkmcnt(8)
    v_mfma_f32_16x16x32_bf16 v[52:55], v[88:91], v[64:67], 0
    ds_read_b128 v[88:91], v12 offset:41088
    s_waitcnt lgkmcnt(8)
    v_mfma_f32_16x16x32_bf16 v[52:55], v[92:95], v[68:71], v[52:55]
    ds_read_b128 v[92:95], v12 offset:49280
    s_waitcnt lgkmcnt(8)
    v_mfma_f32_16x16x32_bf16 v[52:55], v[96:99], v[72:75], v[52:55]
    ds_read_b128 v[96:99], v12 offset:57472
    s_waitcnt lgkmcnt(8)
    v_mfma_f32_16x16x32_bf16 v[52:55], v[100:103], v[76:79], v[52:55]
    v_mov_b32_dpp v32, v36 row_shr:8 row_mask:0xf bank_mask:0xc
    v_mov_b32_dpp v33, v37 row_shr:8 row_mask:0xf bank_mask:0xc
    v_mov_b32_dpp v34, v38 row_shr:8 row_mask:0xf bank_mask:0xc
    v_mov_b32_dpp v35, v39 row_shr:8 row_mask:0xf bank_mask:0xc
    v_and_or_b32 v32, v32, -2, s19
    v_and_or_b32 v33, v33, -2, s19
    v_and_or_b32 v34, v34, -2, s19
    v_and_or_b32 v35, v35, -2, s19
    v_add_u32 v116, 32768, v19
    buffer_store_dwordx4 v[32:35], v116, s[8:11], s34 offen sc1
    s_waitcnt lgkmcnt(7)
    v_mfma_f32_16x16x32_bf16 v[56:59], v[104:107], v[64:67], 0
    s_waitcnt lgkmcnt(6)
    v_mfma_f32_16x16x32_bf16 v[56:59], v[108:111], v[68:71], v[56:59]
    s_waitcnt lgkmcnt(5)
    v_mfma_f32_16x16x32_bf16 v[56:59], v[112:115], v[72:75], v[56:59]
    s_waitcnt lgkmcnt(4)
    v_mfma_f32_16x16x32_bf16 v[56:59], v[80:83], v[76:79], v[56:59]
    s_waitcnt lgkmcnt(3)
    v_mfma_f32_16x16x32_bf16 v[60:63], v[84:87], v[64:67], 0
    s_waitcnt lgkmcnt(2)
    v_mfma_f32_16x16x32_bf16 v[60:63], v[88:91], v[68:71], v[60:63]
    s_waitcnt lgkmcnt(1)
    v_mfma_f32_16x16x32_bf16 v[60:63], v[92:95], v[72:75], v[60:63]
    s_waitcnt lgkmcnt(0)
    v_mfma_f32_16x16x32_bf16 v[60:63], v[96:99], v[76:79], v[60:63]
    v_mov_b32_dpp v48, v52 row_shr:8 row_mask:0xf bank_mask:0xc
    v_mov_b32_dpp v49, v53 row_shr:8 row_mask:0xf bank_mask:0xc
    v_mov_b32_dpp v50, v54 row_shr:8 row_mask:0xf bank_mask:0xc
    v_mov_b32_dpp v51, v55 row_shr:8 row_mask:0xf bank_mask:0xc
    v_and_or_b32 v48, v48, -2, s19
    v_and_or_b32 v49, v49, -2, s19
    v_and_or_b32 v50, v50, -2, s19
    v_and_or_b32 v51, v51, -2, s19
    v_add_u32 v116, 65536, v19
    buffer_store_dwordx4 v[48:51], v116, s[8:11], s34 offen sc1
    s_nop 7
    v_mov_b32_dpp v56, v60 row_shr:8 row_mask:0xf bank_mask:0xc
    v_mov_b32_dpp v57, v61 row_shr:8 row_mask:0xf bank_mask:0xc
    v_mov_b32_dpp v58, v62 row_shr:8 row_mask:0xf bank_mask:0xc
    v_mov_b32_dpp v59, v63 row_shr:8 row_mask:0xf bank_mask:0xc
    v_and_or_b32 v56, v56, -2, s19
    v_and_or_b32 v57, v57, -2, s19
    v_and_or_b32 v58, v58, -2, s19
    v_and_or_b32 v59, v59, -2, s19
    v_add_u32 v116, 98304, v19
    buffer_store_dwordx4 v[56:59], v116, s[8:11], s34 offen sc1
    buffer_load_dwordx4 v[64:67], v20, s[8:11], s34 offen offset:0 sc1
    buffer_load_dwordx4 v[68:71], v20, s[8:11], s34 offen offset:512 sc1
    buffer_load_dwordx4 v[72:75], v20, s[8:11], s34 offen offset:1024 sc1
    buffer_load_dwordx4 v[76:79], v20, s[8:11], s34 offen offset:1536 sc1
    s_waitcnt vmcnt(0)
    v_or3_b32 v48, v64, v65, v66
    v_or3_b32 v49, v67, v68, v69
    v_or3_b32 v48, v48, v70, v71
    v_or3_b32 v49, v49, v72, v73
    v_or3_b32 v48, v48, v74, v75
    v_or3_b32 v49, v49, v76, v77
    v_or3_b32 v48, v48, v78, v79
    v_or_b32 v48, v48, v49
    v_and_b32 v50, v64, v65
    v_and_b32 v51, v66, v67
    v_and_b32 v50, v50, v68
    v_and_b32 v51, v51, v69
    v_and_b32 v50, v50, v70
    v_and_b32 v51, v51, v71
    v_and_b32 v50, v50, v72
    v_and_b32 v51, v51, v73
    v_and_b32 v50, v50, v74
    v_and_b32 v51, v51, v75
    v_and_b32 v50, v50, v76
    v_and_b32 v51, v51, v77
    v_and_b32 v50, v50, v78
    v_and_b32 v51, v51, v79
    v_and_b32 v50, v50, v51
    v_xor_b32 v48, s19, v48
    v_xor_b32 v50, s19, v50
    v_or_b32 v48, v48, v50
    v_and_b32 v48, 1, v48
    v_cmp_ne_u32 vcc, 0, v48
    s_mov_b64 exec, vcc
    s_cbranch_execz chain_kernel_ok126
    s_add_u32 s60, s60, 1
    s_cmp_gt_u32 s60, 0x200000
    s_cbranch_scc1 chain_kernel_done1
chain_kernel_poll125:
    buffer_load_dwordx4 v[64:67], v20, s[8:11], s34 offen offset:0 sc1
    buffer_load_dwordx4 v[68:71], v20, s[8:11], s34 offen offset:512 sc1
    buffer_load_dwordx4 v[72:75], v20, s[8:11], s34 offen offset:1024 sc1
    buffer_load_dwordx4 v[76:79], v20, s[8:11], s34 offen offset:1536 sc1
    s_waitcnt vmcnt(0)
    v_or3_b32 v48, v64, v65, v66
    v_or3_b32 v49, v67, v68, v69
    v_or3_b32 v48, v48, v70, v71
    v_or3_b32 v49, v49, v72, v73
    v_or3_b32 v48, v48, v74, v75
    v_or3_b32 v49, v49, v76, v77
    v_or3_b32 v48, v48, v78, v79
    v_or_b32 v48, v48, v49
    v_and_b32 v50, v64, v65
    v_and_b32 v51, v66, v67
    v_and_b32 v50, v50, v68
    v_and_b32 v51, v51, v69
    v_and_b32 v50, v50, v70
    v_and_b32 v51, v51, v71
    v_and_b32 v50, v50, v72
    v_and_b32 v51, v51, v73
    v_and_b32 v50, v50, v74
    v_and_b32 v51, v51, v75
    v_and_b32 v50, v50, v76
    v_and_b32 v51, v51, v77
    v_and_b32 v50, v50, v78
    v_and_b32 v51, v51, v79
    v_and_b32 v50, v50, v51
    v_xor_b32 v48, s19, v48
    v_xor_b32 v50, s19, v50
    v_or_b32 v48, v48, v50
    v_and_b32 v48, 1, v48
    v_cmp_ne_u32 vcc, 0, v48
    s_mov_b64 exec, vcc
    s_cbranch_execz chain_kernel_ok126
    s_add_u32 s60, s60, 1
    s_cmp_gt_u32 s60, 0x200000
    s_cbranch_scc1 chain_kernel_done1
    s_branch chain_kernel_poll125
chain_kernel_ok126:
    s_mov_b64 exec, -1
    v_add_f32 v64, v64, v68
    v_add_f32 v72, v72, v76
    v_add_f32 v65, v65, v69
    v_add_f32 v73, v73, v77
    v_add_f32 v66, v66, v70
    v_add_f32 v74, v74, v78
    v_add_f32 v67, v67, v71
    v_add_f32 v75, v75, v79
    v_add_f32 v64, v64, v72
    v_add_f32 v65, v65, v73
    v_add_f32 v66, v66, v74
    v_add_f32 v67, v67, v75
    s_nop 1
    v_add_f32_dpp v68, v64, v64 row_ror:8 row_mask:0xf bank_mask:0xf
    v_add_f32_dpp v69, v65, v65 row_ror:8 row_mask:0xf bank_mask:0xf
    v_add_f32_dpp v70, v66, v66 row_ror:8 row_mask:0xf bank_mask:0xf
    v_add_f32_dpp v71, v67, v67 row_ror:8 row_mask:0xf bank_mask:0xf
    v_mov_b32 v72, v68
    v_mov_b32 v73, v69
    v_mov_b32 v74, v70
    v_mov_b32 v75, v71
    s_nop 1
    v_permlane16_swap_b32 v68, v72
    v_permlane16_swap_b32 v69, v73
    v_permlane16_swap_b32 v70, v74
    v_permlane16_swap_b32 v71, v75
    s_nop 1
    v_add_f32 v68, v68, v72
    v_add_f32 v69, v69, v73
    v_add_f32 v70, v70, v74
    v_add_f32 v71, v71, v75
    v_mov_b32 v72, v68
    v_mov_b32 v73, v69
    v_mov_b32 v74, v70
    v_mov_b32 v75, v71
    s_nop 1
    v_permlane32_swap_b32 v68, v72
    v_permlane32_swap_b32 v69, v73
    v_permlane32_swap_b32 v70, v74
    v_permlane32_swap_b32 v71, v75
    s_nop 1
    v_add_f32 v68, v68, v72
    v_add_f32 v69, v69, v73
    v_add_f32 v70, v70, v74
    v_add_f32 v71, v71, v75
    v_cvt_pk_bf16_f32 v64, v68, v69
    v_cvt_pk_bf16_f32 v65, v70, v71
    buffer_store_dwordx2 v[64:65], v22, s[8:11], s36 offen sc1
    v_mov_b32 v66, -1
    v_mov_b32 v67, -1
    buffer_store_dwordx2 v[66:67], v22, s[8:11], s35 offen sc1
    s_add_u32 s17, s17, 1
    s_branch chain_kernel_step20
chain_kernel_done1:
    s_branch chain_kernel_done02
chain_kernel_worker3:
chain_kernel_wl27:
    s_load_dwordx2 s[12:13], s[0:1], 96
    s_waitcnt lgkmcnt(0)
    s_mov_b32 s14, 256
    s_mov_b32 s15, 0x00020000
    s_barrier
    s_cmp_lg_u32 s18, 0
    s_cbranch_scc1 chain_kernel_t031
    s_mov_b64 exec, 1
    v_mov_b32 v5, 1
    v_mov_b32 v6, 128
    buffer_atomic_add v5, v6, s[12:15], 0 offen sc0
    s_waitcnt vmcnt(0)
    v_mov_b32 v6, 0
    ds_write_b32 v6, v5
    s_mov_b64 exec, -1
    s_waitcnt lgkmcnt(0)
chain_kernel_t031:
    s_barrier
    v_mov_b32 v6, 0
    ds_read_b32 v5, v6
    s_waitcnt lgkmcnt(0)
    v_readfirstlane_b32 s50, v5
    s_nop 3
    s_barrier
    s_cmp_ge_u32 s50, 1536
    s_cbranch_scc1 chain_kernel_done02
    s_cmp_ge_u32 s50, 1024
    s_cbranch_scc1 chain_kernel_wq28
    s_lshr_b32 s28, s50, 6
    s_and_b32 s29, s50, 63
    s_add_u32 s29, s29, 32
    s_branch chain_kernel_wgo29
chain_kernel_wq28:
    s_sub_u32 s51, s50, 1024
    s_lshr_b32 s28, s51, 5
    s_and_b32 s29, s51, 31
chain_kernel_wgo29:
    s_load_dwordx2 s[20:21], s[0:1], 104
    s_waitcnt lgkmcnt(0)
    s_mov_b32 s22, 268435456
    s_mov_b32 s23, 0x00020000
    s_mov_b32 s8, s20
    s_mov_b32 s9, s21
    s_mov_b32 s10, s22
    s_mov_b32 s11, s23
    s_load_dwordx2 s[12:13], s[0:1], 16
    s_load_dwordx2 s[16:17], s[0:1], 24
    s_load_dwordx2 s[18:19], s[0:1], 32
    s_waitcnt lgkmcnt(0)
    s_lshr_b32 s35, s29, 5
    s_cmp_eq_u32 s35, 1
    s_cselect_b32 s12, s16, s12
    s_cselect_b32 s13, s17, s13
    s_cmp_eq_u32 s35, 2
    s_cselect_b32 s12, s18, s12
    s_cselect_b32 s13, s19, s13
    s_mov_b32 s14, 4194304
    s_mov_b32 s15, 0x00020000
    s_and_b32 s36, s29, 31
    s_lshl_b32 s37, s36, 8
    v_and_b32 v13, 63, v0
    v_lshrrev_b32 v14, 6, v0
    v_and_b32 v15, 1, v14
    v_lshrrev_b32 v16, 1, v14
    v_lshrrev_b32 v17, 3, v0
    v_and_b32 v18, 7, v0
    s_lshl_b32 s38, s28, 7
    v_add_u32 v19, s38, v17
    s_mov_b32 s39, 1024
    v_mul_lo_u32 v19, v19, s39
    v_lshl_add_u32 v1, v18, 4, v19
    v_add_u32 v2, 32768, v1
    v_add_u32 v3, 65536, v1
    v_add_u32 v4, 98304, v1
    v_mul_u32_u24 v9, 144, v17
    v_lshl_add_u32 v9, v18, 4, v9
    v_lshrrev_b32 v17, 4, v0
    v_and_b32 v18, 15, v0
    s_mov_b32 s39, 8192
    v_mul_lo_u32 v19, v17, s39
    v_lshl_add_u32 v5, v18, 4, v19
    v_add_u32 v5, s37, v5
    v_add_u32 v6, 131072, v5
    v_add_u32 v7, 262144, v5
    v_add_u32 v8, 393216, v5
    v_mul_u32_u24 v10, 320, v17
    v_lshl_add_u32 v10, v18, 4, v10
    v_add_u32 v10, 18432, v10
    v_and_b32 v17, 31, v13
    v_lshl_add_u32 v17, v15, 6, v17
    v_mul_u32_u24 v11, 144, v17
    v_lshrrev_b32 v18, 5, v13
    v_lshl_add_u32 v11, v18, 4, v11
    v_and_b32 v17, 15, v13
    v_lshrrev_b32 v17, 2, v17
    v_lshl_add_u32 v17, v18, 3, v17
    v_mul_u32_u24 v12, 320, v17
    v_lshrrev_b32 v17, 4, v13
    v_and_b32 v17, 1, v17
    v_lshlrev_b32 v17, 5, v17
    v_add_u32 v12, v12, v17
    v_and_b32 v17, 3, v13
    v_lshl_add_u32 v12, v17, 3, v12
    v_lshl_add_u32 v12, v16, 7, v12
    v_add_u32 v12, 18432, v12
    v_mov_b32 v64, 0
    v_mov_b32 v65, 0
    v_mov_b32 v66, 0
    v_mov_b32 v67, 0
    v_mov_b32 v68, 0
    v_mov_b32 v69, 0
    v_mov_b32 v70, 0
    v_mov_b32 v71, 0
    v_mov_b32 v72, 0
    v_mov_b32 v73, 0
    v_mov_b32 v74, 0
    v_mov_b32 v75, 0
    v_mov_b32 v76, 0
    v_mov_b32 v77, 0
    v_mov_b32 v78, 0
    v_mov_b32 v79, 0
    v_mov_b32 v80, 0
    v_mov_b32 v81, 0
    v_mov_b32 v82, 0
    v_mov_b32 v83, 0
    v_mov_b32 v84, 0
    v_mov_b32 v85, 0
    v_mov_b32 v86, 0
    v_mov_b32 v87, 0
    v_mov_b32 v88, 0
    v_mov_b32 v89, 0
    v_mov_b32 v90, 0
    v_mov_b32 v91, 0
    v_mov_b32 v92, 0
    v_mov_b32 v93, 0
    v_mov_b32 v94, 0
    v_mov_b32 v95, 0
    v_mov_b32 v96, 0
    v_mov_b32 v97, 0
    v_mov_b32 v98, 0
    v_mov_b32 v99, 0
    v_mov_b32 v100, 0
    v_mov_b32 v101, 0
    v_mov_b32 v102, 0
    v_mov_b32 v103, 0
    v_mov_b32 v104, 0
    v_mov_b32 v105, 0
    v_mov_b32 v106, 0
    v_mov_b32 v107, 0
    v_mov_b32 v108, 0
    v_mov_b32 v109, 0
    v_mov_b32 v110, 0
    v_mov_b32 v111, 0
    v_mov_b32 v112, 0
    v_mov_b32 v113, 0
    v_mov_b32 v114, 0
    v_mov_b32 v115, 0
    v_mov_b32 v116, 0
    v_mov_b32 v117, 0
    v_mov_b32 v118, 0
    v_mov_b32 v119, 0
    v_mov_b32 v120, 0
    v_mov_b32 v121, 0
    v_mov_b32 v122, 0
    v_mov_b32 v123, 0
    v_mov_b32 v124, 0
    v_mov_b32 v125, 0
    v_mov_b32 v126, 0
    v_mov_b32 v127, 0
    s_mov_b32 s33, 0
    s_mov_b32 s34, 0
    s_mov_b32 s31, 0
    buffer_load_dwordx4 v[128:131], v1, s[8:11], s33 offen
    buffer_load_dwordx4 v[132:135], v2, s[8:11], s33 offen
    buffer_load_dwordx4 v[136:139], v3, s[8:11], s33 offen
    buffer_load_dwordx4 v[140:143], v4, s[8:11], s33 offen
    buffer_load_dwordx4 v[144:147], v5, s[12:15], s34 offen
    buffer_load_dwordx4 v[148:151], v6, s[12:15], s34 offen
    buffer_load_dwordx4 v[152:155], v7, s[12:15], s34 offen
    buffer_load_dwordx4 v[156:159], v8, s[12:15], s34 offen
    s_add_u32 s33, s33, 128
    s_add_u32 s34, s34, 524288
    buffer_load_dwordx4 v[192:195], v1, s[8:11], s33 offen
    buffer_load_dwordx4 v[196:199], v2, s[8:11], s33 offen
    buffer_load_dwordx4 v[200:203], v3, s[8:11], s33 offen
    buffer_load_dwordx4 v[204:207], v4, s[8:11], s33 offen
    buffer_load_dwordx4 v[208:211], v5, s[12:15], s34 offen
    buffer_load_dwordx4 v[212:215], v6, s[12:15], s34 offen
    buffer_load_dwordx4 v[216:219], v7, s[12:15], s34 offen
    buffer_load_dwordx4 v[220:223], v8, s[12:15], s34 offen
    s_add_u32 s33, s33, 128
    s_add_u32 s34, s34, 524288
    s_waitcnt vmcnt(8)
    ds_write_b128 v9, v[128:131] offset:0
    ds_write_b128 v9, v[132:135] offset:4608
    ds_write_b128 v9, v[136:139] offset:9216
    ds_write_b128 v9, v[140:143] offset:13824
    ds_write_b128 v10, v[144:147] offset:0
    ds_write_b128 v10, v[148:151] offset:5120
    ds_write_b128 v10, v[152:155] offset:10240
    ds_write_b128 v10, v[156:159] offset:15360
    s_waitcnt lgkmcnt(0)
    s_barrier
    s_cmp_eq_u32 s35, 2
    s_cbranch_scc1 chain_kernel_vpath33
    buffer_load_dwordx4 v[128:131], v1, s[8:11], s33 offen
    buffer_load_dwordx4 v[132:135], v2, s[8:11], s33 offen
    buffer_load_dwordx4 v[136:139], v3, s[8:11], s33 offen
    buffer_load_dwordx4 v[140:143], v4, s[8:11], s33 offen
    buffer_load_dwordx4 v[144:147], v5, s[12:15], s34 offen
    buffer_load_dwordx4 v[148:151], v6, s[12:15], s34 offen
    buffer_load_dwordx4 v[152:155], v7, s[12:15], s34 offen
    buffer_load_dwordx4 v[156:159], v8, s[12:15], s34 offen
    s_add_u32 s33, s33, 128
    s_add_u32 s34, s34, 524288
    ds_read_b128 v[160:163], v11 offset:0
    ds_read_b128 v[164:167], v11 offset:4608
    ds_read_b64_tr_b16 v[168:169], v12 offset:0
    ds_read_b64_tr_b16 v[170:171], v12 offset:1280
    ds_read_b64_tr_b16 v[172:173], v12 offset:64
    ds_read_b64_tr_b16 v[174:175], v12 offset:1344
    ds_read_b128 v[176:179], v11 offset:32
    ds_read_b128 v[180:183], v11 offset:4640
    ds_read_b64_tr_b16 v[184:185], v12 offset:5120
    ds_read_b64_tr_b16 v[186:187], v12 offset:6400
    ds_read_b64_tr_b16 v[188:189], v12 offset:5184
    ds_read_b64_tr_b16 v[190:191], v12 offset:6464
    s_waitcnt lgkmcnt(6)
    v_mfma_f32_32x32x16_bf16 v[64:79], v[168:171], v[160:163], v[64:79]
    v_mfma_f32_32x32x16_bf16 v[80:95], v[172:175], v[160:163], v[80:95]
    v_mfma_f32_32x32x16_bf16 v[96:111], v[168:171], v[164:167], v[96:111]
    v_mfma_f32_32x32x16_bf16 v[112:127], v[172:175], v[164:167], v[112:127]
    ds_read_b128 v[160:163], v11 offset:64
    ds_read_b128 v[164:167], v11 offset:4672
    ds_read_b64_tr_b16 v[168:169], v12 offset:10240
    ds_read_b64_tr_b16 v[170:171], v12 offset:11520
    ds_read_b64_tr_b16 v[172:173], v12 offset:10304
    ds_read_b64_tr_b16 v[174:175], v12 offset:11584
    s_waitcnt lgkmcnt(6)
    v_mfma_f32_32x32x16_bf16 v[64:79], v[184:187], v[176:179], v[64:79]
    v_mfma_f32_32x32x16_bf16 v[80:95], v[188:191], v[176:179], v[80:95]
    v_mfma_f32_32x32x16_bf16 v[96:111], v[184:187], v[180:183], v[96:111]
    v_mfma_f32_32x32x16_bf16 v[112:127], v[188:191], v[180:183], v[112:127]
    ds_read_b128 v[176:179], v11 offset:96
    ds_read_b128 v[180:183], v11 offset:4704
    ds_read_b64_tr_b16 v[184:185], v12 offset:15360
    ds_read_b64_tr_b16 v[186:187], v12 offset:16640
    ds_read_b64_tr_b16 v[188:189], v12 offset:15424
    ds_read_b64_tr_b16 v[190:191], v12 offset:16704
    s_waitcnt lgkmcnt(6)
    v_mfma_f32_32x32x16_bf16 v[64:79], v[168:171], v[160:163], v[64:79]
    v_mfma_f32_32x32x16_bf16 v[80:95], v[172:175], v[160:163], v[80:95]
    v_mfma_f32_32x32x16_bf16 v[96:111], v[168:171], v[164:167], v[96:111]
    v_mfma_f32_32x32x16_bf16 v[112:127], v[172:175], v[164:167], v[112:127]
    s_waitcnt lgkmcnt(0)
    v_mfma_f32_32x32x16_bf16 v[64:79], v[184:187], v[176:179], v[64:79]
    v_mfma_f32_32x32x16_bf16 v[80:95], v[188:191], v[176:179], v[80:95]
    v_mfma_f32_32x32x16_bf16 v[96:111], v[184:187], v[180:183], v[96:111]
    v_mfma_f32_32x32x16_bf16 v[112:127], v[188:191], v[180:183], v[112:127]
    s_waitcnt vmcnt(8)
    ds_write_b128 v9, v[192:195] offset:40960
    ds_write_b128 v9, v[196:199] offset:45568
    ds_write_b128 v9, v[200:203] offset:50176
    ds_write_b128 v9, v[204:207] offset:54784
    ds_write_b128 v10, v[208:211] offset:40960
    ds_write_b128 v10, v[212:215] offset:46080
    ds_write_b128 v10, v[216:219] offset:51200
    ds_write_b128 v10, v[220:223] offset:56320
    s_waitcnt lgkmcnt(0)
    s_barrier
    buffer_load_dwordx4 v[192:195], v1, s[8:11], s33 offen
    buffer_load_dwordx4 v[196:199], v2, s[8:11], s33 offen
    buffer_load_dwordx4 v[200:203], v3, s[8:11], s33 offen
    buffer_load_dwordx4 v[204:207], v4, s[8:11], s33 offen
    buffer_load_dwordx4 v[208:211], v5, s[12:15], s34 offen
    buffer_load_dwordx4 v[212:215], v6, s[12:15], s34 offen
    buffer_load_dwordx4 v[216:219], v7, s[12:15], s34 offen
    buffer_load_dwordx4 v[220:223], v8, s[12:15], s34 offen
    s_add_u32 s33, s33, 128
    s_add_u32 s34, s34, 524288
    ds_read_b128 v[160:163], v11 offset:40960
    ds_read_b128 v[164:167], v11 offset:45568
    ds_read_b64_tr_b16 v[168:169], v12 offset:40960
    ds_read_b64_tr_b16 v[170:171], v12 offset:42240
    ds_read_b64_tr_b16 v[172:173], v12 offset:41024
    ds_read_b64_tr_b16 v[174:175], v12 offset:42304
    ds_read_b128 v[176:179], v11 offset:40992
    ds_read_b128 v[180:183], v11 offset:45600
    ds_read_b64_tr_b16 v[184:185], v12 offset:46080
    ds_read_b64_tr_b16 v[186:187], v12 offset:47360
    ds_read_b64_tr_b16 v[188:189], v12 offset:46144
    ds_read_b64_tr_b16 v[190:191], v12 offset:47424
    s_waitcnt lgkmcnt(6)
    v_mfma_f32_32x32x16_bf16 v[64:79], v[168:171], v[160:163], v[64:79]
    v_mfma_f32_32x32x16_bf16 v[80:95], v[172:175], v[160:163], v[80:95]
    v_mfma_f32_32x32x16_bf16 v[96:111], v[168:171], v[164:167], v[96:111]
    v_mfma_f32_32x32x16_bf16 v[112:127], v[172:175], v[164:167], v[112:127]
    ds_read_b128 v[160:163], v11 offset:41024
    ds_read_b128 v[164:167], v11 offset:45632
    ds_read_b64_tr_b16 v[168:169], v12 offset:51200
    ds_read_b64_tr_b16 v[170:171], v12 offset:52480
    ds_read_b64_tr_b16 v[172:173], v12 offset:51264
    ds_read_b64_tr_b16 v[174:175], v12 offset:52544
    s_waitcnt lgkmcnt(6)
    v_mfma_f32_32x32x16_bf16 v[64:79], v[184:187], v[176:179], v[64:79]
    v_mfma_f32_32x32x16_bf16 v[80:95], v[188:191], v[176:179], v[80:95]
    v_mfma_f32_32x32x16_bf16 v[96:111], v[184:187], v[180:183], v[96:111]
    v_mfma_f32_32x32x16_bf16 v[112:127], v[188:191], v[180:183], v[112:127]
    ds_read_b128 v[176:179], v11 offset:41056
    ds_read_b128 v[180:183], v11 offset:45664
    ds_read_b64_tr_b16 v[184:185], v12 offset:56320
    ds_read_b64_tr_b16 v[186:187], v12 offset:57600
    ds_read_b64_tr_b16 v[188:189], v12 offset:56384
    ds_read_b64_tr_b16 v[190:191], v12 offset:57664
    s_waitcnt lgkmcnt(6)
    v_mfma_f32_32x32x16_bf16 v[64:79], v[168:171], v[160:163], v[64:79]
    v_mfma_f32_32x32x16_bf16 v[80:95], v[172:175], v[160:163], v[80:95]
    v_mfma_f32_32x32x16_bf16 v[96:111], v[168:171], v[164:167], v[96:111]
    v_mfma_f32_32x32x16_bf16 v[112:127], v[172:175], v[164:167], v[112:127]
    s_waitcnt lgkmcnt(0)
    v_mfma_f32_32x32x16_bf16 v[64:79], v[184:187], v[176:179], v[64:79]
    v_mfma_f32_32x32x16_bf16 v[80:95], v[188:191], v[176:179], v[80:95]
    v_mfma_f32_32x32x16_bf16 v[96:111], v[184:187], v[180:183], v[96:111]
    v_mfma_f32_32x32x16_bf16 v[112:127], v[188:191], v[180:183], v[112:127]
    s_waitcnt vmcnt(8)
    ds_write_b128 v9, v[128:131] offset:0
    ds_write_b128 v9, v[132:135] offset:4608
    ds_write_b128 v9, v[136:139] offset:9216
    ds_write_b128 v9, v[140:143] offset:13824
    ds_write_b128 v10, v[144:147] offset:0
    ds_write_b128 v10, v[148:151] offset:5120
    ds_write_b128 v10, v[152:155] offset:10240
    ds_write_b128 v10, v[156:159] offset:15360
    s_waitcnt lgkmcnt(0)
    s_barrier
    buffer_load_dwordx4 v[128:131], v1, s[8:11], s33 offen
    buffer_load_dwordx4 v[132:135], v2, s[8:11], s33 offen
    buffer_load_dwordx4 v[136:139], v3, s[8:11], s33 offen
    buffer_load_dwordx4 v[140:143], v4, s[8:11], s33 offen
    buffer_load_dwordx4 v[144:147], v5, s[12:15], s34 offen
    buffer_load_dwordx4 v[148:151], v6, s[12:15], s34 offen
    buffer_load_dwordx4 v[152:155], v7, s[12:15], s34 offen
    buffer_load_dwordx4 v[156:159], v8, s[12:15], s34 offen
    s_add_u32 s33, s33, 128
    s_add_u32 s34, s34, 524288
    ds_read_b128 v[160:163], v11 offset:0
    ds_read_b128 v[164:167], v11 offset:4608
    ds_read_b64_tr_b16 v[168:169], v12 offset:0
    ds_read_b64_tr_b16 v[170:171], v12 offset:1280
    ds_read_b64_tr_b16 v[172:173], v12 offset:64
    ds_read_b64_tr_b16 v[174:175], v12 offset:1344
    ds_read_b128 v[176:179], v11 offset:32
    ds_read_b128 v[180:183], v11 offset:4640
    ds_read_b64_tr_b16 v[184:185], v12 offset:5120
    ds_read_b64_tr_b16 v[186:187], v12 offset:6400
    ds_read_b64_tr_b16 v[188:189], v12 offset:5184
    ds_read_b64_tr_b16 v[190:191], v12 offset:6464
    s_waitcnt lgkmcnt(6)
    v_mfma_f32_32x32x16_bf16 v[64:79], v[168:171], v[160:163], v[64:79]
    v_mfma_f32_32x32x16_bf16 v[80:95], v[172:175], v[160:163], v[80:95]
    v_mfma_f32_32x32x16_bf16 v[96:111], v[168:171], v[164:167], v[96:111]
    v_mfma_f32_32x32x16_bf16 v[112:127], v[172:175], v[164:167], v[112:127]
    ds_read_b128 v[160:163], v11 offset:64
    ds_read_b128 v[164:167], v11 offset:4672
    ds_read_b64_tr_b16 v[168:169], v12 offset:10240
    ds_read_b64_tr_b16 v[170:171], v12 offset:11520
    ds_read_b64_tr_b16 v[172:173], v12 offset:10304
    ds_read_b64_tr_b16 v[174:175], v12 offset:11584
    s_waitcnt lgkmcnt(6)
    v_mfma_f32_32x32x16_bf16 v[64:79], v[184:187], v[176:179], v[64:79]
    v_mfma_f32_32x32x16_bf16 v[80:95], v[188:191], v[176:179], v[80:95]
    v_mfma_f32_32x32x16_bf16 v[96:111], v[184:187], v[180:183], v[96:111]
    v_mfma_f32_32x32x16_bf16 v[112:127], v[188:191], v[180:183], v[112:127]
    ds_read_b128 v[176:179], v11 offset:96
    ds_read_b128 v[180:183], v11 offset:4704
    ds_read_b64_tr_b16 v[184:185], v12 offset:15360
    ds_read_b64_tr_b16 v[186:187], v12 offset:16640
    ds_read_b64_tr_b16 v[188:189], v12 offset:15424
    ds_read_b64_tr_b16 v[190:191], v12 offset:16704
    s_waitcnt lgkmcnt(6)
    v_mfma_f32_32x32x16_bf16 v[64:79], v[168:171], v[160:163], v[64:79]
    v_mfma_f32_32x32x16_bf16 v[80:95], v[172:175], v[160:163], v[80:95]
    v_mfma_f32_32x32x16_bf16 v[96:111], v[168:171], v[164:167], v[96:111]
    v_mfma_f32_32x32x16_bf16 v[112:127], v[172:175], v[164:167], v[112:127]
    s_waitcnt lgkmcnt(0)
    v_mfma_f32_32x32x16_bf16 v[64:79], v[184:187], v[176:179], v[64:79]
    v_mfma_f32_32x32x16_bf16 v[80:95], v[188:191], v[176:179], v[80:95]
    v_mfma_f32_32x32x16_bf16 v[96:111], v[184:187], v[180:183], v[96:111]
    v_mfma_f32_32x32x16_bf16 v[112:127], v[188:191], v[180:183], v[112:127]
    s_waitcnt vmcnt(8)
    ds_write_b128 v9, v[192:195] offset:40960
    ds_write_b128 v9, v[196:199] offset:45568
    ds_write_b128 v9, v[200:203] offset:50176
    ds_write_b128 v9, v[204:207] offset:54784
    ds_write_b128 v10, v[208:211] offset:40960
    ds_write_b128 v10, v[212:215] offset:46080
    ds_write_b128 v10, v[216:219] offset:51200
    ds_write_b128 v10, v[220:223] offset:56320
    s_waitcnt lgkmcnt(0)
    s_barrier
    buffer_load_dwordx4 v[192:195], v1, s[8:11], s33 offen
    buffer_load_dwordx4 v[196:199], v2, s[8:11], s33 offen
    buffer_load_dwordx4 v[200:203], v3, s[8:11], s33 offen
    buffer_load_dwordx4 v[204:207], v4, s[8:11], s33 offen
    buffer_load_dwordx4 v[208:211], v5, s[12:15], s34 offen
    buffer_load_dwordx4 v[212:215], v6, s[12:15], s34 offen
    buffer_load_dwordx4 v[216:219], v7, s[12:15], s34 offen
    buffer_load_dwordx4 v[220:223], v8, s[12:15], s34 offen
    s_add_u32 s33, s33, 128
    s_add_u32 s34, s34, 524288
    ds_read_b128 v[160:163], v11 offset:40960
    ds_read_b128 v[164:167], v11 offset:45568
    ds_read_b64_tr_b16 v[168:169], v12 offset:40960
    ds_read_b64_tr_b16 v[170:171], v12 offset:42240
    ds_read_b64_tr_b16 v[172:173], v12 offset:41024
    ds_read_b64_tr_b16 v[174:175], v12 offset:42304
    ds_read_b128 v[176:179], v11 offset:40992
    ds_read_b128 v[180:183], v11 offset:45600
    ds_read_b64_tr_b16 v[184:185], v12 offset:46080
    ds_read_b64_tr_b16 v[186:187], v12 offset:47360
    ds_read_b64_tr_b16 v[188:189], v12 offset:46144
    ds_read_b64_tr_b16 v[190:191], v12 offset:47424
    s_waitcnt lgkmcnt(6)
    v_mfma_f32_32x32x16_bf16 v[64:79], v[168:171], v[160:163], v[64:79]
    v_mfma_f32_32x32x16_bf16 v[80:95], v[172:175], v[160:163], v[80:95]
    v_mfma_f32_32x32x16_bf16 v[96:111], v[168:171], v[164:167], v[96:111]
    v_mfma_f32_32x32x16_bf16 v[112:127], v[172:175], v[164:167], v[112:127]
    ds_read_b128 v[160:163], v11 offset:41024
    ds_read_b128 v[164:167], v11 offset:45632
    ds_read_b64_tr_b16 v[168:169], v12 offset:51200
    ds_read_b64_tr_b16 v[170:171], v12 offset:52480
    ds_read_b64_tr_b16 v[172:173], v12 offset:51264
    ds_read_b64_tr_b16 v[174:175], v12 offset:52544
    s_waitcnt lgkmcnt(6)
    v_mfma_f32_32x32x16_bf16 v[64:79], v[184:187], v[176:179], v[64:79]
    v_mfma_f32_32x32x16_bf16 v[80:95], v[188:191], v[176:179], v[80:95]
    v_mfma_f32_32x32x16_bf16 v[96:111], v[184:187], v[180:183], v[96:111]
    v_mfma_f32_32x32x16_bf16 v[112:127], v[188:191], v[180:183], v[112:127]
    ds_read_b128 v[176:179], v11 offset:41056
    ds_read_b128 v[180:183], v11 offset:45664
    ds_read_b64_tr_b16 v[184:185], v12 offset:56320
    ds_read_b64_tr_b16 v[186:187], v12 offset:57600
    ds_read_b64_tr_b16 v[188:189], v12 offset:56384
    ds_read_b64_tr_b16 v[190:191], v12 offset:57664
    s_waitcnt lgkmcnt(6)
    v_mfma_f32_32x32x16_bf16 v[64:79], v[168:171], v[160:163], v[64:79]
    v_mfma_f32_32x32x16_bf16 v[80:95], v[172:175], v[160:163], v[80:95]
    v_mfma_f32_32x32x16_bf16 v[96:111], v[168:171], v[164:167], v[96:111]
    v_mfma_f32_32x32x16_bf16 v[112:127], v[172:175], v[164:167], v[112:127]
    s_waitcnt lgkmcnt(0)
    v_mfma_f32_32x32x16_bf16 v[64:79], v[184:187], v[176:179], v[64:79]
    v_mfma_f32_32x32x16_bf16 v[80:95], v[188:191], v[176:179], v[80:95]
    v_mfma_f32_32x32x16_bf16 v[96:111], v[184:187], v[180:183], v[96:111]
    v_mfma_f32_32x32x16_bf16 v[112:127], v[188:191], v[180:183], v[112:127]
    s_waitcnt vmcnt(8)
    ds_write_b128 v9, v[128:131] offset:0
    ds_write_b128 v9, v[132:135] offset:4608
    ds_write_b128 v9, v[136:139] offset:9216
    ds_write_b128 v9, v[140:143] offset:13824
    ds_write_b128 v10, v[144:147] offset:0
    ds_write_b128 v10, v[148:151] offset:5120
    ds_write_b128 v10, v[152:155] offset:10240
    ds_write_b128 v10, v[156:159] offset:15360
    s_waitcnt lgkmcnt(0)
    s_barrier
    buffer_load_dwordx4 v[128:131], v1, s[8:11], s33 offen
    buffer_load_dwordx4 v[132:135], v2, s[8:11], s33 offen
    buffer_load_dwordx4 v[136:139], v3, s[8:11], s33 offen
    buffer_load_dwordx4 v[140:143], v4, s[8:11], s33 offen
    buffer_load_dwordx4 v[144:147], v5, s[12:15], s34 offen
    buffer_load_dwordx4 v[148:151], v6, s[12:15], s34 offen
    buffer_load_dwordx4 v[152:155], v7, s[12:15], s34 offen
    buffer_load_dwordx4 v[156:159], v8, s[12:15], s34 offen
    s_add_u32 s33, s33, 128
    s_add_u32 s34, s34, 524288
    ds_read_b128 v[160:163], v11 offset:0
    ds_read_b128 v[164:167], v11 offset:4608
    ds_read_b64_tr_b16 v[168:169], v12 offset:0
    ds_read_b64_tr_b16 v[170:171], v12 offset:1280
    ds_read_b64_tr_b16 v[172:173], v12 offset:64
    ds_read_b64_tr_b16 v[174:175], v12 offset:1344
    ds_read_b128 v[176:179], v11 offset:32
    ds_read_b128 v[180:183], v11 offset:4640
    ds_read_b64_tr_b16 v[184:185], v12 offset:5120
    ds_read_b64_tr_b16 v[186:187], v12 offset:6400
    ds_read_b64_tr_b16 v[188:189], v12 offset:5184
    ds_read_b64_tr_b16 v[190:191], v12 offset:6464
    s_waitcnt lgkmcnt(6)
    v_mfma_f32_32x32x16_bf16 v[64:79], v[168:171], v[160:163], v[64:79]
    v_mfma_f32_32x32x16_bf16 v[80:95], v[172:175], v[160:163], v[80:95]
    v_mfma_f32_32x32x16_bf16 v[96:111], v[168:171], v[164:167], v[96:111]
    v_mfma_f32_32x32x16_bf16 v[112:127], v[172:175], v[164:167], v[112:127]
    ds_read_b128 v[160:163], v11 offset:64
    ds_read_b128 v[164:167], v11 offset:4672
    ds_read_b64_tr_b16 v[168:169], v12 offset:10240
    ds_read_b64_tr_b16 v[170:171], v12 offset:11520
    ds_read_b64_tr_b16 v[172:173], v12 offset:10304
    ds_read_b64_tr_b16 v[174:175], v12 offset:11584
    s_waitcnt lgkmcnt(6)
    v_mfma_f32_32x32x16_bf16 v[64:79], v[184:187], v[176:179], v[64:79]
    v_mfma_f32_32x32x16_bf16 v[80:95], v[188:191], v[176:179], v[80:95]
    v_mfma_f32_32x32x16_bf16 v[96:111], v[184:187], v[180:183], v[96:111]
    v_mfma_f32_32x32x16_bf16 v[112:127], v[188:191], v[180:183], v[112:127]
    ds_read_b128 v[176:179], v11 offset:96
    ds_read_b128 v[180:183], v11 offset:4704
    ds_read_b64_tr_b16 v[184:185], v12 offset:15360
    ds_read_b64_tr_b16 v[186:187], v12 offset:16640
    ds_read_b64_tr_b16 v[188:189], v12 offset:15424
    ds_read_b64_tr_b16 v[190:191], v12 offset:16704
    s_waitcnt lgkmcnt(6)
    v_mfma_f32_32x32x16_bf16 v[64:79], v[168:171], v[160:163], v[64:79]
    v_mfma_f32_32x32x16_bf16 v[80:95], v[172:175], v[160:163], v[80:95]
    v_mfma_f32_32x32x16_bf16 v[96:111], v[168:171], v[164:167], v[96:111]
    v_mfma_f32_32x32x16_bf16 v[112:127], v[172:175], v[164:167], v[112:127]
    s_waitcnt lgkmcnt(0)
    v_mfma_f32_32x32x16_bf16 v[64:79], v[184:187], v[176:179], v[64:79]
    v_mfma_f32_32x32x16_bf16 v[80:95], v[188:191], v[176:179], v[80:95]
    v_mfma_f32_32x32x16_bf16 v[96:111], v[184:187], v[180:183], v[96:111]
    v_mfma_f32_32x32x16_bf16 v[112:127], v[188:191], v[180:183], v[112:127]
    s_waitcnt vmcnt(8)
    ds_write_b128 v9, v[192:195] offset:40960
    ds_write_b128 v9, v[196:199] offset:45568
    ds_write_b128 v9, v[200:203] offset:50176
    ds_write_b128 v9, v[204:207] offset:54784
    ds_write_b128 v10, v[208:211] offset:40960
    ds_write_b128 v10, v[212:215] offset:46080
    ds_write_b128 v10, v[216:219] offset:51200
    ds_write_b128 v10, v[220:223] offset:56320
    s_waitcnt lgkmcnt(0)
    s_barrier
    buffer_load_dwordx4 v[192:195], v1, s[8:11], s33 offen
    buffer_load_dwordx4 v[196:199], v2, s[8:11], s33 offen
    buffer_load_dwordx4 v[200:203], v3, s[8:11], s33 offen
    buffer_load_dwordx4 v[204:207], v4, s[8:11], s33 offen
    buffer_load_dwordx4 v[208:211], v5, s[12:15], s34 offen
    buffer_load_dwordx4 v[212:215], v6, s[12:15], s34 offen
    buffer_load_dwordx4 v[216:219], v7, s[12:15], s34 offen
    buffer_load_dwordx4 v[220:223], v8, s[12:15], s34 offen
    s_add_u32 s33, s33, 128
    s_add_u32 s34, s34, 524288
    ds_read_b128 v[160:163], v11 offset:40960
    ds_read_b128 v[164:167], v11 offset:45568
    ds_read_b64_tr_b16 v[168:169], v12 offset:40960
    ds_read_b64_tr_b16 v[170:171], v12 offset:42240
    ds_read_b64_tr_b16 v[172:173], v12 offset:41024
    ds_read_b64_tr_b16 v[174:175], v12 offset:42304
    ds_read_b128 v[176:179], v11 offset:40992
    ds_read_b128 v[180:183], v11 offset:45600
    ds_read_b64_tr_b16 v[184:185], v12 offset:46080
    ds_read_b64_tr_b16 v[186:187], v12 offset:47360
    ds_read_b64_tr_b16 v[188:189], v12 offset:46144
    ds_read_b64_tr_b16 v[190:191], v12 offset:47424
    s_waitcnt lgkmcnt(6)
    v_mfma_f32_32x32x16_bf16 v[64:79], v[168:171], v[160:163], v[64:79]
    v_mfma_f32_32x32x16_bf16 v[80:95], v[172:175], v[160:163], v[80:95]
    v_mfma_f32_32x32x16_bf16 v[96:111], v[168:171], v[164:167], v[96:111]
    v_mfma_f32_32x32x16_bf16 v[112:127], v[172:175], v[164:167], v[112:127]
    ds_read_b128 v[160:163], v11 offset:41024
    ds_read_b128 v[164:167], v11 offset:45632
    ds_read_b64_tr_b16 v[168:169], v12 offset:51200
    ds_read_b64_tr_b16 v[170:171], v12 offset:52480
    ds_read_b64_tr_b16 v[172:173], v12 offset:51264
    ds_read_b64_tr_b16 v[174:175], v12 offset:52544
    s_waitcnt lgkmcnt(6)
    v_mfma_f32_32x32x16_bf16 v[64:79], v[184:187], v[176:179], v[64:79]
    v_mfma_f32_32x32x16_bf16 v[80:95], v[188:191], v[176:179], v[80:95]
    v_mfma_f32_32x32x16_bf16 v[96:111], v[184:187], v[180:183], v[96:111]
    v_mfma_f32_32x32x16_bf16 v[112:127], v[188:191], v[180:183], v[112:127]
    ds_read_b128 v[176:179], v11 offset:41056
    ds_read_b128 v[180:183], v11 offset:45664
    ds_read_b64_tr_b16 v[184:185], v12 offset:56320
    ds_read_b64_tr_b16 v[186:187], v12 offset:57600
    ds_read_b64_tr_b16 v[188:189], v12 offset:56384
    ds_read_b64_tr_b16 v[190:191], v12 offset:57664
    s_waitcnt lgkmcnt(6)
    v_mfma_f32_32x32x16_bf16 v[64:79], v[168:171], v[160:163], v[64:79]
    v_mfma_f32_32x32x16_bf16 v[80:95], v[172:175], v[160:163], v[80:95]
    v_mfma_f32_32x32x16_bf16 v[96:111], v[168:171], v[164:167], v[96:111]
    v_mfma_f32_32x32x16_bf16 v[112:127], v[172:175], v[164:167], v[112:127]
    s_waitcnt lgkmcnt(0)
    v_mfma_f32_32x32x16_bf16 v[64:79], v[184:187], v[176:179], v[64:79]
    v_mfma_f32_32x32x16_bf16 v[80:95], v[188:191], v[176:179], v[80:95]
    v_mfma_f32_32x32x16_bf16 v[96:111], v[184:187], v[180:183], v[96:111]
    v_mfma_f32_32x32x16_bf16 v[112:127], v[188:191], v[180:183], v[112:127]
    s_waitcnt vmcnt(8)
    ds_write_b128 v9, v[128:131] offset:0
    ds_write_b128 v9, v[132:135] offset:4608
    ds_write_b128 v9, v[136:139] offset:9216
    ds_write_b128 v9, v[140:143] offset:13824
    ds_write_b128 v10, v[144:147] offset:0
    ds_write_b128 v10, v[148:151] offset:5120
    ds_write_b128 v10, v[152:155] offset:10240
    ds_write_b128 v10, v[156:159] offset:15360
    s_waitcnt lgkmcnt(0)
    s_barrier
    ds_read_b128 v[160:163], v11 offset:0
    ds_read_b128 v[164:167], v11 offset:4608
    ds_read_b64_tr_b16 v[168:169], v12 offset:0
    ds_read_b64_tr_b16 v[170:171], v12 offset:1280
    ds_read_b64_tr_b16 v[172:173], v12 offset:64
    ds_read_b64_tr_b16 v[174:175], v12 offset:1344
    ds_read_b128 v[176:179], v11 offset:32
    ds_read_b128 v[180:183], v11 offset:4640
    ds_read_b64_tr_b16 v[184:185], v12 offset:5120
    ds_read_b64_tr_b16 v[186:187], v12 offset:6400
    ds_read_b64_tr_b16 v[188:189], v12 offset:5184
    ds_read_b64_tr_b16 v[190:191], v12 offset:6464
    s_waitcnt lgkmcnt(6)
    v_mfma_f32_32x32x16_bf16 v[64:79], v[168:171], v[160:163], v[64:79]
    v_mfma_f32_32x32x16_bf16 v[80:95], v[172:175], v[160:163], v[80:95]
    v_mfma_f32_32x32x16_bf16 v[96:111], v[168:171], v[164:167], v[96:111]
    v_mfma_f32_32x32x16_bf16 v[112:127], v[172:175], v[164:167], v[112:127]
    ds_read_b128 v[160:163], v11 offset:64
    ds_read_b128 v[164:167], v11 offset:4672
    ds_read_b64_tr_b16 v[168:169], v12 offset:10240
    ds_read_b64_tr_b16 v[170:171], v12 offset:11520
    ds_read_b64_tr_b16 v[172:173], v12 offset:10304
    ds_read_b64_tr_b16 v[174:175], v12 offset:11584
    s_waitcnt lgkmcnt(6)
    v_mfma_f32_32x32x16_bf16 v[64:79], v[184:187], v[176:179], v[64:79]
    v_mfma_f32_32x32x16_bf16 v[80:95], v[188:191], v[176:179], v[80:95]
    v_mfma_f32_32x32x16_bf16 v[96:111], v[184:187], v[180:183], v[96:111]
    v_mfma_f32_32x32x16_bf16 v[112:127], v[188:191], v[180:183], v[112:127]
    ds_read_b128 v[176:179], v11 offset:96
    ds_read_b128 v[180:183], v11 offset:4704
    ds_read_b64_tr_b16 v[184:185], v12 offset:15360
    ds_read_b64_tr_b16 v[186:187], v12 offset:16640
    ds_read_b64_tr_b16 v[188:189], v12 offset:15424
    ds_read_b64_tr_b16 v[190:191], v12 offset:16704
    s_waitcnt lgkmcnt(6)
    v_mfma_f32_32x32x16_bf16 v[64:79], v[168:171], v[160:163], v[64:79]
    v_mfma_f32_32x32x16_bf16 v[80:95], v[172:175], v[160:163], v[80:95]
    v_mfma_f32_32x32x16_bf16 v[96:111], v[168:171], v[164:167], v[96:111]
    v_mfma_f32_32x32x16_bf16 v[112:127], v[172:175], v[164:167], v[112:127]
    s_waitcnt lgkmcnt(0)
    v_mfma_f32_32x32x16_bf16 v[64:79], v[184:187], v[176:179], v[64:79]
    v_mfma_f32_32x32x16_bf16 v[80:95], v[188:191], v[176:179], v[80:95]
    v_mfma_f32_32x32x16_bf16 v[96:111], v[184:187], v[180:183], v[96:111]
    v_mfma_f32_32x32x16_bf16 v[112:127], v[188:191], v[180:183], v[112:127]
    s_waitcnt vmcnt(0)
    ds_write_b128 v9, v[192:195] offset:40960
    ds_write_b128 v9, v[196:199] offset:45568
    ds_write_b128 v9, v[200:203] offset:50176
    ds_write_b128 v9, v[204:207] offset:54784
    ds_write_b128 v10, v[208:211] offset:40960
    ds_write_b128 v10, v[212:215] offset:46080
    ds_write_b128 v10, v[216:219] offset:51200
    ds_write_b128 v10, v[220:223] offset:56320
    s_waitcnt lgkmcnt(0)
    s_barrier
    ds_read_b128 v[160:163], v11 offset:40960
    ds_read_b128 v[164:167], v11 offset:45568
    ds_read_b64_tr_b16 v[168:169], v12 offset:40960
    ds_read_b64_tr_b16 v[170:171], v12 offset:42240
    ds_read_b64_tr_b16 v[172:173], v12 offset:41024
    ds_read_b64_tr_b16 v[174:175], v12 offset:42304
    ds_read_b128 v[176:179], v11 offset:40992
    ds_read_b128 v[180:183], v11 offset:45600
    ds_read_b64_tr_b16 v[184:185], v12 offset:46080
    ds_read_b64_tr_b16 v[186:187], v12 offset:47360
    ds_read_b64_tr_b16 v[188:189], v12 offset:46144
    ds_read_b64_tr_b16 v[190:191], v12 offset:47424
    s_waitcnt lgkmcnt(6)
    v_mfma_f32_32x32x16_bf16 v[64:79], v[168:171], v[160:163], v[64:79]
    v_mfma_f32_32x32x16_bf16 v[80:95], v[172:175], v[160:163], v[80:95]
    v_mfma_f32_32x32x16_bf16 v[96:111], v[168:171], v[164:167], v[96:111]
    v_mfma_f32_32x32x16_bf16 v[112:127], v[172:175], v[164:167], v[112:127]
    ds_read_b128 v[160:163], v11 offset:41024
    ds_read_b128 v[164:167], v11 offset:45632
    ds_read_b64_tr_b16 v[168:169], v12 offset:51200
    ds_read_b64_tr_b16 v[170:171], v12 offset:52480
    ds_read_b64_tr_b16 v[172:173], v12 offset:51264
    ds_read_b64_tr_b16 v[174:175], v12 offset:52544
    s_waitcnt lgkmcnt(6)
    v_mfma_f32_32x32x16_bf16 v[64:79], v[184:187], v[176:179], v[64:79]
    v_mfma_f32_32x32x16_bf16 v[80:95], v[188:191], v[176:179], v[80:95]
    v_mfma_f32_32x32x16_bf16 v[96:111], v[184:187], v[180:183], v[96:111]
    v_mfma_f32_32x32x16_bf16 v[112:127], v[188:191], v[180:183], v[112:127]
    ds_read_b128 v[176:179], v11 offset:41056
    ds_read_b128 v[180:183], v11 offset:45664
    ds_read_b64_tr_b16 v[184:185], v12 offset:56320
    ds_read_b64_tr_b16 v[186:187], v12 offset:57600
    ds_read_b64_tr_b16 v[188:189], v12 offset:56384
    ds_read_b64_tr_b16 v[190:191], v12 offset:57664
    s_waitcnt lgkmcnt(6)
    v_mfma_f32_32x32x16_bf16 v[64:79], v[168:171], v[160:163], v[64:79]
    v_mfma_f32_32x32x16_bf16 v[80:95], v[172:175], v[160:163], v[80:95]
    v_mfma_f32_32x32x16_bf16 v[96:111], v[168:171], v[164:167], v[96:111]
    v_mfma_f32_32x32x16_bf16 v[112:127], v[172:175], v[164:167], v[112:127]
    s_waitcnt lgkmcnt(0)
    v_mfma_f32_32x32x16_bf16 v[64:79], v[184:187], v[176:179], v[64:79]
    v_mfma_f32_32x32x16_bf16 v[80:95], v[188:191], v[176:179], v[80:95]
    v_mfma_f32_32x32x16_bf16 v[96:111], v[184:187], v[180:183], v[96:111]
    v_mfma_f32_32x32x16_bf16 v[112:127], v[188:191], v[180:183], v[112:127]
    s_nop 15
    s_nop 3
    v_and_b32 v22, 31, v13
    v_lshl_add_u32 v22, v15, 6, v22
    v_add_u32 v22, s38, v22
    s_mov_b32 s39, 8192
    v_mul_lo_u32 v22, v22, s39
    v_lshrrev_b32 v23, 5, v13
    v_lshl_add_u32 v22, v23, 3, v22
    v_add_u32 v22, s37, v22
    v_mul_u32_u24 v23, 128, v16
    v_add_u32 v22, v22, v23
    s_mov_b32 s40, 4194304
    s_mov_b32 s41, 20971520
    s_cmp_eq_u32 s35, 1
    s_cselect_b32 s40, s41, s40
    v_mov_b32 v23, v22
    v_cvt_pk_bf16_f32 v24, v64, v65
    v_cvt_pk_bf16_f32 v25, v66, v67
    buffer_store_dwordx2 v[24:25], v23, s[20:23], s40 offen offset:0 sc1
    s_nop 1
    v_cvt_pk_bf16_f32 v24, v68, v69
    v_cvt_pk_bf16_f32 v25, v70, v71
    buffer_store_dwordx2 v[24:25], v23, s[20:23], s40 offen offset:16 sc1
    s_nop 1
    v_cvt_pk_bf16_f32 v24, v72, v73
    v_cvt_pk_bf16_f32 v25, v74, v75
    buffer_store_dwordx2 v[24:25], v23, s[20:23], s40 offen offset:32 sc1
    s_nop 1
    v_cvt_pk_bf16_f32 v24, v76, v77
    v_cvt_pk_bf16_f32 v25, v78, v79
    buffer_store_dwordx2 v[24:25], v23, s[20:23], s40 offen offset:48 sc1
    s_nop 1
    v_cvt_pk_bf16_f32 v24, v80, v81
    v_cvt_pk_bf16_f32 v25, v82, v83
    buffer_store_dwordx2 v[24:25], v23, s[20:23], s40 offen offset:64 sc1
    s_nop 1
    v_cvt_pk_bf16_f32 v24, v84, v85
    v_cvt_pk_bf16_f32 v25, v86, v87
    buffer_store_dwordx2 v[24:25], v23, s[20:23], s40 offen offset:80 sc1
    s_nop 1
    v_cvt_pk_bf16_f32 v24, v88, v89
    v_cvt_pk_bf16_f32 v25, v90, v91
    buffer_store_dwordx2 v[24:25], v23, s[20:23], s40 offen offset:96 sc1
    s_nop 1
    v_cvt_pk_bf16_f32 v24, v92, v93
    v_cvt_pk_bf16_f32 v25, v94, v95
    buffer_store_dwordx2 v[24:25], v23, s[20:23], s40 offen offset:112 sc1
    s_nop 1
    v_add_u32 v23, 262144, v22
    v_cvt_pk_bf16_f32 v24, v96, v97
    v_cvt_pk_bf16_f32 v25, v98, v99
    buffer_store_dwordx2 v[24:25], v23, s[20:23], s40 offen offset:0 sc1
    s_nop 1
    v_cvt_pk_bf16_f32 v24, v100, v101
    v_cvt_pk_bf16_f32 v25, v102, v103
    buffer_store_dwordx2 v[24:25], v23, s[20:23], s40 offen offset:16 sc1
    s_nop 1
    v_cvt_pk_bf16_f32 v24, v104, v105
    v_cvt_pk_bf16_f32 v25, v106, v107
    buffer_store_dwordx2 v[24:25], v23, s[20:23], s40 offen offset:32 sc1
    s_nop 1
    v_cvt_pk_bf16_f32 v24, v108, v109
    v_cvt_pk_bf16_f32 v25, v110, v111
    buffer_store_dwordx2 v[24:25], v23, s[20:23], s40 offen offset:48 sc1
    s_nop 1
    v_cvt_pk_bf16_f32 v24, v112, v113
    v_cvt_pk_bf16_f32 v25, v114, v115
    buffer_store_dwordx2 v[24:25], v23, s[20:23], s40 offen offset:64 sc1
    s_nop 1
    v_cvt_pk_bf16_f32 v24, v116, v117
    v_cvt_pk_bf16_f32 v25, v118, v119
    buffer_store_dwordx2 v[24:25], v23, s[20:23], s40 offen offset:80 sc1
    s_nop 1
    v_cvt_pk_bf16_f32 v24, v120, v121
    v_cvt_pk_bf16_f32 v25, v122, v123
    buffer_store_dwordx2 v[24:25], v23, s[20:23], s40 offen offset:96 sc1
    s_nop 1
    v_cvt_pk_bf16_f32 v24, v124, v125
    v_cvt_pk_bf16_f32 v25, v126, v127
    buffer_store_dwordx2 v[24:25], v23, s[20:23], s40 offen offset:112 sc1
    s_nop 1
    s_branch chain_kernel_done32
chain_kernel_vpath33:
    buffer_load_dwordx4 v[128:131], v1, s[8:11], s33 offen
    buffer_load_dwordx4 v[132:135], v2, s[8:11], s33 offen
    buffer_load_dwordx4 v[136:139], v3, s[8:11], s33 offen
    buffer_load_dwordx4 v[140:143], v4, s[8:11], s33 offen
    buffer_load_dwordx4 v[144:147], v5, s[12:15], s34 offen
    buffer_load_dwordx4 v[148:151], v6, s[12:15], s34 offen
    buffer_load_dwordx4 v[152:155], v7, s[12:15], s34 offen
    buffer_load_dwordx4 v[156:159], v8, s[12:15], s34 offen
    s_add_u32 s33, s33, 128
    s_add_u32 s34, s34, 524288
    ds_read_b128 v[160:163], v11 offset:0
    ds_read_b128 v[164:167], v11 offset:4608
    ds_read_b64_tr_b16 v[168:169], v12 offset:0
    ds_read_b64_tr_b16 v[170:171], v12 offset:1280
    ds_read_b64_tr_b16 v[172:173], v12 offset:64
    ds_read_b64_tr_b16 v[174:175], v12 offset:1344
    ds_read_b128 v[176:179], v11 offset:32
    ds_read_b128 v[180:183], v11 offset:4640
    ds_read_b64_tr_b16 v[184:185], v12 offset:5120
    ds_read_b64_tr_b16 v[186:187], v12 offset:6400
    ds_read_b64_tr_b16 v[188:189], v12 offset:5184
    ds_read_b64_tr_b16 v[190:191], v12 offset:6464
    s_waitcnt lgkmcnt(6)
    v_mfma_f32_32x32x16_bf16 v[64:79], v[160:163], v[168:171], v[64:79]
    v_mfma_f32_32x32x16_bf16 v[80:95], v[160:163], v[172:175], v[80:95]
    v_mfma_f32_32x32x16_bf16 v[96:111], v[164:167], v[168:171], v[96:111]
    v_mfma_f32_32x32x16_bf16 v[112:127], v[164:167], v[172:175], v[112:127]
    ds_read_b128 v[160:163], v11 offset:64
    ds_read_b128 v[164:167], v11 offset:4672
    ds_read_b64_tr_b16 v[168:169], v12 offset:10240
    ds_read_b64_tr_b16 v[170:171], v12 offset:11520
    ds_read_b64_tr_b16 v[172:173], v12 offset:10304
    ds_read_b64_tr_b16 v[174:175], v12 offset:11584
    s_waitcnt lgkmcnt(6)
    v_mfma_f32_32x32x16_bf16 v[64:79], v[176:179], v[184:187], v[64:79]
    v_mfma_f32_32x32x16_bf16 v[80:95], v[176:179], v[188:191], v[80:95]
    v_mfma_f32_32x32x16_bf16 v[96:111], v[180:183], v[184:187], v[96:111]
    v_mfma_f32_32x32x16_bf16 v[112:127], v[180:183], v[188:191], v[112:127]
    ds_read_b128 v[176:179], v11 offset:96
    ds_read_b128 v[180:183], v11 offset:4704
    ds_read_b64_tr_b16 v[184:185], v12 offset:15360
    ds_read_b64_tr_b16 v[186:187], v12 offset:16640
    ds_read_b64_tr_b16 v[188:189], v12 offset:15424
    ds_read_b64_tr_b16 v[190:191], v12 offset:16704
    s_waitcnt lgkmcnt(6)
    v_mfma_f32_32x32x16_bf16 v[64:79], v[160:163], v[168:171], v[64:79]
    v_mfma_f32_32x32x16_bf16 v[80:95], v[160:163], v[172:175], v[80:95]
    v_mfma_f32_32x32x16_bf16 v[96:111], v[164:167], v[168:171], v[96:111]
    v_mfma_f32_32x32x16_bf16 v[112:127], v[164:167], v[172:175], v[112:127]
    s_waitcnt lgkmcnt(0)
    v_mfma_f32_32x32x16_bf16 v[64:79], v[176:179], v[184:187], v[64:79]
    v_mfma_f32_32x32x16_bf16 v[80:95], v[176:179], v[188:191], v[80:95]
    v_mfma_f32_32x32x16_bf16 v[96:111], v[180:183], v[184:187], v[96:111]
    v_mfma_f32_32x32x16_bf16 v[112:127], v[180:183], v[188:191], v[112:127]
    s_waitcnt vmcnt(8)
    ds_write_b128 v9, v[192:195] offset:40960
    ds_write_b128 v9, v[196:199] offset:45568
    ds_write_b128 v9, v[200:203] offset:50176
    ds_write_b128 v9, v[204:207] offset:54784
    ds_write_b128 v10, v[208:211] offset:40960
    ds_write_b128 v10, v[212:215] offset:46080
    ds_write_b128 v10, v[216:219] offset:51200
    ds_write_b128 v10, v[220:223] offset:56320
    s_waitcnt lgkmcnt(0)
    s_barrier
    buffer_load_dwordx4 v[192:195], v1, s[8:11], s33 offen
    buffer_load_dwordx4 v[196:199], v2, s[8:11], s33 offen
    buffer_load_dwordx4 v[200:203], v3, s[8:11], s33 offen
    buffer_load_dwordx4 v[204:207], v4, s[8:11], s33 offen
    buffer_load_dwordx4 v[208:211], v5, s[12:15], s34 offen
    buffer_load_dwordx4 v[212:215], v6, s[12:15], s34 offen
    buffer_load_dwordx4 v[216:219], v7, s[12:15], s34 offen
    buffer_load_dwordx4 v[220:223], v8, s[12:15], s34 offen
    s_add_u32 s33, s33, 128
    s_add_u32 s34, s34, 524288
    ds_read_b128 v[160:163], v11 offset:40960
    ds_read_b128 v[164:167], v11 offset:45568
    ds_read_b64_tr_b16 v[168:169], v12 offset:40960
    ds_read_b64_tr_b16 v[170:171], v12 offset:42240
    ds_read_b64_tr_b16 v[172:173], v12 offset:41024
    ds_read_b64_tr_b16 v[174:175], v12 offset:42304
    ds_read_b128 v[176:179], v11 offset:40992
    ds_read_b128 v[180:183], v11 offset:45600
    ds_read_b64_tr_b16 v[184:185], v12 offset:46080
    ds_read_b64_tr_b16 v[186:187], v12 offset:47360
    ds_read_b64_tr_b16 v[188:189], v12 offset:46144
    ds_read_b64_tr_b16 v[190:191], v12 offset:47424
    s_waitcnt lgkmcnt(6)
    v_mfma_f32_32x32x16_bf16 v[64:79], v[160:163], v[168:171], v[64:79]
    v_mfma_f32_32x32x16_bf16 v[80:95], v[160:163], v[172:175], v[80:95]
    v_mfma_f32_32x32x16_bf16 v[96:111], v[164:167], v[168:171], v[96:111]
    v_mfma_f32_32x32x16_bf16 v[112:127], v[164:167], v[172:175], v[112:127]
    ds_read_b128 v[160:163], v11 offset:41024
    ds_read_b128 v[164:167], v11 offset:45632
    ds_read_b64_tr_b16 v[168:169], v12 offset:51200
    ds_read_b64_tr_b16 v[170:171], v12 offset:52480
    ds_read_b64_tr_b16 v[172:173], v12 offset:51264
    ds_read_b64_tr_b16 v[174:175], v12 offset:52544
    s_waitcnt lgkmcnt(6)
    v_mfma_f32_32x32x16_bf16 v[64:79], v[176:179], v[184:187], v[64:79]
    v_mfma_f32_32x32x16_bf16 v[80:95], v[176:179], v[188:191], v[80:95]
    v_mfma_f32_32x32x16_bf16 v[96:111], v[180:183], v[184:187], v[96:111]
    v_mfma_f32_32x32x16_bf16 v[112:127], v[180:183], v[188:191], v[112:127]
    ds_read_b128 v[176:179], v11 offset:41056
    ds_read_b128 v[180:183], v11 offset:45664
    ds_read_b64_tr_b16 v[184:185], v12 offset:56320
    ds_read_b64_tr_b16 v[186:187], v12 offset:57600
    ds_read_b64_tr_b16 v[188:189], v12 offset:56384
    ds_read_b64_tr_b16 v[190:191], v12 offset:57664
    s_waitcnt lgkmcnt(6)
    v_mfma_f32_32x32x16_bf16 v[64:79], v[160:163], v[168:171], v[64:79]
    v_mfma_f32_32x32x16_bf16 v[80:95], v[160:163], v[172:175], v[80:95]
    v_mfma_f32_32x32x16_bf16 v[96:111], v[164:167], v[168:171], v[96:111]
    v_mfma_f32_32x32x16_bf16 v[112:127], v[164:167], v[172:175], v[112:127]
    s_waitcnt lgkmcnt(0)
    v_mfma_f32_32x32x16_bf16 v[64:79], v[176:179], v[184:187], v[64:79]
    v_mfma_f32_32x32x16_bf16 v[80:95], v[176:179], v[188:191], v[80:95]
    v_mfma_f32_32x32x16_bf16 v[96:111], v[180:183], v[184:187], v[96:111]
    v_mfma_f32_32x32x16_bf16 v[112:127], v[180:183], v[188:191], v[112:127]
    s_waitcnt vmcnt(8)
    ds_write_b128 v9, v[128:131] offset:0
    ds_write_b128 v9, v[132:135] offset:4608
    ds_write_b128 v9, v[136:139] offset:9216
    ds_write_b128 v9, v[140:143] offset:13824
    ds_write_b128 v10, v[144:147] offset:0
    ds_write_b128 v10, v[148:151] offset:5120
    ds_write_b128 v10, v[152:155] offset:10240
    ds_write_b128 v10, v[156:159] offset:15360
    s_waitcnt lgkmcnt(0)
    s_barrier
    buffer_load_dwordx4 v[128:131], v1, s[8:11], s33 offen
    buffer_load_dwordx4 v[132:135], v2, s[8:11], s33 offen
    buffer_load_dwordx4 v[136:139], v3, s[8:11], s33 offen
    buffer_load_dwordx4 v[140:143], v4, s[8:11], s33 offen
    buffer_load_dwordx4 v[144:147], v5, s[12:15], s34 offen
    buffer_load_dwordx4 v[148:151], v6, s[12:15], s34 offen
    buffer_load_dwordx4 v[152:155], v7, s[12:15], s34 offen
    buffer_load_dwordx4 v[156:159], v8, s[12:15], s34 offen
    s_add_u32 s33, s33, 128
    s_add_u32 s34, s34, 524288
    ds_read_b128 v[160:163], v11 offset:0
    ds_read_b128 v[164:167], v11 offset:4608
    ds_read_b64_tr_b16 v[168:169], v12 offset:0
    ds_read_b64_tr_b16 v[170:171], v12 offset:1280
    ds_read_b64_tr_b16 v[172:173], v12 offset:64
    ds_read_b64_tr_b16 v[174:175], v12 offset:1344
    ds_read_b128 v[176:179], v11 offset:32
    ds_read_b128 v[180:183], v11 offset:4640
    ds_read_b64_tr_b16 v[184:185], v12 offset:5120
    ds_read_b64_tr_b16 v[186:187], v12 offset:6400
    ds_read_b64_tr_b16 v[188:189], v12 offset:5184
    ds_read_b64_tr_b16 v[190:191], v12 offset:6464
    s_waitcnt lgkmcnt(6)
    v_mfma_f32_32x32x16_bf16 v[64:79], v[160:163], v[168:171], v[64:79]
    v_mfma_f32_32x32x16_bf16 v[80:95], v[160:163], v[172:175], v[80:95]
    v_mfma_f32_32x32x16_bf16 v[96:111], v[164:167], v[168:171], v[96:111]
    v_mfma_f32_32x32x16_bf16 v[112:127], v[164:167], v[172:175], v[112:127]
    ds_read_b128 v[160:163], v11 offset:64
    ds_read_b128 v[164:167], v11 offset:4672
    ds_read_b64_tr_b16 v[168:169], v12 offset:10240
    ds_read_b64_tr_b16 v[170:171], v12 offset:11520
    ds_read_b64_tr_b16 v[172:173], v12 offset:10304
    ds_read_b64_tr_b16 v[174:175], v12 offset:11584
    s_waitcnt lgkmcnt(6)
    v_mfma_f32_32x32x16_bf16 v[64:79], v[176:179], v[184:187], v[64:79]
    v_mfma_f32_32x32x16_bf16 v[80:95], v[176:179], v[188:191], v[80:95]
    v_mfma_f32_32x32x16_bf16 v[96:111], v[180:183], v[184:187], v[96:111]
    v_mfma_f32_32x32x16_bf16 v[112:127], v[180:183], v[188:191], v[112:127]
    ds_read_b128 v[176:179], v11 offset:96
    ds_read_b128 v[180:183], v11 offset:4704
    ds_read_b64_tr_b16 v[184:185], v12 offset:15360
    ds_read_b64_tr_b16 v[186:187], v12 offset:16640
    ds_read_b64_tr_b16 v[188:189], v12 offset:15424
    ds_read_b64_tr_b16 v[190:191], v12 offset:16704
    s_waitcnt lgkmcnt(6)
    v_mfma_f32_32x32x16_bf16 v[64:79], v[160:163], v[168:171], v[64:79]
    v_mfma_f32_32x32x16_bf16 v[80:95], v[160:163], v[172:175], v[80:95]
    v_mfma_f32_32x32x16_bf16 v[96:111], v[164:167], v[168:171], v[96:111]
    v_mfma_f32_32x32x16_bf16 v[112:127], v[164:167], v[172:175], v[112:127]
    s_waitcnt lgkmcnt(0)
    v_mfma_f32_32x32x16_bf16 v[64:79], v[176:179], v[184:187], v[64:79]
    v_mfma_f32_32x32x16_bf16 v[80:95], v[176:179], v[188:191], v[80:95]
    v_mfma_f32_32x32x16_bf16 v[96:111], v[180:183], v[184:187], v[96:111]
    v_mfma_f32_32x32x16_bf16 v[112:127], v[180:183], v[188:191], v[112:127]
    s_waitcnt vmcnt(8)
    ds_write_b128 v9, v[192:195] offset:40960
    ds_write_b128 v9, v[196:199] offset:45568
    ds_write_b128 v9, v[200:203] offset:50176
    ds_write_b128 v9, v[204:207] offset:54784
    ds_write_b128 v10, v[208:211] offset:40960
    ds_write_b128 v10, v[212:215] offset:46080
    ds_write_b128 v10, v[216:219] offset:51200
    ds_write_b128 v10, v[220:223] offset:56320
    s_waitcnt lgkmcnt(0)
    s_barrier
    buffer_load_dwordx4 v[192:195], v1, s[8:11], s33 offen
    buffer_load_dwordx4 v[196:199], v2, s[8:11], s33 offen
    buffer_load_dwordx4 v[200:203], v3, s[8:11], s33 offen
    buffer_load_dwordx4 v[204:207], v4, s[8:11], s33 offen
    buffer_load_dwordx4 v[208:211], v5, s[12:15], s34 offen
    buffer_load_dwordx4 v[212:215], v6, s[12:15], s34 offen
    buffer_load_dwordx4 v[216:219], v7, s[12:15], s34 offen
    buffer_load_dwordx4 v[220:223], v8, s[12:15], s34 offen
    s_add_u32 s33, s33, 128
    s_add_u32 s34, s34, 524288
    ds_read_b128 v[160:163], v11 offset:40960
    ds_read_b128 v[164:167], v11 offset:45568
    ds_read_b64_tr_b16 v[168:169], v12 offset:40960
    ds_read_b64_tr_b16 v[170:171], v12 offset:42240
    ds_read_b64_tr_b16 v[172:173], v12 offset:41024
    ds_read_b64_tr_b16 v[174:175], v12 offset:42304
    ds_read_b128 v[176:179], v11 offset:40992
    ds_read_b128 v[180:183], v11 offset:45600
    ds_read_b64_tr_b16 v[184:185], v12 offset:46080
    ds_read_b64_tr_b16 v[186:187], v12 offset:47360
    ds_read_b64_tr_b16 v[188:189], v12 offset:46144
    ds_read_b64_tr_b16 v[190:191], v12 offset:47424
    s_waitcnt lgkmcnt(6)
    v_mfma_f32_32x32x16_bf16 v[64:79], v[160:163], v[168:171], v[64:79]
    v_mfma_f32_32x32x16_bf16 v[80:95], v[160:163], v[172:175], v[80:95]
    v_mfma_f32_32x32x16_bf16 v[96:111], v[164:167], v[168:171], v[96:111]
    v_mfma_f32_32x32x16_bf16 v[112:127], v[164:167], v[172:175], v[112:127]
    ds_read_b128 v[160:163], v11 offset:41024
    ds_read_b128 v[164:167], v11 offset:45632
    ds_read_b64_tr_b16 v[168:169], v12 offset:51200
    ds_read_b64_tr_b16 v[170:171], v12 offset:52480
    ds_read_b64_tr_b16 v[172:173], v12 offset:51264
    ds_read_b64_tr_b16 v[174:175], v12 offset:52544
    s_waitcnt lgkmcnt(6)
    v_mfma_f32_32x32x16_bf16 v[64:79], v[176:179], v[184:187], v[64:79]
    v_mfma_f32_32x32x16_bf16 v[80:95], v[176:179], v[188:191], v[80:95]
    v_mfma_f32_32x32x16_bf16 v[96:111], v[180:183], v[184:187], v[96:111]
    v_mfma_f32_32x32x16_bf16 v[112:127], v[180:183], v[188:191], v[112:127]
    ds_read_b128 v[176:179], v11 offset:41056
    ds_read_b128 v[180:183], v11 offset:45664
    ds_read_b64_tr_b16 v[184:185], v12 offset:56320
    ds_read_b64_tr_b16 v[186:187], v12 offset:57600
    ds_read_b64_tr_b16 v[188:189], v12 offset:56384
    ds_read_b64_tr_b16 v[190:191], v12 offset:57664
    s_waitcnt lgkmcnt(6)
    v_mfma_f32_32x32x16_bf16 v[64:79], v[160:163], v[168:171], v[64:79]
    v_mfma_f32_32x32x16_bf16 v[80:95], v[160:163], v[172:175], v[80:95]
    v_mfma_f32_32x32x16_bf16 v[96:111], v[164:167], v[168:171], v[96:111]
    v_mfma_f32_32x32x16_bf16 v[112:127], v[164:167], v[172:175], v[112:127]
    s_waitcnt lgkmcnt(0)
    v_mfma_f32_32x32x16_bf16 v[64:79], v[176:179], v[184:187], v[64:79]
    v_mfma_f32_32x32x16_bf16 v[80:95], v[176:179], v[188:191], v[80:95]
    v_mfma_f32_32x32x16_bf16 v[96:111], v[180:183], v[184:187], v[96:111]
    v_mfma_f32_32x32x16_bf16 v[112:127], v[180:183], v[188:191], v[112:127]
    s_waitcnt vmcnt(8)
    ds_write_b128 v9, v[128:131] offset:0
    ds_write_b128 v9, v[132:135] offset:4608
    ds_write_b128 v9, v[136:139] offset:9216
    ds_write_b128 v9, v[140:143] offset:13824
    ds_write_b128 v10, v[144:147] offset:0
    ds_write_b128 v10, v[148:151] offset:5120
    ds_write_b128 v10, v[152:155] offset:10240
    ds_write_b128 v10, v[156:159] offset:15360
    s_waitcnt lgkmcnt(0)
    s_barrier
    buffer_load_dwordx4 v[128:131], v1, s[8:11], s33 offen
    buffer_load_dwordx4 v[132:135], v2, s[8:11], s33 offen
    buffer_load_dwordx4 v[136:139], v3, s[8:11], s33 offen
    buffer_load_dwordx4 v[140:143], v4, s[8:11], s33 offen
    buffer_load_dwordx4 v[144:147], v5, s[12:15], s34 offen
    buffer_load_dwordx4 v[148:151], v6, s[12:15], s34 offen
    buffer_load_dwordx4 v[152:155], v7, s[12:15], s34 offen
    buffer_load_dwordx4 v[156:159], v8, s[12:15], s34 offen
    s_add_u32 s33, s33, 128
    s_add_u32 s34, s34, 524288
    ds_read_b128 v[160:163], v11 offset:0
    ds_read_b128 v[164:167], v11 offset:4608
    ds_read_b64_tr_b16 v[168:169], v12 offset:0
    ds_read_b64_tr_b16 v[170:171], v12 offset:1280
    ds_read_b64_tr_b16 v[172:173], v12 offset:64
    ds_read_b64_tr_b16 v[174:175], v12 offset:1344
    ds_read_b128 v[176:179], v11 offset:32
    ds_read_b128 v[180:183], v11 offset:4640
    ds_read_b64_tr_b16 v[184:185], v12 offset:5120
    ds_read_b64_tr_b16 v[186:187], v12 offset:6400
    ds_read_b64_tr_b16 v[188:189], v12 offset:5184
    ds_read_b64_tr_b16 v[190:191], v12 offset:6464
    s_waitcnt lgkmcnt(6)
    v_mfma_f32_32x32x16_bf16 v[64:79], v[160:163], v[168:171], v[64:79]
    v_mfma_f32_32x32x16_bf16 v[80:95], v[160:163], v[172:175], v[80:95]
    v_mfma_f32_32x32x16_bf16 v[96:111], v[164:167], v[168:171], v[96:111]
    v_mfma_f32_32x32x16_bf16 v[112:127], v[164:167], v[172:175], v[112:127]
    ds_read_b128 v[160:163], v11 offset:64
    ds_read_b128 v[164:167], v11 offset:4672
    ds_read_b64_tr_b16 v[168:169], v12 offset:10240
    ds_read_b64_tr_b16 v[170:171], v12 offset:11520
    ds_read_b64_tr_b16 v[172:173], v12 offset:10304
    ds_read_b64_tr_b16 v[174:175], v12 offset:11584
    s_waitcnt lgkmcnt(6)
    v_mfma_f32_32x32x16_bf16 v[64:79], v[176:179], v[184:187], v[64:79]
    v_mfma_f32_32x32x16_bf16 v[80:95], v[176:179], v[188:191], v[80:95]
    v_mfma_f32_32x32x16_bf16 v[96:111], v[180:183], v[184:187], v[96:111]
    v_mfma_f32_32x32x16_bf16 v[112:127], v[180:183], v[188:191], v[112:127]
    ds_read_b128 v[176:179], v11 offset:96
    ds_read_b128 v[180:183], v11 offset:4704
    ds_read_b64_tr_b16 v[184:185], v12 offset:15360
    ds_read_b64_tr_b16 v[186:187], v12 offset:16640
    ds_read_b64_tr_b16 v[188:189], v12 offset:15424
    ds_read_b64_tr_b16 v[190:191], v12 offset:16704
    s_waitcnt lgkmcnt(6)
    v_mfma_f32_32x32x16_bf16 v[64:79], v[160:163], v[168:171], v[64:79]
    v_mfma_f32_32x32x16_bf16 v[80:95], v[160:163], v[172:175], v[80:95]
    v_mfma_f32_32x32x16_bf16 v[96:111], v[164:167], v[168:171], v[96:111]
    v_mfma_f32_32x32x16_bf16 v[112:127], v[164:167], v[172:175], v[112:127]
    s_waitcnt lgkmcnt(0)
    v_mfma_f32_32x32x16_bf16 v[64:79], v[176:179], v[184:187], v[64:79]
    v_mfma_f32_32x32x16_bf16 v[80:95], v[176:179], v[188:191], v[80:95]
    v_mfma_f32_32x32x16_bf16 v[96:111], v[180:183], v[184:187], v[96:111]
    v_mfma_f32_32x32x16_bf16 v[112:127], v[180:183], v[188:191], v[112:127]
    s_waitcnt vmcnt(8)
    ds_write_b128 v9, v[192:195] offset:40960
    ds_write_b128 v9, v[196:199] offset:45568
    ds_write_b128 v9, v[200:203] offset:50176
    ds_write_b128 v9, v[204:207] offset:54784
    ds_write_b128 v10, v[208:211] offset:40960
    ds_write_b128 v10, v[212:215] offset:46080
    ds_write_b128 v10, v[216:219] offset:51200
    ds_write_b128 v10, v[220:223] offset:56320
    s_waitcnt lgkmcnt(0)
    s_barrier
    buffer_load_dwordx4 v[192:195], v1, s[8:11], s33 offen
    buffer_load_dwordx4 v[196:199], v2, s[8:11], s33 offen
    buffer_load_dwordx4 v[200:203], v3, s[8:11], s33 offen
    buffer_load_dwordx4 v[204:207], v4, s[8:11], s33 offen
    buffer_load_dwordx4 v[208:211], v5, s[12:15], s34 offen
    buffer_load_dwordx4 v[212:215], v6, s[12:15], s34 offen
    buffer_load_dwordx4 v[216:219], v7, s[12:15], s34 offen
    buffer_load_dwordx4 v[220:223], v8, s[12:15], s34 offen
    s_add_u32 s33, s33, 128
    s_add_u32 s34, s34, 524288
    ds_read_b128 v[160:163], v11 offset:40960
    ds_read_b128 v[164:167], v11 offset:45568
    ds_read_b64_tr_b16 v[168:169], v12 offset:40960
    ds_read_b64_tr_b16 v[170:171], v12 offset:42240
    ds_read_b64_tr_b16 v[172:173], v12 offset:41024
    ds_read_b64_tr_b16 v[174:175], v12 offset:42304
    ds_read_b128 v[176:179], v11 offset:40992
    ds_read_b128 v[180:183], v11 offset:45600
    ds_read_b64_tr_b16 v[184:185], v12 offset:46080
    ds_read_b64_tr_b16 v[186:187], v12 offset:47360
    ds_read_b64_tr_b16 v[188:189], v12 offset:46144
    ds_read_b64_tr_b16 v[190:191], v12 offset:47424
    s_waitcnt lgkmcnt(6)
    v_mfma_f32_32x32x16_bf16 v[64:79], v[160:163], v[168:171], v[64:79]
    v_mfma_f32_32x32x16_bf16 v[80:95], v[160:163], v[172:175], v[80:95]
    v_mfma_f32_32x32x16_bf16 v[96:111], v[164:167], v[168:171], v[96:111]
    v_mfma_f32_32x32x16_bf16 v[112:127], v[164:167], v[172:175], v[112:127]
    ds_read_b128 v[160:163], v11 offset:41024
    ds_read_b128 v[164:167], v11 offset:45632
    ds_read_b64_tr_b16 v[168:169], v12 offset:51200
    ds_read_b64_tr_b16 v[170:171], v12 offset:52480
    ds_read_b64_tr_b16 v[172:173], v12 offset:51264
    ds_read_b64_tr_b16 v[174:175], v12 offset:52544
    s_waitcnt lgkmcnt(6)
    v_mfma_f32_32x32x16_bf16 v[64:79], v[176:179], v[184:187], v[64:79]
    v_mfma_f32_32x32x16_bf16 v[80:95], v[176:179], v[188:191], v[80:95]
    v_mfma_f32_32x32x16_bf16 v[96:111], v[180:183], v[184:187], v[96:111]
    v_mfma_f32_32x32x16_bf16 v[112:127], v[180:183], v[188:191], v[112:127]
    ds_read_b128 v[176:179], v11 offset:41056
    ds_read_b128 v[180:183], v11 offset:45664
    ds_read_b64_tr_b16 v[184:185], v12 offset:56320
    ds_read_b64_tr_b16 v[186:187], v12 offset:57600
    ds_read_b64_tr_b16 v[188:189], v12 offset:56384
    ds_read_b64_tr_b16 v[190:191], v12 offset:57664
    s_waitcnt lgkmcnt(6)
    v_mfma_f32_32x32x16_bf16 v[64:79], v[160:163], v[168:171], v[64:79]
    v_mfma_f32_32x32x16_bf16 v[80:95], v[160:163], v[172:175], v[80:95]
    v_mfma_f32_32x32x16_bf16 v[96:111], v[164:167], v[168:171], v[96:111]
    v_mfma_f32_32x32x16_bf16 v[112:127], v[164:167], v[172:175], v[112:127]
    s_waitcnt lgkmcnt(0)
    v_mfma_f32_32x32x16_bf16 v[64:79], v[176:179], v[184:187], v[64:79]
    v_mfma_f32_32x32x16_bf16 v[80:95], v[176:179], v[188:191], v[80:95]
    v_mfma_f32_32x32x16_bf16 v[96:111], v[180:183], v[184:187], v[96:111]
    v_mfma_f32_32x32x16_bf16 v[112:127], v[180:183], v[188:191], v[112:127]
    s_waitcnt vmcnt(8)
    ds_write_b128 v9, v[128:131] offset:0
    ds_write_b128 v9, v[132:135] offset:4608
    ds_write_b128 v9, v[136:139] offset:9216
    ds_write_b128 v9, v[140:143] offset:13824
    ds_write_b128 v10, v[144:147] offset:0
    ds_write_b128 v10, v[148:151] offset:5120
    ds_write_b128 v10, v[152:155] offset:10240
    ds_write_b128 v10, v[156:159] offset:15360
    s_waitcnt lgkmcnt(0)
    s_barrier
    ds_read_b128 v[160:163], v11 offset:0
    ds_read_b128 v[164:167], v11 offset:4608
    ds_read_b64_tr_b16 v[168:169], v12 offset:0
    ds_read_b64_tr_b16 v[170:171], v12 offset:1280
    ds_read_b64_tr_b16 v[172:173], v12 offset:64
    ds_read_b64_tr_b16 v[174:175], v12 offset:1344
    ds_read_b128 v[176:179], v11 offset:32
    ds_read_b128 v[180:183], v11 offset:4640
    ds_read_b64_tr_b16 v[184:185], v12 offset:5120
    ds_read_b64_tr_b16 v[186:187], v12 offset:6400
    ds_read_b64_tr_b16 v[188:189], v12 offset:5184
    ds_read_b64_tr_b16 v[190:191], v12 offset:6464
    s_waitcnt lgkmcnt(6)
    v_mfma_f32_32x32x16_bf16 v[64:79], v[160:163], v[168:171], v[64:79]
    v_mfma_f32_32x32x16_bf16 v[80:95], v[160:163], v[172:175], v[80:95]
    v_mfma_f32_32x32x16_bf16 v[96:111], v[164:167], v[168:171], v[96:111]
    v_mfma_f32_32x32x16_bf16 v[112:127], v[164:167], v[172:175], v[112:127]
    ds_read_b128 v[160:163], v11 offset:64
    ds_read_b128 v[164:167], v11 offset:4672
    ds_read_b64_tr_b16 v[168:169], v12 offset:10240
    ds_read_b64_tr_b16 v[170:171], v12 offset:11520
    ds_read_b64_tr_b16 v[172:173], v12 offset:10304
    ds_read_b64_tr_b16 v[174:175], v12 offset:11584
    s_waitcnt lgkmcnt(6)
    v_mfma_f32_32x32x16_bf16 v[64:79], v[176:179], v[184:187], v[64:79]
    v_mfma_f32_32x32x16_bf16 v[80:95], v[176:179], v[188:191], v[80:95]
    v_mfma_f32_32x32x16_bf16 v[96:111], v[180:183], v[184:187], v[96:111]
    v_mfma_f32_32x32x16_bf16 v[112:127], v[180:183], v[188:191], v[112:127]
    ds_read_b128 v[176:179], v11 offset:96
    ds_read_b128 v[180:183], v11 offset:4704
    ds_read_b64_tr_b16 v[184:185], v12 offset:15360
    ds_read_b64_tr_b16 v[186:187], v12 offset:16640
    ds_read_b64_tr_b16 v[188:189], v12 offset:15424
    ds_read_b64_tr_b16 v[190:191], v12 offset:16704
    s_waitcnt lgkmcnt(6)
    v_mfma_f32_32x32x16_bf16 v[64:79], v[160:163], v[168:171], v[64:79]
    v_mfma_f32_32x32x16_bf16 v[80:95], v[160:163], v[172:175], v[80:95]
    v_mfma_f32_32x32x16_bf16 v[96:111], v[164:167], v[168:171], v[96:111]
    v_mfma_f32_32x32x16_bf16 v[112:127], v[164:167], v[172:175], v[112:127]
    s_waitcnt lgkmcnt(0)
    v_mfma_f32_32x32x16_bf16 v[64:79], v[176:179], v[184:187], v[64:79]
    v_mfma_f32_32x32x16_bf16 v[80:95], v[176:179], v[188:191], v[80:95]
    v_mfma_f32_32x32x16_bf16 v[96:111], v[180:183], v[184:187], v[96:111]
    v_mfma_f32_32x32x16_bf16 v[112:127], v[180:183], v[188:191], v[112:127]
    s_waitcnt vmcnt(0)
    ds_write_b128 v9, v[192:195] offset:40960
    ds_write_b128 v9, v[196:199] offset:45568
    ds_write_b128 v9, v[200:203] offset:50176
    ds_write_b128 v9, v[204:207] offset:54784
    ds_write_b128 v10, v[208:211] offset:40960
    ds_write_b128 v10, v[212:215] offset:46080
    ds_write_b128 v10, v[216:219] offset:51200
    ds_write_b128 v10, v[220:223] offset:56320
    s_waitcnt lgkmcnt(0)
    s_barrier
    ds_read_b128 v[160:163], v11 offset:40960
    ds_read_b128 v[164:167], v11 offset:45568
    ds_read_b64_tr_b16 v[168:169], v12 offset:40960
    ds_read_b64_tr_b16 v[170:171], v12 offset:42240
    ds_read_b64_tr_b16 v[172:173], v12 offset:41024
    ds_read_b64_tr_b16 v[174:175], v12 offset:42304
    ds_read_b128 v[176:179], v11 offset:40992
    ds_read_b128 v[180:183], v11 offset:45600
    ds_read_b64_tr_b16 v[184:185], v12 offset:46080
    ds_read_b64_tr_b16 v[186:187], v12 offset:47360
    ds_read_b64_tr_b16 v[188:189], v12 offset:46144
    ds_read_b64_tr_b16 v[190:191], v12 offset:47424
    s_waitcnt lgkmcnt(6)
    v_mfma_f32_32x32x16_bf16 v[64:79], v[160:163], v[168:171], v[64:79]
    v_mfma_f32_32x32x16_bf16 v[80:95], v[160:163], v[172:175], v[80:95]
    v_mfma_f32_32x32x16_bf16 v[96:111], v[164:167], v[168:171], v[96:111]
    v_mfma_f32_32x32x16_bf16 v[112:127], v[164:167], v[172:175], v[112:127]
    ds_read_b128 v[160:163], v11 offset:41024
    ds_read_b128 v[164:167], v11 offset:45632
    ds_read_b64_tr_b16 v[168:169], v12 offset:51200
    ds_read_b64_tr_b16 v[170:171], v12 offset:52480
    ds_read_b64_tr_b16 v[172:173], v12 offset:51264
    ds_read_b64_tr_b16 v[174:175], v12 offset:52544
    s_waitcnt lgkmcnt(6)
    v_mfma_f32_32x32x16_bf16 v[64:79], v[176:179], v[184:187], v[64:79]
    v_mfma_f32_32x32x16_bf16 v[80:95], v[176:179], v[188:191], v[80:95]
    v_mfma_f32_32x32x16_bf16 v[96:111], v[180:183], v[184:187], v[96:111]
    v_mfma_f32_32x32x16_bf16 v[112:127], v[180:183], v[188:191], v[112:127]
    ds_read_b128 v[176:179], v11 offset:41056
    ds_read_b128 v[180:183], v11 offset:45664
    ds_read_b64_tr_b16 v[184:185], v12 offset:56320
    ds_read_b64_tr_b16 v[186:187], v12 offset:57600
    ds_read_b64_tr_b16 v[188:189], v12 offset:56384
    ds_read_b64_tr_b16 v[190:191], v12 offset:57664
    s_waitcnt lgkmcnt(6)
    v_mfma_f32_32x32x16_bf16 v[64:79], v[160:163], v[168:171], v[64:79]
    v_mfma_f32_32x32x16_bf16 v[80:95], v[160:163], v[172:175], v[80:95]
    v_mfma_f32_32x32x16_bf16 v[96:111], v[164:167], v[168:171], v[96:111]
    v_mfma_f32_32x32x16_bf16 v[112:127], v[164:167], v[172:175], v[112:127]
    s_waitcnt lgkmcnt(0)
    v_mfma_f32_32x32x16_bf16 v[64:79], v[176:179], v[184:187], v[64:79]
    v_mfma_f32_32x32x16_bf16 v[80:95], v[176:179], v[188:191], v[80:95]
    v_mfma_f32_32x32x16_bf16 v[96:111], v[180:183], v[184:187], v[96:111]
    v_mfma_f32_32x32x16_bf16 v[112:127], v[180:183], v[188:191], v[112:127]
    s_nop 15
    s_nop 3
    s_lshl_b32 s41, s28, 2
    v_lshl_add_u32 v22, v15, 1, s41
    v_lshlrev_b32 v22, 5, v22
    v_add_u32 v22, s36, v22
    v_lshlrev_b32 v22, 7, v22
    v_and_b32 v23, 31, v13
    v_lshl_add_u32 v23, v16, 6, v23
    v_add_u32 v22, v22, v23
    v_lshlrev_b32 v22, 6, v22
    v_lshrrev_b32 v23, 5, v13
    v_lshl_add_u32 v22, v23, 3, v22
    s_mov_b32 s40, 37748736
    v_mov_b32 v23, v22
    v_cvt_pk_bf16_f32 v24, v64, v65
    v_cvt_pk_bf16_f32 v25, v66, v67
    buffer_store_dwordx2 v[24:25], v23, s[20:23], s40 offen offset:0 sc1
    s_nop 1
    v_cvt_pk_bf16_f32 v24, v68, v69
    v_cvt_pk_bf16_f32 v25, v70, v71
    buffer_store_dwordx2 v[24:25], v23, s[20:23], s40 offen offset:16 sc1
    s_nop 1
    v_cvt_pk_bf16_f32 v24, v72, v73
    v_cvt_pk_bf16_f32 v25, v74, v75
    buffer_store_dwordx2 v[24:25], v23, s[20:23], s40 offen offset:32 sc1
    s_nop 1
    v_cvt_pk_bf16_f32 v24, v76, v77
    v_cvt_pk_bf16_f32 v25, v78, v79
    buffer_store_dwordx2 v[24:25], v23, s[20:23], s40 offen offset:48 sc1
    s_nop 1
    v_cvt_pk_bf16_f32 v24, v80, v81
    v_cvt_pk_bf16_f32 v25, v82, v83
    buffer_store_dwordx2 v[24:25], v23, s[20:23], s40 offen offset:2048 sc1
    s_nop 1
    v_cvt_pk_bf16_f32 v24, v84, v85
    v_cvt_pk_bf16_f32 v25, v86, v87
    buffer_store_dwordx2 v[24:25], v23, s[20:23], s40 offen offset:2064 sc1
    s_nop 1
    v_cvt_pk_bf16_f32 v24, v88, v89
    v_cvt_pk_bf16_f32 v25, v90, v91
    buffer_store_dwordx2 v[24:25], v23, s[20:23], s40 offen offset:2080 sc1
    s_nop 1
    v_cvt_pk_bf16_f32 v24, v92, v93
    v_cvt_pk_bf16_f32 v25, v94, v95
    buffer_store_dwordx2 v[24:25], v23, s[20:23], s40 offen offset:2096 sc1
    s_nop 1
    v_add_u32 v23, 262144, v22
    v_cvt_pk_bf16_f32 v24, v96, v97
    v_cvt_pk_bf16_f32 v25, v98, v99
    buffer_store_dwordx2 v[24:25], v23, s[20:23], s40 offen offset:0 sc1
    s_nop 1
    v_cvt_pk_bf16_f32 v24, v100, v101
    v_cvt_pk_bf16_f32 v25, v102, v103
    buffer_store_dwordx2 v[24:25], v23, s[20:23], s40 offen offset:16 sc1
    s_nop 1
    v_cvt_pk_bf16_f32 v24, v104, v105
    v_cvt_pk_bf16_f32 v25, v106, v107
    buffer_store_dwordx2 v[24:25], v23, s[20:23], s40 offen offset:32 sc1
    s_nop 1
    v_cvt_pk_bf16_f32 v24, v108, v109
    v_cvt_pk_bf16_f32 v25, v110, v111
    buffer_store_dwordx2 v[24:25], v23, s[20:23], s40 offen offset:48 sc1
    s_nop 1
    v_cvt_pk_bf16_f32 v24, v112, v113
    v_cvt_pk_bf16_f32 v25, v114, v115
    buffer_store_dwordx2 v[24:25], v23, s[20:23], s40 offen offset:2048 sc1
    s_nop 1
    v_cvt_pk_bf16_f32 v24, v116, v117
    v_cvt_pk_bf16_f32 v25, v118, v119
    buffer_store_dwordx2 v[24:25], v23, s[20:23], s40 offen offset:2064 sc1
    s_nop 1
    v_cvt_pk_bf16_f32 v24, v120, v121
    v_cvt_pk_bf16_f32 v25, v122, v123
    buffer_store_dwordx2 v[24:25], v23, s[20:23], s40 offen offset:2080 sc1
    s_nop 1
    v_cvt_pk_bf16_f32 v24, v124, v125
    v_cvt_pk_bf16_f32 v25, v126, v127
    buffer_store_dwordx2 v[24:25], v23, s[20:23], s40 offen offset:2096 sc1
    s_nop 1
chain_kernel_done32:
    v_lshrrev_b32 v2, 6, v0
    s_nop 0
    v_readfirstlane_b32 s18, v2
    s_waitcnt vmcnt(0)
    s_barrier
    s_cmp_ge_u32 s50, 1024
    s_cbranch_scc1 chain_kernel_wl27
    s_cmp_lg_u32 s18, 0
    s_cbranch_scc1 chain_kernel_wl27
    s_lshl_b32 s51, s50, 2
    s_add_u32 s51, s51, 105906176
    v_mov_b32 v5, 1
    v_mov_b32 v6, 0
    buffer_store_dword v5, v6, s[20:23], s51 offen sc1
    s_branch chain_kernel_wl27
chain_kernel_done02:
    s_endpgm
.globl attn_kernel
.p2align 8
.type attn_kernel,@function
attn_kernel:
    s_cmp_ge_u32 s2, 512
    s_cbranch_scc1 attn_kernel_done1
    s_load_dwordx2 s[8:9], s[0:1], 104
    s_waitcnt lgkmcnt(0)
    s_mov_b32 s10, 268435456
    s_mov_b32 s11, 0x00020000
    v_and_b32 v1, 63, v0
    v_lshrrev_b32 v2, 6, v0
    s_nop 0
    v_readfirstlane_b32 s3, v2
    s_lshl_b32 s4, s2, 2
    s_add_u32 s4, s4, s3
    s_lshr_b32 s5, s4, 5
    s_and_b32 s6, s4, 31
    v_and_b32 v3, 15, v1
    v_lshrrev_b32 v4, 4, v1
    s_lshl_b32 s7, s5, 18
    s_lshl_b32 s12, s6, 8
    s_add_u32 s7, s7, s12
    v_lshlrev_b32 v5, 13, v3
    v_lshl_add_u32 v5, v4, 4, v5
    v_add_u32 v5, s7, v5
    v_add_u32 v6, 131072, v5
    s_mov_b32 s13, 4194304
    s_mov_b32 s14, 20971520
    buffer_load_dwordx4 v[16:19], v5, s[8:11], s13 offen offset:0
    buffer_load_dwordx4 v[20:23], v5, s[8:11], s13 offen offset:64
    buffer_load_dwordx4 v[24:27], v5, s[8:11], s13 offen offset:128
    buffer_load_dwordx4 v[28:31], v5, s[8:11], s13 offen offset:192
    buffer_load_dwordx4 v[32:35], v6, s[8:11], s13 offen offset:0
    buffer_load_dwordx4 v[36:39], v6, s[8:11], s13 offen offset:64
    buffer_load_dwordx4 v[40:43], v6, s[8:11], s13 offen offset:128
    buffer_load_dwordx4 v[44:47], v6, s[8:11], s13 offen offset:192
    buffer_load_dwordx4 v[64:67], v5, s[8:11], s14 offen offset:0
    buffer_load_dwordx4 v[68:71], v5, s[8:11], s14 offen offset:64
    buffer_load_dwordx4 v[72:75], v5, s[8:11], s14 offen offset:128
    buffer_load_dwordx4 v[76:79], v5, s[8:11], s14 offen offset:192
    buffer_load_dwordx4 v[80:83], v6, s[8:11], s14 offen offset:0
    buffer_load_dwordx4 v[84:87], v6, s[8:11], s14 offen offset:64
    buffer_load_dwordx4 v[88:91], v6, s[8:11], s14 offen offset:128
    buffer_load_dwordx4 v[92:95], v6, s[8:11], s14 offen offset:192
    s_lshl_b32 s15, s5, 5
    s_add_u32 s15, s15, s6
    s_lshl_b32 s16, s15, 11
    v_and_b32 v7, 7, v3
    v_lshlrev_b32 v7, 8, v7
    v_lshl_add_u32 v7, v4, 4, v7
    v_add_u32 v7, s16, v7
    s_mov_b32 s17, 83886080
    buffer_load_dwordx4 v[48:51], v7, s[8:11], s17 offen offset:0
    buffer_load_dwordx4 v[52:55], v7, s[8:11], s17 offen offset:64
    buffer_load_dwordx4 v[56:59], v7, s[8:11], s17 offen offset:128
    buffer_load_dwordx4 v[60:63], v7, s[8:11], s17 offen offset:192
    s_lshl_b32 s18, s15, 13
    v_lshlrev_b32 v8, 6, v3
    v_lshl_add_u32 v8, v4, 3, v8
    v_add_u32 v8, s18, v8
    v_lshlrev_b32 v9, 4, v3
    v_and_b32 v10, 1, v4
    v_lshl_add_u32 v9, v10, 3, v9
    v_add_u32 v9, s16, v9
    s_mov_b32 s19, 37748736
    s_mov_b32 s20, 88080384
    buffer_load_dwordx2 v[120:121], v9, s[8:11], s20 offen offset:0
    buffer_load_dwordx2 v[122:123], v8, s[8:11], s19 offen offset:0
    buffer_load_dwordx2 v[124:125], v8, s[8:11], s19 offen offset:32
    v_mov_b32 v126, 0
    v_mov_b32 v127, 0
    buffer_load_dwordx2 v[128:129], v9, s[8:11], s20 offen offset:256
    buffer_load_dwordx2 v[130:131], v8, s[8:11], s19 offen offset:1024
    buffer_load_dwordx2 v[132:133], v8, s[8:11], s19 offen offset:1056
    v_mov_b32 v134, 0
    v_mov_b32 v135, 0
    buffer_load_dwordx2 v[136:137], v9, s[8:11], s20 offen offset:512
    buffer_load_dwordx2 v[138:139], v8, s[8:11], s19 offen offset:2048
    buffer_load_dwordx2 v[140:141], v8, s[8:11], s19 offen offset:2080
    v_mov_b32 v142, 0
    v_mov_b32 v143, 0
    buffer_load_dwordx2 v[144:145], v9, s[8:11], s20 offen offset:768
    buffer_load_dwordx2 v[146:147], v8, s[8:11], s19 offen offset:3072
    buffer_load_dwordx2 v[148:149], v8, s[8:11], s19 offen offset:3104
    v_mov_b32 v150, 0
    v_mov_b32 v151, 0
    buffer_load_dwordx2 v[152:153], v9, s[8:11], s20 offen offset:1024
    v_add_u32 v8, 4096, v8
    buffer_load_dwordx2 v[154:155], v8, s[8:11], s19 offen offset:0
    buffer_load_dwordx2 v[156:157], v8, s[8:11], s19 offen offset:32
    v_mov_b32 v158, 0
    v_mov_b32 v159, 0
    buffer_load_dwordx2 v[160:161], v9, s[8:11], s20 offen offset:1280
    buffer_load_dwordx2 v[162:163], v8, s[8:11], s19 offen offset:1024
    buffer_load_dwordx2 v[164:165], v8, s[8:11], s19 offen offset:1056
    v_mov_b32 v166, 0
    v_mov_b32 v167, 0
    buffer_load_dwordx2 v[168:169], v9, s[8:11], s20 offen offset:1536
    buffer_load_dwordx2 v[170:171], v8, s[8:11], s19 offen offset:2048
    buffer_load_dwordx2 v[172:173], v8, s[8:11], s19 offen offset:2080
    v_mov_b32 v174, 0
    v_mov_b32 v175, 0
    buffer_load_dwordx2 v[176:177], v9, s[8:11], s20 offen offset:1792
    buffer_load_dwordx2 v[178:179], v8, s[8:11], s19 offen offset:3072
    buffer_load_dwordx2 v[180:181], v8, s[8:11], s19 offen offset:3104
    v_mov_b32 v182, 0
    v_mov_b32 v183, 0
    v_mov_b32 v96, 0
    v_mov_b32 v97, 0
    v_mov_b32 v98, 0
    v_mov_b32 v99, 0
    v_mov_b32 v100, 0
    v_mov_b32 v101, 0
    v_mov_b32 v102, 0
    v_mov_b32 v103, 0
    v_mov_b32 v104, 0
    v_mov_b32 v105, 0
    v_mov_b32 v106, 0
    v_mov_b32 v107, 0
    v_mov_b32 v108, 0
    v_mov_b32 v109, 0
    v_mov_b32 v110, 0
    v_mov_b32 v111, 0
    v_mov_b32 v112, 0
    v_mov_b32 v113, 0
    v_mov_b32 v114, 0
    v_mov_b32 v115, 0
    v_mov_b32 v116, 0
    v_mov_b32 v117, 0
    v_mov_b32 v118, 0
    v_mov_b32 v119, 0
    s_waitcnt vmcnt(24)
    s_nop 1
    v_mfma_f32_16x16x32_bf16 v[96:99], v[48:51], v[16:19], v[96:99]
    v_mfma_f32_16x16x32_bf16 v[100:103], v[64:67], v[16:19], v[100:103]
    v_mfma_f32_16x16x32_bf16 v[104:107], v[80:83], v[16:19], v[104:107]
    v_mfma_f32_16x16x32_bf16 v[108:111], v[48:51], v[32:35], v[108:111]
    v_mfma_f32_16x16x32_bf16 v[112:115], v[64:67], v[32:35], v[112:115]
    v_mfma_f32_16x16x32_bf16 v[116:119], v[80:83], v[32:35], v[116:119]
    v_mfma_f32_16x16x32_bf16 v[96:99], v[52:55], v[20:23], v[96:99]
    v_mfma_f32_16x16x32_bf16 v[100:103], v[68:71], v[20:23], v[100:103]
    v_mfma_f32_16x16x32_bf16 v[104:107], v[84:87], v[20:23], v[104:107]
    v_mfma_f32_16x16x32_bf16 v[108:111], v[52:55], v[36:39], v[108:111]
    v_mfma_f32_16x16x32_bf16 v[112:115], v[68:71], v[36:39], v[112:115]
    v_mfma_f32_16x16x32_bf16 v[116:119], v[84:87], v[36:39], v[116:119]
    v_mfma_f32_16x16x32_bf16 v[96:99], v[56:59], v[24:27], v[96:99]
    v_mfma_f32_16x16x32_bf16 v[100:103], v[72:75], v[24:27], v[100:103]
    v_mfma_f32_16x16x32_bf16 v[104:107], v[88:91], v[24:27], v[104:107]
    v_mfma_f32_16x16x32_bf16 v[108:111], v[56:59], v[40:43], v[108:111]
    v_mfma_f32_16x16x32_bf16 v[112:115], v[72:75], v[40:43], v[112:115]
    v_mfma_f32_16x16x32_bf16 v[116:119], v[88:91], v[40:43], v[116:119]
    v_mfma_f32_16x16x32_bf16 v[96:99], v[60:63], v[28:31], v[96:99]
    v_mfma_f32_16x16x32_bf16 v[100:103], v[76:79], v[28:31], v[100:103]
    v_mfma_f32_16x16x32_bf16 v[104:107], v[92:95], v[28:31], v[104:107]
    v_mfma_f32_16x16x32_bf16 v[108:111], v[60:63], v[44:47], v[108:111]
    v_mfma_f32_16x16x32_bf16 v[112:115], v[76:79], v[44:47], v[112:115]
    v_mfma_f32_16x16x32_bf16 v[116:119], v[92:95], v[44:47], v[116:119]
    s_nop 7
    s_nop 3
    s_mov_b32 s21, 0x3db504f3
    s_mov_b32 s22, 0xce6e6b28
    s_mov_b32 s23, 0x3fb8aa3b
    v_lshlrev_b32 v11, 2, v4
    v_xor_b32 v12, 16, v1
    v_lshlrev_b32 v12, 2, v12
    v_xor_b32 v13, 32, v1
    v_lshlrev_b32 v13, 2, v13
    v_cvt_pk_bf16_f32 v96, v96, v96
    v_lshlrev_b32 v96, 16, v96
    v_mul_f32 v96, s21, v96
    v_cvt_pk_bf16_f32 v96, v96, v96
    v_lshlrev_b32 v96, 16, v96
    v_cvt_pk_bf16_f32 v97, v97, v97
    v_lshlrev_b32 v97, 16, v97
    v_mul_f32 v97, s21, v97
    v_cvt_pk_bf16_f32 v97, v97, v97
    v_lshlrev_b32 v97, 16, v97
    v_cvt_pk_bf16_f32 v98, v98, v98
    v_lshlrev_b32 v98, 16, v98
    v_mul_f32 v98, s21, v98
    v_cvt_pk_bf16_f32 v98, v98, v98
    v_lshlrev_b32 v98, 16, v98
    v_cvt_pk_bf16_f32 v99, v99, v99
    v_lshlrev_b32 v99, 16, v99
    v_mul_f32 v99, s21, v99
    v_cvt_pk_bf16_f32 v99, v99, v99
    v_lshlrev_b32 v99, 16, v99
    v_cvt_pk_bf16_f32 v100, v100, v100
    v_lshlrev_b32 v100, 16, v100
    v_mul_f32 v100, s21, v100
    v_cvt_pk_bf16_f32 v100, v100, v100
    v_lshlrev_b32 v100, 16, v100
    v_cvt_pk_bf16_f32 v101, v101, v101
    v_lshlrev_b32 v101, 16, v101
    v_mul_f32 v101, s21, v101
    v_cvt_pk_bf16_f32 v101, v101, v101
    v_lshlrev_b32 v101, 16, v101
    v_cvt_pk_bf16_f32 v102, v102, v102
    v_lshlrev_b32 v102, 16, v102
    v_mul_f32 v102, s21, v102
    v_cvt_pk_bf16_f32 v102, v102, v102
    v_lshlrev_b32 v102, 16, v102
    v_cvt_pk_bf16_f32 v103, v103, v103
    v_lshlrev_b32 v103, 16, v103
    v_mul_f32 v103, s21, v103
    v_cvt_pk_bf16_f32 v103, v103, v103
    v_lshlrev_b32 v103, 16, v103
    v_cvt_pk_bf16_f32 v104, v104, v104
    v_lshlrev_b32 v104, 16, v104
    v_mul_f32 v104, s21, v104
    v_cvt_pk_bf16_f32 v104, v104, v104
    v_lshlrev_b32 v104, 16, v104
    v_cvt_pk_bf16_f32 v105, v105, v105
    v_lshlrev_b32 v105, 16, v105
    v_mul_f32 v105, s21, v105
    v_cvt_pk_bf16_f32 v105, v105, v105
    v_lshlrev_b32 v105, 16, v105
    v_cvt_pk_bf16_f32 v106, v106, v106
    v_lshlrev_b32 v106, 16, v106
    v_mul_f32 v106, s21, v106
    v_cvt_pk_bf16_f32 v106, v106, v106
    v_lshlrev_b32 v106, 16, v106
    v_cvt_pk_bf16_f32 v107, v107, v107
    v_lshlrev_b32 v107, 16, v107
    v_mul_f32 v107, s21, v107
    v_cvt_pk_bf16_f32 v107, v107, v107
    v_lshlrev_b32 v107, 16, v107
    v_mov_b32 v14, s22
    v_cmp_gt_u32 vcc, 2, v4
    s_nop 1
    v_cndmask_b32 v96, v14, v96, vcc
    v_cndmask_b32 v97, v14, v97, vcc
    v_cndmask_b32 v98, v14, v98, vcc
    v_cndmask_b32 v99, v14, v99, vcc
    v_add_u32 v15, 0, v3
    v_add_u32 v10, 0, v11
    v_cmp_le_u32 vcc, v10, v15
    s_nop 1
    v_cndmask_b32 v100, v14, v100, vcc
    v_add_u32 v10, 1, v11
    v_cmp_le_u32 vcc, v10, v15
    s_nop 1
    v_cndmask_b32 v101, v14, v101, vcc
    v_add_u32 v10, 2, v11
    v_cmp_le_u32 vcc, v10, v15
    s_nop 1
    v_cndmask_b32 v102, v14, v102, vcc
    v_add_u32 v10, 3, v11
    v_cmp_le_u32 vcc, v10, v15
    s_nop 1
    v_cndmask_b32 v103, v14, v103, vcc
    v_add_u32 v10, 16, v11
    v_cmp_le_u32 vcc, v10, v15
    s_nop 1
    v_cndmask_b32 v104, v14, v104, vcc
    v_add_u32 v10, 17, v11
    v_cmp_le_u32 vcc, v10, v15
    s_nop 1
    v_cndmask_b32 v105, v14, v105, vcc
    v_add_u32 v10, 18, v11
    v_cmp_le_u32 vcc, v10, v15
    s_nop 1
    v_cndmask_b32 v106, v14, v106, vcc
    v_add_u32 v10, 19, v11
    v_cmp_le_u32 vcc, v10, v15
    s_nop 1
    v_cndmask_b32 v107, v14, v107, vcc
    v_max_f32 v14, v96, v97
    v_max_f32 v14, v14, v98
    v_max_f32 v14, v14, v99
    v_max_f32 v14, v14, v100
    v_max_f32 v14, v14, v101
    v_max_f32 v14, v14, v102
    v_max_f32 v14, v14, v103
    v_max_f32 v14, v14, v104
    v_max_f32 v14, v14, v105
    v_max_f32 v14, v14, v106
    v_max_f32 v14, v14, v107
    ds_bpermute_b32 v10, v12, v14
    s_waitcnt lgkmcnt(0)
    v_max_f32 v14, v14, v10
    ds_bpermute_b32 v10, v13, v14
    s_waitcnt lgkmcnt(0)
    v_max_f32 v14, v14, v10
    v_sub_f32 v96, v96, v14
    v_mul_f32 v96, s23, v96
    v_exp_f32 v96, v96
    v_sub_f32 v97, v97, v14
    v_mul_f32 v97, s23, v97
    v_exp_f32 v97, v97
    v_sub_f32 v98, v98, v14
    v_mul_f32 v98, s23, v98
    v_exp_f32 v98, v98
    v_sub_f32 v99, v99, v14
    v_mul_f32 v99, s23, v99
    v_exp_f32 v99, v99
    v_sub_f32 v100, v100, v14
    v_mul_f32 v100, s23, v100
    v_exp_f32 v100, v100
    v_sub_f32 v101, v101, v14
    v_mul_f32 v101, s23, v101
    v_exp_f32 v101, v101
    v_sub_f32 v102, v102, v14
    v_mul_f32 v102, s23, v102
    v_exp_f32 v102, v102
    v_sub_f32 v103, v103, v14
    v_mul_f32 v103, s23, v103
    v_exp_f32 v103, v103
    v_sub_f32 v104, v104, v14
    v_mul_f32 v104, s23, v104
    v_exp_f32 v104, v104
    v_sub_f32 v105, v105, v14
    v_mul_f32 v105, s23, v105
    v_exp_f32 v105, v105
    v_sub_f32 v106, v106, v14
    v_mul_f32 v106, s23, v106
    v_exp_f32 v106, v106
    v_sub_f32 v107, v107, v14
    v_mul_f32 v107, s23, v107
    v_exp_f32 v107, v107
    s_nop 0
    v_add_f32 v14, v96, v97
    v_add_f32 v14, v14, v98
    v_add_f32 v14, v14, v99
    v_add_f32 v14, v14, v100
    v_add_f32 v14, v14, v101
    v_add_f32 v14, v14, v102
    v_add_f32 v14, v14, v103
    v_add_f32 v14, v14, v104
    v_add_f32 v14, v14, v105
    v_add_f32 v14, v14, v106
    v_add_f32 v14, v14, v107
    ds_bpermute_b32 v10, v12, v14
    s_waitcnt lgkmcnt(0)
    v_add_f32 v14, v14, v10
    ds_bpermute_b32 v10, v13, v14
    s_waitcnt lgkmcnt(0)
    v_add_f32 v14, v14, v10
    v_rcp_f32 v14, v14
    s_nop 0
    v_mul_f32 v96, v96, v14
    v_mul_f32 v97, v97, v14
    v_mul_f32 v98, v98, v14
    v_mul_f32 v99, v99, v14
    v_mul_f32 v100, v100, v14
    v_mul_f32 v101, v101, v14
    v_mul_f32 v102, v102, v14
    v_mul_f32 v103, v103, v14
    v_mul_f32 v104, v104, v14
    v_mul_f32 v105, v105, v14
    v_mul_f32 v106, v106, v14
    v_mul_f32 v107, v107, v14
    v_cvt_pk_bf16_f32 v184, v96, v97
    v_cvt_pk_bf16_f32 v185, v98, v99
    v_cvt_pk_bf16_f32 v186, v100, v101
    v_cvt_pk_bf16_f32 v187, v102, v103
    v_cvt_pk_bf16_f32 v188, v104, v105
    v_cvt_pk_bf16_f32 v189, v106, v107
    v_mov_b32 v190, 0
    v_mov_b32 v191, 0
    v_cvt_pk_bf16_f32 v108, v108, v108
    v_lshlrev_b32 v108, 16, v108
    v_mul_f32 v108, s21, v108
    v_cvt_pk_bf16_f32 v108, v108, v108
    v_lshlrev_b32 v108, 16, v108
    v_cvt_pk_bf16_f32 v109, v109, v109
    v_lshlrev_b32 v109, 16, v109
    v_mul_f32 v109, s21, v109
    v_cvt_pk_bf16_f32 v109, v109, v109
    v_lshlrev_b32 v109, 16, v109
    v_cvt_pk_bf16_f32 v110, v110, v110
    v_lshlrev_b32 v110, 16, v110
    v_mul_f32 v110, s21, v110
    v_cvt_pk_bf16_f32 v110, v110, v110
    v_lshlrev_b32 v110, 16, v110
    v_cvt_pk_bf16_f32 v111, v111, v111
    v_lshlrev_b32 v111, 16, v111
    v_mul_f32 v111, s21, v111
    v_cvt_pk_bf16_f32 v111, v111, v111
    v_lshlrev_b32 v111, 16, v111
    v_cvt_pk_bf16_f32 v112, v112, v112
    v_lshlrev_b32 v112, 16, v112
    v_mul_f32 v112, s21, v112
    v_cvt_pk_bf16_f32 v112, v112, v112
    v_lshlrev_b32 v112, 16, v112
    v_cvt_pk_bf16_f32 v113, v113, v113
    v_lshlrev_b32 v113, 16, v113
    v_mul_f32 v113, s21, v113
    v_cvt_pk_bf16_f32 v113, v113, v113
    v_lshlrev_b32 v113, 16, v113
    v_cvt_pk_bf16_f32 v114, v114, v114
    v_lshlrev_b32 v114, 16, v114
    v_mul_f32 v114, s21, v114
    v_cvt_pk_bf16_f32 v114, v114, v114
    v_lshlrev_b32 v114, 16, v114
    v_cvt_pk_bf16_f32 v115, v115, v115
    v_lshlrev_b32 v115, 16, v115
    v_mul_f32 v115, s21, v115
    v_cvt_pk_bf16_f32 v115, v115, v115
    v_lshlrev_b32 v115, 16, v115
    v_cvt_pk_bf16_f32 v116, v116, v116
    v_lshlrev_b32 v116, 16, v116
    v_mul_f32 v116, s21, v116
    v_cvt_pk_bf16_f32 v116, v116, v116
    v_lshlrev_b32 v116, 16, v116
    v_cvt_pk_bf16_f32 v117, v117, v117
    v_lshlrev_b32 v117, 16, v117
    v_mul_f32 v117, s21, v117
    v_cvt_pk_bf16_f32 v117, v117, v117
    v_lshlrev_b32 v117, 16, v117
    v_cvt_pk_bf16_f32 v118, v118, v118
    v_lshlrev_b32 v118, 16, v118
    v_mul_f32 v118, s21, v118
    v_cvt_pk_bf16_f32 v118, v118, v118
    v_lshlrev_b32 v118, 16, v118
    v_cvt_pk_bf16_f32 v119, v119, v119
    v_lshlrev_b32 v119, 16, v119
    v_mul_f32 v119, s21, v119
    v_cvt_pk_bf16_f32 v119, v119, v119
    v_lshlrev_b32 v119, 16, v119
    v_mov_b32 v14, s22
    v_cmp_gt_u32 vcc, 2, v4
    s_nop 1
    v_cndmask_b32 v108, v14, v108, vcc
    v_cndmask_b32 v109, v14, v109, vcc
    v_cndmask_b32 v110, v14, v110, vcc
    v_cndmask_b32 v111, v14, v111, vcc
    v_add_u32 v15, 16, v3
    v_add_u32 v10, 0, v11
    v_cmp_le_u32 vcc, v10, v15
    s_nop 1
    v_cndmask_b32 v112, v14, v112, vcc
    v_add_u32 v10, 1, v11
    v_cmp_le_u32 vcc, v10, v15
    s_nop 1
    v_cndmask_b32 v113, v14, v113, vcc
    v_add_u32 v10, 2, v11
    v_cmp_le_u32 vcc, v10, v15
    s_nop 1
    v_cndmask_b32 v114, v14, v114, vcc
    v_add_u32 v10, 3, v11
    v_cmp_le_u32 vcc, v10, v15
    s_nop 1
    v_cndmask_b32 v115, v14, v115, vcc
    v_add_u32 v10, 16, v11
    v_cmp_le_u32 vcc, v10, v15
    s_nop 1
    v_cndmask_b32 v116, v14, v116, vcc
    v_add_u32 v10, 17, v11
    v_cmp_le_u32 vcc, v10, v15
    s_nop 1
    v_cndmask_b32 v117, v14, v117, vcc
    v_add_u32 v10, 18, v11
    v_cmp_le_u32 vcc, v10, v15
    s_nop 1
    v_cndmask_b32 v118, v14, v118, vcc
    v_add_u32 v10, 19, v11
    v_cmp_le_u32 vcc, v10, v15
    s_nop 1
    v_cndmask_b32 v119, v14, v119, vcc
    v_max_f32 v14, v108, v109
    v_max_f32 v14, v14, v110
    v_max_f32 v14, v14, v111
    v_max_f32 v14, v14, v112
    v_max_f32 v14, v14, v113
    v_max_f32 v14, v14, v114
    v_max_f32 v14, v14, v115
    v_max_f32 v14, v14, v116
    v_max_f32 v14, v14, v117
    v_max_f32 v14, v14, v118
    v_max_f32 v14, v14, v119
    ds_bpermute_b32 v10, v12, v14
    s_waitcnt lgkmcnt(0)
    v_max_f32 v14, v14, v10
    ds_bpermute_b32 v10, v13, v14
    s_waitcnt lgkmcnt(0)
    v_max_f32 v14, v14, v10
    v_sub_f32 v108, v108, v14
    v_mul_f32 v108, s23, v108
    v_exp_f32 v108, v108
    v_sub_f32 v109, v109, v14
    v_mul_f32 v109, s23, v109
    v_exp_f32 v109, v109
    v_sub_f32 v110, v110, v14
    v_mul_f32 v110, s23, v110
    v_exp_f32 v110, v110
    v_sub_f32 v111, v111, v14
    v_mul_f32 v111, s23, v111
    v_exp_f32 v111, v111
    v_sub_f32 v112, v112, v14
    v_mul_f32 v112, s23, v112
    v_exp_f32 v112, v112
    v_sub_f32 v113, v113, v14
    v_mul_f32 v113, s23, v113
    v_exp_f32 v113, v113
    v_sub_f32 v114, v114, v14
    v_mul_f32 v114, s23, v114
    v_exp_f32 v114, v114
    v_sub_f32 v115, v115, v14
    v_mul_f32 v115, s23, v115
    v_exp_f32 v115, v115
    v_sub_f32 v116, v116, v14
    v_mul_f32 v116, s23, v116
    v_exp_f32 v116, v116
    v_sub_f32 v117, v117, v14
    v_mul_f32 v117, s23, v117
    v_exp_f32 v117, v117
    v_sub_f32 v118, v118, v14
    v_mul_f32 v118, s23, v118
    v_exp_f32 v118, v118
    v_sub_f32 v119, v119, v14
    v_mul_f32 v119, s23, v119
    v_exp_f32 v119, v119
    s_nop 0
    v_add_f32 v14, v108, v109
    v_add_f32 v14, v14, v110
    v_add_f32 v14, v14, v111
    v_add_f32 v14, v14, v112
    v_add_f32 v14, v14, v113
    v_add_f32 v14, v14, v114
    v_add_f32 v14, v14, v115
    v_add_f32 v14, v14, v116
    v_add_f32 v14, v14, v117
    v_add_f32 v14, v14, v118
    v_add_f32 v14, v14, v119
    ds_bpermute_b32 v10, v12, v14
    s_waitcnt lgkmcnt(0)
    v_add_f32 v14, v14, v10
    ds_bpermute_b32 v10, v13, v14
    s_waitcnt lgkmcnt(0)
    v_add_f32 v14, v14, v10
    v_rcp_f32 v14, v14
    s_nop 0
    v_mul_f32 v108, v108, v14
    v_mul_f32 v109, v109, v14
    v_mul_f32 v110, v110, v14
    v_mul_f32 v111, v111, v14
    v_mul_f32 v112, v112, v14
    v_mul_f32 v113, v113, v14
    v_mul_f32 v114, v114, v14
    v_mul_f32 v115, v115, v14
    v_mul_f32 v116, v116, v14
    v_mul_f32 v117, v117, v14
    v_mul_f32 v118, v118, v14
    v_mul_f32 v119, v119, v14
    v_cvt_pk_bf16_f32 v192, v108, v109
    v_cvt_pk_bf16_f32 v193, v110, v111
    v_cvt_pk_bf16_f32 v194, v112, v113
    v_cvt_pk_bf16_f32 v195, v114, v115
    v_cvt_pk_bf16_f32 v196, v116, v117
    v_cvt_pk_bf16_f32 v197, v118, v119
    v_mov_b32 v198, 0
    v_mov_b32 v199, 0
    s_waitcnt vmcnt(0)
    v_mov_b32 v16, 0
    v_mov_b32 v17, 0
    v_mov_b32 v18, 0
    v_mov_b32 v19, 0
    v_mov_b32 v20, 0
    v_mov_b32 v21, 0
    v_mov_b32 v22, 0
    v_mov_b32 v23, 0
    v_mov_b32 v24, 0
    v_mov_b32 v25, 0
    v_mov_b32 v26, 0
    v_mov_b32 v27, 0
    v_mov_b32 v28, 0
    v_mov_b32 v29, 0
    v_mov_b32 v30, 0
    v_mov_b32 v31, 0
    v_mov_b32 v32, 0
    v_mov_b32 v33, 0
    v_mov_b32 v34, 0
    v_mov_b32 v35, 0
    v_mov_b32 v36, 0
    v_mov_b32 v37, 0
    v_mov_b32 v38, 0
    v_mov_b32 v39, 0
    v_mov_b32 v40, 0
    v_mov_b32 v41, 0
    v_mov_b32 v42, 0
    v_mov_b32 v43, 0
    v_mov_b32 v44, 0
    v_mov_b32 v45, 0
    v_mov_b32 v46, 0
    v_mov_b32 v47, 0
    v_mov_b32 v48, 0
    v_mov_b32 v49, 0
    v_mov_b32 v50, 0
    v_mov_b32 v51, 0
    v_mov_b32 v52, 0
    v_mov_b32 v53, 0
    v_mov_b32 v54, 0
    v_mov_b32 v55, 0
    v_mov_b32 v56, 0
    v_mov_b32 v57, 0
    v_mov_b32 v58, 0
    v_mov_b32 v59, 0
    v_mov_b32 v60, 0
    v_mov_b32 v61, 0
    v_mov_b32 v62, 0
    v_mov_b32 v63, 0
    v_mov_b32 v64, 0
    v_mov_b32 v65, 0
    v_mov_b32 v66, 0
    v_mov_b32 v67, 0
    v_mov_b32 v68, 0
    v_mov_b32 v69, 0
    v_mov_b32 v70, 0
    v_mov_b32 v71, 0
    v_mov_b32 v72, 0
    v_mov_b32 v73, 0
    v_mov_b32 v74, 0
    v_mov_b32 v75, 0
    v_mov_b32 v76, 0
    v_mov_b32 v77, 0
    v_mov_b32 v78, 0
    v_mov_b32 v79, 0
    s_nop 1
    v_mfma_f32_16x16x32_bf16 v[16:19], v[120:123], v[184:187], v[16:19]
    v_mfma_f32_16x16x32_bf16 v[20:23], v[128:131], v[184:187], v[20:23]
    v_mfma_f32_16x16x32_bf16 v[24:27], v[136:139], v[184:187], v[24:27]
    v_mfma_f32_16x16x32_bf16 v[28:31], v[144:147], v[184:187], v[28:31]
    v_mfma_f32_16x16x32_bf16 v[32:35], v[152:155], v[184:187], v[32:35]
    v_mfma_f32_16x16x32_bf16 v[36:39], v[160:163], v[184:187], v[36:39]
    v_mfma_f32_16x16x32_bf16 v[40:43], v[168:171], v[184:187], v[40:43]
    v_mfma_f32_16x16x32_bf16 v[44:47], v[176:179], v[184:187], v[44:47]
    v_mfma_f32_16x16x32_bf16 v[48:51], v[120:123], v[192:195], v[48:51]
    v_mfma_f32_16x16x32_bf16 v[52:55], v[128:131], v[192:195], v[52:55]
    v_mfma_f32_16x16x32_bf16 v[56:59], v[136:139], v[192:195], v[56:59]
    v_mfma_f32_16x16x32_bf16 v[60:63], v[144:147], v[192:195], v[60:63]
    v_mfma_f32_16x16x32_bf16 v[64:67], v[152:155], v[192:195], v[64:67]
    v_mfma_f32_16x16x32_bf16 v[68:71], v[160:163], v[192:195], v[68:71]
    v_mfma_f32_16x16x32_bf16 v[72:75], v[168:171], v[192:195], v[72:75]
    v_mfma_f32_16x16x32_bf16 v[76:79], v[176:179], v[192:195], v[76:79]
    v_mfma_f32_16x16x32_bf16 v[16:19], v[124:127], v[188:191], v[16:19]
    v_mfma_f32_16x16x32_bf16 v[20:23], v[132:135], v[188:191], v[20:23]
    v_mfma_f32_16x16x32_bf16 v[24:27], v[140:143], v[188:191], v[24:27]
    v_mfma_f32_16x16x32_bf16 v[28:31], v[148:151], v[188:191], v[28:31]
    v_mfma_f32_16x16x32_bf16 v[32:35], v[156:159], v[188:191], v[32:35]
    v_mfma_f32_16x16x32_bf16 v[36:39], v[164:167], v[188:191], v[36:39]
    v_mfma_f32_16x16x32_bf16 v[40:43], v[172:175], v[188:191], v[40:43]
    v_mfma_f32_16x16x32_bf16 v[44:47], v[180:183], v[188:191], v[44:47]
    v_mfma_f32_16x16x32_bf16 v[48:51], v[124:127], v[196:199], v[48:51]
    v_mfma_f32_16x16x32_bf16 v[52:55], v[132:135], v[196:199], v[52:55]
    v_mfma_f32_16x16x32_bf16 v[56:59], v[140:143], v[196:199], v[56:59]
    v_mfma_f32_16x16x32_bf16 v[60:63], v[148:151], v[196:199], v[60:63]
    v_mfma_f32_16x16x32_bf16 v[64:67], v[156:159], v[196:199], v[64:67]
    v_mfma_f32_16x16x32_bf16 v[68:71], v[164:167], v[196:199], v[68:71]
    v_mfma_f32_16x16x32_bf16 v[72:75], v[172:175], v[196:199], v[72:75]
    v_mfma_f32_16x16x32_bf16 v[76:79], v[180:183], v[196:199], v[76:79]
    s_nop 7
    s_nop 3
    v_lshlrev_b32 v5, 13, v3
    v_lshl_add_u32 v5, v4, 3, v5
    v_add_u32 v5, s7, v5
    v_add_u32 v6, 131072, v5
    s_mov_b32 s13, 54525952
    v_cvt_pk_bf16_f32 v16, v16, v17
    v_cvt_pk_bf16_f32 v17, v18, v19
    buffer_store_dwordx2 v[16:17], v5, s[8:11], s13 offen offset:0
    v_cvt_pk_bf16_f32 v20, v20, v21
    v_cvt_pk_bf16_f32 v21, v22, v23
    buffer_store_dwordx2 v[20:21], v5, s[8:11], s13 offen offset:32
    v_cvt_pk_bf16_f32 v24, v24, v25
    v_cvt_pk_bf16_f32 v25, v26, v27
    buffer_store_dwordx2 v[24:25], v5, s[8:11], s13 offen offset:64
    v_cvt_pk_bf16_f32 v28, v28, v29
    v_cvt_pk_bf16_f32 v29, v30, v31
    buffer_store_dwordx2 v[28:29], v5, s[8:11], s13 offen offset:96
    v_cvt_pk_bf16_f32 v32, v32, v33
    v_cvt_pk_bf16_f32 v33, v34, v35
    buffer_store_dwordx2 v[32:33], v5, s[8:11], s13 offen offset:128
    v_cvt_pk_bf16_f32 v36, v36, v37
    v_cvt_pk_bf16_f32 v37, v38, v39
    buffer_store_dwordx2 v[36:37], v5, s[8:11], s13 offen offset:160
    v_cvt_pk_bf16_f32 v40, v40, v41
    v_cvt_pk_bf16_f32 v41, v42, v43
    buffer_store_dwordx2 v[40:41], v5, s[8:11], s13 offen offset:192
    v_cvt_pk_bf16_f32 v44, v44, v45
    v_cvt_pk_bf16_f32 v45, v46, v47
    buffer_store_dwordx2 v[44:45], v5, s[8:11], s13 offen offset:224
    v_cvt_pk_bf16_f32 v48, v48, v49
    v_cvt_pk_bf16_f32 v49, v50, v51
    buffer_store_dwordx2 v[48:49], v6, s[8:11], s13 offen offset:0
    v_cvt_pk_bf16_f32 v52, v52, v53
    v_cvt_pk_bf16_f32 v53, v54, v55
    buffer_store_dwordx2 v[52:53], v6, s[8:11], s13 offen offset:32
    v_cvt_pk_bf16_f32 v56, v56, v57
    v_cvt_pk_bf16_f32 v57, v58, v59
    buffer_store_dwordx2 v[56:57], v6, s[8:11], s13 offen offset:64
    v_cvt_pk_bf16_f32 v60, v60, v61
    v_cvt_pk_bf16_f32 v61, v62, v63
    buffer_store_dwordx2 v[60:61], v6, s[8:11], s13 offen offset:96
    v_cvt_pk_bf16_f32 v64, v64, v65
    v_cvt_pk_bf16_f32 v65, v66, v67
    buffer_store_dwordx2 v[64:65], v6, s[8:11], s13 offen offset:128
    v_cvt_pk_bf16_f32 v68, v68, v69
    v_cvt_pk_bf16_f32 v69, v70, v71
    buffer_store_dwordx2 v[68:69], v6, s[8:11], s13 offen offset:160
    v_cvt_pk_bf16_f32 v72, v72, v73
    v_cvt_pk_bf16_f32 v73, v74, v75
    buffer_store_dwordx2 v[72:73], v6, s[8:11], s13 offen offset:192
    v_cvt_pk_bf16_f32 v76, v76, v77
    v_cvt_pk_bf16_f32 v77, v78, v79
    buffer_store_dwordx2 v[76:77], v6, s[8:11], s13 offen offset:224
attn_kernel_done1:
    s_endpgm
.globl oproj_kernel
.p2align 8
.type oproj_kernel,@function
oproj_kernel:
    s_cmp_ge_u32 s2, 256
    s_cbranch_scc1 oproj_kernel_done1
    s_and_b32 s28, s2, 15
    s_lshr_b32 s29, s2, 4
    s_lshr_b32 s44, s29, 2
    s_and_b32 s29, s29, 3
    s_load_dwordx2 s[20:21], s[0:1], 104
    s_waitcnt lgkmcnt(0)
    s_mov_b32 s22, 268435456
    s_mov_b32 s23, 0x00020000
    s_mov_b32 s8, s20
    s_mov_b32 s9, s21
    s_mov_b32 s10, s22
    s_mov_b32 s11, s23
    s_load_dwordx2 s[12:13], s[0:1], 40
    s_waitcnt lgkmcnt(0)
    s_mov_b32 s14, 4194304
    s_mov_b32 s15, 0x00020000
    s_load_dwordx2 s[24:25], s[0:1], 0
    s_waitcnt lgkmcnt(0)
    s_mov_b32 s26, 2097152
    s_mov_b32 s27, 0x00020000
    s_lshl_b32 s37, s29, 8
    v_and_b32 v13, 63, v0
    v_lshrrev_b32 v14, 6, v0
    v_and_b32 v15, 1, v14
    v_lshrrev_b32 v16, 1, v14
    v_lshrrev_b32 v17, 3, v0
    v_and_b32 v18, 7, v0
    s_lshl_b32 s38, s28, 7
    v_add_u32 v19, s38, v17
    s_mov_b32 s39, 8192
    v_mul_lo_u32 v19, v19, s39
    v_lshl_add_u32 v1, v18, 4, v19
    v_add_u32 v1, 54525952, v1
    v_add_u32 v2, 262144, v1
    v_add_u32 v3, 524288, v1
    v_add_u32 v4, 786432, v1
    v_mul_u32_u24 v9, 144, v17
    v_lshl_add_u32 v9, v18, 4, v9
    v_lshrrev_b32 v17, 4, v0
    v_and_b32 v18, 15, v0
    s_mov_b32 s39, 1024
    v_mul_lo_u32 v19, v17, s39
    v_lshl_add_u32 v5, v18, 4, v19
    v_add_u32 v5, s37, v5
    v_add_u32 v6, 16384, v5
    v_add_u32 v7, 32768, v5
    v_add_u32 v8, 49152, v5
    v_mul_u32_u24 v10, 320, v17
    v_lshl_add_u32 v10, v18, 4, v10
    v_add_u32 v10, 18432, v10
    v_and_b32 v17, 31, v13
    v_lshl_add_u32 v17, v15, 6, v17
    v_mul_u32_u24 v11, 144, v17
    v_lshrrev_b32 v18, 5, v13
    v_lshl_add_u32 v11, v18, 4, v11
    v_and_b32 v17, 15, v13
    v_lshrrev_b32 v17, 2, v17
    v_lshl_add_u32 v17, v18, 3, v17
    v_mul_u32_u24 v12, 320, v17
    v_lshrrev_b32 v17, 4, v13
    v_and_b32 v17, 1, v17
    v_lshlrev_b32 v17, 5, v17
    v_add_u32 v12, v12, v17
    v_and_b32 v17, 3, v13
    v_lshl_add_u32 v12, v17, 3, v12
    v_lshl_add_u32 v12, v16, 7, v12
    v_add_u32 v12, 18432, v12
    v_mov_b32 v64, 0
    v_mov_b32 v65, 0
    v_mov_b32 v66, 0
    v_mov_b32 v67, 0
    v_mov_b32 v68, 0
    v_mov_b32 v69, 0
    v_mov_b32 v70, 0
    v_mov_b32 v71, 0
    v_mov_b32 v72, 0
    v_mov_b32 v73, 0
    v_mov_b32 v74, 0
    v_mov_b32 v75, 0
    v_mov_b32 v76, 0
    v_mov_b32 v77, 0
    v_mov_b32 v78, 0
    v_mov_b32 v79, 0
    v_mov_b32 v80, 0
    v_mov_b32 v81, 0
    v_mov_b32 v82, 0
    v_mov_b32 v83, 0
    v_mov_b32 v84, 0
    v_mov_b32 v85, 0
    v_mov_b32 v86, 0
    v_mov_b32 v87, 0
    v_mov_b32 v88, 0
    v_mov_b32 v89, 0
    v_mov_b32 v90, 0
    v_mov_b32 v91, 0
    v_mov_b32 v92, 0
    v_mov_b32 v93, 0
    v_mov_b32 v94, 0
    v_mov_b32 v95, 0
    v_mov_b32 v96, 0
    v_mov_b32 v97, 0
    v_mov_b32 v98, 0
    v_mov_b32 v99, 0
    v_mov_b32 v100, 0
    v_mov_b32 v101, 0
    v_mov_b32 v102, 0
    v_mov_b32 v103, 0
    v_mov_b32 v104, 0
    v_mov_b32 v105, 0
    v_mov_b32 v106, 0
    v_mov_b32 v107, 0
    v_mov_b32 v108, 0
    v_mov_b32 v109, 0
    v_mov_b32 v110, 0
    v_mov_b32 v111, 0
    v_mov_b32 v112, 0
    v_mov_b32 v113, 0
    v_mov_b32 v114, 0
    v_mov_b32 v115, 0
    v_mov_b32 v116, 0
    v_mov_b32 v117, 0
    v_mov_b32 v118, 0
    v_mov_b32 v119, 0
    v_mov_b32 v120, 0
    v_mov_b32 v121, 0
    v_mov_b32 v122, 0
    v_mov_b32 v123, 0
    v_mov_b32 v124, 0
    v_mov_b32 v125, 0
    v_mov_b32 v126, 0
    v_mov_b32 v127, 0
    s_mul_i32 s33, s44, 2048
    s_mul_i32 s34, s44, 1048576
    s_mov_b32 s31, 0
    buffer_load_dwordx4 v[128:131], v1, s[8:11], s33 offen
    buffer_load_dwordx4 v[132:135], v2, s[8:11], s33 offen
    buffer_load_dwordx4 v[136:139], v3, s[8:11], s33 offen
    buffer_load_dwordx4 v[140:143], v4, s[8:11], s33 offen
    buffer_load_dwordx4 v[144:147], v5, s[12:15], s34 offen
    buffer_load_dwordx4 v[148:151], v6, s[12:15], s34 offen
    buffer_load_dwordx4 v[152:155], v7, s[12:15], s34 offen
    buffer_load_dwordx4 v[156:159], v8, s[12:15], s34 offen
    s_add_u32 s33, s33, 128
    s_add_u32 s34, s34, 65536
    buffer_load_dwordx4 v[192:195], v1, s[8:11], s33 offen
    buffer_load_dwordx4 v[196:199], v2, s[8:11], s33 offen
    buffer_load_dwordx4 v[200:203], v3, s[8:11], s33 offen
    buffer_load_dwordx4 v[204:207], v4, s[8:11], s33 offen
    buffer_load_dwordx4 v[208:211], v5, s[12:15], s34 offen
    buffer_load_dwordx4 v[212:215], v6, s[12:15], s34 offen
    buffer_load_dwordx4 v[216:219], v7, s[12:15], s34 offen
    buffer_load_dwordx4 v[220:223], v8, s[12:15], s34 offen
    s_add_u32 s33, s33, 128
    s_add_u32 s34, s34, 65536
    s_waitcnt vmcnt(8)
    ds_write_b128 v9, v[128:131] offset:0
    ds_write_b128 v9, v[132:135] offset:4608
    ds_write_b128 v9, v[136:139] offset:9216
    ds_write_b128 v9, v[140:143] offset:13824
    ds_write_b128 v10, v[144:147] offset:0
    ds_write_b128 v10, v[148:151] offset:5120
    ds_write_b128 v10, v[152:155] offset:10240
    ds_write_b128 v10, v[156:159] offset:15360
    s_waitcnt lgkmcnt(0)
    s_barrier
    buffer_load_dwordx4 v[128:131], v1, s[8:11], s33 offen
    buffer_load_dwordx4 v[132:135], v2, s[8:11], s33 offen
    buffer_load_dwordx4 v[136:139], v3, s[8:11], s33 offen
    buffer_load_dwordx4 v[140:143], v4, s[8:11], s33 offen
    buffer_load_dwordx4 v[144:147], v5, s[12:15], s34 offen
    buffer_load_dwordx4 v[148:151], v6, s[12:15], s34 offen
    buffer_load_dwordx4 v[152:155], v7, s[12:15], s34 offen
    buffer_load_dwordx4 v[156:159], v8, s[12:15], s34 offen
    s_add_u32 s33, s33, 128
    s_add_u32 s34, s34, 65536
    ds_read_b128 v[160:163], v11 offset:0
    ds_read_b128 v[164:167], v11 offset:4608
    ds_read_b64_tr_b16 v[168:169], v12 offset:0
    ds_read_b64_tr_b16 v[170:171], v12 offset:1280
    ds_read_b64_tr_b16 v[172:173], v12 offset:64
    ds_read_b64_tr_b16 v[174:175], v12 offset:1344
    ds_read_b128 v[176:179], v11 offset:32
    ds_read_b128 v[180:183], v11 offset:4640
    ds_read_b64_tr_b16 v[184:185], v12 offset:5120
    ds_read_b64_tr_b16 v[186:187], v12 offset:6400
    ds_read_b64_tr_b16 v[188:189], v12 offset:5184
    ds_read_b64_tr_b16 v[190:191], v12 offset:6464
    s_waitcnt lgkmcnt(6)
    v_mfma_f32_32x32x16_bf16 v[64:79], v[168:171], v[160:163], v[64:79]
    v_mfma_f32_32x32x16_bf16 v[80:95], v[172:175], v[160:163], v[80:95]
    v_mfma_f32_32x32x16_bf16 v[96:111], v[168:171], v[164:167], v[96:111]
    v_mfma_f32_32x32x16_bf16 v[112:127], v[172:175], v[164:167], v[112:127]
    ds_read_b128 v[160:163], v11 offset:64
    ds_read_b128 v[164:167], v11 offset:4672
    ds_read_b64_tr_b16 v[168:169], v12 offset:10240
    ds_read_b64_tr_b16 v[170:171], v12 offset:11520
    ds_read_b64_tr_b16 v[172:173], v12 offset:10304
    ds_read_b64_tr_b16 v[174:175], v12 offset:11584
    s_waitcnt lgkmcnt(6)
    v_mfma_f32_32x32x16_bf16 v[64:79], v[184:187], v[176:179], v[64:79]
    v_mfma_f32_32x32x16_bf16 v[80:95], v[188:191], v[176:179], v[80:95]
    v_mfma_f32_32x32x16_bf16 v[96:111], v[184:187], v[180:183], v[96:111]
    v_mfma_f32_32x32x16_bf16 v[112:127], v[188:191], v[180:183], v[112:127]
    ds_read_b128 v[176:179], v11 offset:96
    ds_read_b128 v[180:183], v11 offset:4704
    ds_read_b64_tr_b16 v[184:185], v12 offset:15360
    ds_read_b64_tr_b16 v[186:187], v12 offset:16640
    ds_read_b64_tr_b16 v[188:189], v12 offset:15424
    ds_read_b64_tr_b16 v[190:191], v12 offset:16704
    s_waitcnt lgkmcnt(6)
    v_mfma_f32_32x32x16_bf16 v[64:79], v[168:171], v[160:163], v[64:79]
    v_mfma_f32_32x32x16_bf16 v[80:95], v[172:175], v[160:163], v[80:95]
    v_mfma_f32_32x32x16_bf16 v[96:111], v[168:171], v[164:167], v[96:111]
    v_mfma_f32_32x32x16_bf16 v[112:127], v[172:175], v[164:167], v[112:127]
    s_waitcnt lgkmcnt(0)
    v_mfma_f32_32x32x16_bf16 v[64:79], v[184:187], v[176:179], v[64:79]
    v_mfma_f32_32x32x16_bf16 v[80:95], v[188:191], v[176:179], v[80:95]
    v_mfma_f32_32x32x16_bf16 v[96:111], v[184:187], v[180:183], v[96:111]
    v_mfma_f32_32x32x16_bf16 v[112:127], v[188:191], v[180:183], v[112:127]
    s_waitcnt vmcnt(8)
    ds_write_b128 v9, v[192:195] offset:40960
    ds_write_b128 v9, v[196:199] offset:45568
    ds_write_b128 v9, v[200:203] offset:50176
    ds_write_b128 v9, v[204:207] offset:54784
    ds_write_b128 v10, v[208:211] offset:40960
    ds_write_b128 v10, v[212:215] offset:46080
    ds_write_b128 v10, v[216:219] offset:51200
    ds_write_b128 v10, v[220:223] offset:56320
    s_waitcnt lgkmcnt(0)
    s_barrier
    buffer_load_dwordx4 v[192:195], v1, s[8:11], s33 offen
    buffer_load_dwordx4 v[196:199], v2, s[8:11], s33 offen
    buffer_load_dwordx4 v[200:203], v3, s[8:11], s33 offen
    buffer_load_dwordx4 v[204:207], v4, s[8:11], s33 offen
    buffer_load_dwordx4 v[208:211], v5, s[12:15], s34 offen
    buffer_load_dwordx4 v[212:215], v6, s[12:15], s34 offen
    buffer_load_dwordx4 v[216:219], v7, s[12:15], s34 offen
    buffer_load_dwordx4 v[220:223], v8, s[12:15], s34 offen
    s_add_u32 s33, s33, 128
    s_add_u32 s34, s34, 65536
    ds_read_b128 v[160:163], v11 offset:40960
    ds_read_b128 v[164:167], v11 offset:45568
    ds_read_b64_tr_b16 v[168:169], v12 offset:40960
    ds_read_b64_tr_b16 v[170:171], v12 offset:42240
    ds_read_b64_tr_b16 v[172:173], v12 offset:41024
    ds_read_b64_tr_b16 v[174:175], v12 offset:42304
    ds_read_b128 v[176:179], v11 offset:40992
    ds_read_b128 v[180:183], v11 offset:45600
    ds_read_b64_tr_b16 v[184:185], v12 offset:46080
    ds_read_b64_tr_b16 v[186:187], v12 offset:47360
    ds_read_b64_tr_b16 v[188:189], v12 offset:46144
    ds_read_b64_tr_b16 v[190:191], v12 offset:47424
    s_waitcnt lgkmcnt(6)
    v_mfma_f32_32x32x16_bf16 v[64:79], v[168:171], v[160:163], v[64:79]
    v_mfma_f32_32x32x16_bf16 v[80:95], v[172:175], v[160:163], v[80:95]
    v_mfma_f32_32x32x16_bf16 v[96:111], v[168:171], v[164:167], v[96:111]
    v_mfma_f32_32x32x16_bf16 v[112:127], v[172:175], v[164:167], v[112:127]
    ds_read_b128 v[160:163], v11 offset:41024
    ds_read_b128 v[164:167], v11 offset:45632
    ds_read_b64_tr_b16 v[168:169], v12 offset:51200
    ds_read_b64_tr_b16 v[170:171], v12 offset:52480
    ds_read_b64_tr_b16 v[172:173], v12 offset:51264
    ds_read_b64_tr_b16 v[174:175], v12 offset:52544
    s_waitcnt lgkmcnt(6)
    v_mfma_f32_32x32x16_bf16 v[64:79], v[184:187], v[176:179], v[64:79]
    v_mfma_f32_32x32x16_bf16 v[80:95], v[188:191], v[176:179], v[80:95]
    v_mfma_f32_32x32x16_bf16 v[96:111], v[184:187], v[180:183], v[96:111]
    v_mfma_f32_32x32x16_bf16 v[112:127], v[188:191], v[180:183], v[112:127]
    ds_read_b128 v[176:179], v11 offset:41056
    ds_read_b128 v[180:183], v11 offset:45664
    ds_read_b64_tr_b16 v[184:185], v12 offset:56320
    ds_read_b64_tr_b16 v[186:187], v12 offset:57600
    ds_read_b64_tr_b16 v[188:189], v12 offset:56384
    ds_read_b64_tr_b16 v[190:191], v12 offset:57664
    s_waitcnt lgkmcnt(6)
    v_mfma_f32_32x32x16_bf16 v[64:79], v[168:171], v[160:163], v[64:79]
    v_mfma_f32_32x32x16_bf16 v[80:95], v[172:175], v[160:163], v[80:95]
    v_mfma_f32_32x32x16_bf16 v[96:111], v[168:171], v[164:167], v[96:111]
    v_mfma_f32_32x32x16_bf16 v[112:127], v[172:175], v[164:167], v[112:127]
    s_waitcnt lgkmcnt(0)
    v_mfma_f32_32x32x16_bf16 v[64:79], v[184:187], v[176:179], v[64:79]
    v_mfma_f32_32x32x16_bf16 v[80:95], v[188:191], v[176:179], v[80:95]
    v_mfma_f32_32x32x16_bf16 v[96:111], v[184:187], v[180:183], v[96:111]
    v_mfma_f32_32x32x16_bf16 v[112:127], v[188:191], v[180:183], v[112:127]
    s_waitcnt vmcnt(8)
    ds_write_b128 v9, v[128:131] offset:0
    ds_write_b128 v9, v[132:135] offset:4608
    ds_write_b128 v9, v[136:139] offset:9216
    ds_write_b128 v9, v[140:143] offset:13824
    ds_write_b128 v10, v[144:147] offset:0
    ds_write_b128 v10, v[148:151] offset:5120
    ds_write_b128 v10, v[152:155] offset:10240
    ds_write_b128 v10, v[156:159] offset:15360
    s_waitcnt lgkmcnt(0)
    s_barrier
    buffer_load_dwordx4 v[128:131], v1, s[8:11], s33 offen
    buffer_load_dwordx4 v[132:135], v2, s[8:11], s33 offen
    buffer_load_dwordx4 v[136:139], v3, s[8:11], s33 offen
    buffer_load_dwordx4 v[140:143], v4, s[8:11], s33 offen
    buffer_load_dwordx4 v[144:147], v5, s[12:15], s34 offen
    buffer_load_dwordx4 v[148:151], v6, s[12:15], s34 offen
    buffer_load_dwordx4 v[152:155], v7, s[12:15], s34 offen
    buffer_load_dwordx4 v[156:159], v8, s[12:15], s34 offen
    s_add_u32 s33, s33, 128
    s_add_u32 s34, s34, 65536
    ds_read_b128 v[160:163], v11 offset:0
    ds_read_b128 v[164:167], v11 offset:4608
    ds_read_b64_tr_b16 v[168:169], v12 offset:0
    ds_read_b64_tr_b16 v[170:171], v12 offset:1280
    ds_read_b64_tr_b16 v[172:173], v12 offset:64
    ds_read_b64_tr_b16 v[174:175], v12 offset:1344
    ds_read_b128 v[176:179], v11 offset:32
    ds_read_b128 v[180:183], v11 offset:4640
    ds_read_b64_tr_b16 v[184:185], v12 offset:5120
    ds_read_b64_tr_b16 v[186:187], v12 offset:6400
    ds_read_b64_tr_b16 v[188:189], v12 offset:5184
    ds_read_b64_tr_b16 v[190:191], v12 offset:6464
    s_waitcnt lgkmcnt(6)
    v_mfma_f32_32x32x16_bf16 v[64:79], v[168:171], v[160:163], v[64:79]
    v_mfma_f32_32x32x16_bf16 v[80:95], v[172:175], v[160:163], v[80:95]
    v_mfma_f32_32x32x16_bf16 v[96:111], v[168:171], v[164:167], v[96:111]
    v_mfma_f32_32x32x16_bf16 v[112:127], v[172:175], v[164:167], v[112:127]
    ds_read_b128 v[160:163], v11 offset:64
    ds_read_b128 v[164:167], v11 offset:4672
    ds_read_b64_tr_b16 v[168:169], v12 offset:10240
    ds_read_b64_tr_b16 v[170:171], v12 offset:11520
    ds_read_b64_tr_b16 v[172:173], v12 offset:10304
    ds_read_b64_tr_b16 v[174:175], v12 offset:11584
    s_waitcnt lgkmcnt(6)
    v_mfma_f32_32x32x16_bf16 v[64:79], v[184:187], v[176:179], v[64:79]
    v_mfma_f32_32x32x16_bf16 v[80:95], v[188:191], v[176:179], v[80:95]
    v_mfma_f32_32x32x16_bf16 v[96:111], v[184:187], v[180:183], v[96:111]
    v_mfma_f32_32x32x16_bf16 v[112:127], v[188:191], v[180:183], v[112:127]
    ds_read_b128 v[176:179], v11 offset:96
    ds_read_b128 v[180:183], v11 offset:4704
    ds_read_b64_tr_b16 v[184:185], v12 offset:15360
    ds_read_b64_tr_b16 v[186:187], v12 offset:16640
    ds_read_b64_tr_b16 v[188:189], v12 offset:15424
    ds_read_b64_tr_b16 v[190:191], v12 offset:16704
    s_waitcnt lgkmcnt(6)
    v_mfma_f32_32x32x16_bf16 v[64:79], v[168:171], v[160:163], v[64:79]
    v_mfma_f32_32x32x16_bf16 v[80:95], v[172:175], v[160:163], v[80:95]
    v_mfma_f32_32x32x16_bf16 v[96:111], v[168:171], v[164:167], v[96:111]
    v_mfma_f32_32x32x16_bf16 v[112:127], v[172:175], v[164:167], v[112:127]
    s_waitcnt lgkmcnt(0)
    v_mfma_f32_32x32x16_bf16 v[64:79], v[184:187], v[176:179], v[64:79]
    v_mfma_f32_32x32x16_bf16 v[80:95], v[188:191], v[176:179], v[80:95]
    v_mfma_f32_32x32x16_bf16 v[96:111], v[184:187], v[180:183], v[96:111]
    v_mfma_f32_32x32x16_bf16 v[112:127], v[188:191], v[180:183], v[112:127]
    s_waitcnt vmcnt(8)
    ds_write_b128 v9, v[192:195] offset:40960
    ds_write_b128 v9, v[196:199] offset:45568
    ds_write_b128 v9, v[200:203] offset:50176
    ds_write_b128 v9, v[204:207] offset:54784
    ds_write_b128 v10, v[208:211] offset:40960
    ds_write_b128 v10, v[212:215] offset:46080
    ds_write_b128 v10, v[216:219] offset:51200
    ds_write_b128 v10, v[220:223] offset:56320
    s_waitcnt lgkmcnt(0)
    s_barrier
    buffer_load_dwordx4 v[192:195], v1, s[8:11], s33 offen
    buffer_load_dwordx4 v[196:199], v2, s[8:11], s33 offen
    buffer_load_dwordx4 v[200:203], v3, s[8:11], s33 offen
    buffer_load_dwordx4 v[204:207], v4, s[8:11], s33 offen
    buffer_load_dwordx4 v[208:211], v5, s[12:15], s34 offen
    buffer_load_dwordx4 v[212:215], v6, s[12:15], s34 offen
    buffer_load_dwordx4 v[216:219], v7, s[12:15], s34 offen
    buffer_load_dwordx4 v[220:223], v8, s[12:15], s34 offen
    s_add_u32 s33, s33, 128
    s_add_u32 s34, s34, 65536
    ds_read_b128 v[160:163], v11 offset:40960
    ds_read_b128 v[164:167], v11 offset:45568
    ds_read_b64_tr_b16 v[168:169], v12 offset:40960
    ds_read_b64_tr_b16 v[170:171], v12 offset:42240
    ds_read_b64_tr_b16 v[172:173], v12 offset:41024
    ds_read_b64_tr_b16 v[174:175], v12 offset:42304
    ds_read_b128 v[176:179], v11 offset:40992
    ds_read_b128 v[180:183], v11 offset:45600
    ds_read_b64_tr_b16 v[184:185], v12 offset:46080
    ds_read_b64_tr_b16 v[186:187], v12 offset:47360
    ds_read_b64_tr_b16 v[188:189], v12 offset:46144
    ds_read_b64_tr_b16 v[190:191], v12 offset:47424
    s_waitcnt lgkmcnt(6)
    v_mfma_f32_32x32x16_bf16 v[64:79], v[168:171], v[160:163], v[64:79]
    v_mfma_f32_32x32x16_bf16 v[80:95], v[172:175], v[160:163], v[80:95]
    v_mfma_f32_32x32x16_bf16 v[96:111], v[168:171], v[164:167], v[96:111]
    v_mfma_f32_32x32x16_bf16 v[112:127], v[172:175], v[164:167], v[112:127]
    ds_read_b128 v[160:163], v11 offset:41024
    ds_read_b128 v[164:167], v11 offset:45632
    ds_read_b64_tr_b16 v[168:169], v12 offset:51200
    ds_read_b64_tr_b16 v[170:171], v12 offset:52480
    ds_read_b64_tr_b16 v[172:173], v12 offset:51264
    ds_read_b64_tr_b16 v[174:175], v12 offset:52544
    s_waitcnt lgkmcnt(6)
    v_mfma_f32_32x32x16_bf16 v[64:79], v[184:187], v[176:179], v[64:79]
    v_mfma_f32_32x32x16_bf16 v[80:95], v[188:191], v[176:179], v[80:95]
    v_mfma_f32_32x32x16_bf16 v[96:111], v[184:187], v[180:183], v[96:111]
    v_mfma_f32_32x32x16_bf16 v[112:127], v[188:191], v[180:183], v[112:127]
    ds_read_b128 v[176:179], v11 offset:41056
    ds_read_b128 v[180:183], v11 offset:45664
    ds_read_b64_tr_b16 v[184:185], v12 offset:56320
    ds_read_b64_tr_b16 v[186:187], v12 offset:57600
    ds_read_b64_tr_b16 v[188:189], v12 offset:56384
    ds_read_b64_tr_b16 v[190:191], v12 offset:57664
    s_waitcnt lgkmcnt(6)
    v_mfma_f32_32x32x16_bf16 v[64:79], v[168:171], v[160:163], v[64:79]
    v_mfma_f32_32x32x16_bf16 v[80:95], v[172:175], v[160:163], v[80:95]
    v_mfma_f32_32x32x16_bf16 v[96:111], v[168:171], v[164:167], v[96:111]
    v_mfma_f32_32x32x16_bf16 v[112:127], v[172:175], v[164:167], v[112:127]
    s_waitcnt lgkmcnt(0)
    v_mfma_f32_32x32x16_bf16 v[64:79], v[184:187], v[176:179], v[64:79]
    v_mfma_f32_32x32x16_bf16 v[80:95], v[188:191], v[176:179], v[80:95]
    v_mfma_f32_32x32x16_bf16 v[96:111], v[184:187], v[180:183], v[96:111]
    v_mfma_f32_32x32x16_bf16 v[112:127], v[188:191], v[180:183], v[112:127]
    s_waitcnt vmcnt(8)
    ds_write_b128 v9, v[128:131] offset:0
    ds_write_b128 v9, v[132:135] offset:4608
    ds_write_b128 v9, v[136:139] offset:9216
    ds_write_b128 v9, v[140:143] offset:13824
    ds_write_b128 v10, v[144:147] offset:0
    ds_write_b128 v10, v[148:151] offset:5120
    ds_write_b128 v10, v[152:155] offset:10240
    ds_write_b128 v10, v[156:159] offset:15360
    s_waitcnt lgkmcnt(0)
    s_barrier
    buffer_load_dwordx4 v[128:131], v1, s[8:11], s33 offen
    buffer_load_dwordx4 v[132:135], v2, s[8:11], s33 offen
    buffer_load_dwordx4 v[136:139], v3, s[8:11], s33 offen
    buffer_load_dwordx4 v[140:143], v4, s[8:11], s33 offen
    buffer_load_dwordx4 v[144:147], v5, s[12:15], s34 offen
    buffer_load_dwordx4 v[148:151], v6, s[12:15], s34 offen
    buffer_load_dwordx4 v[152:155], v7, s[12:15], s34 offen
    buffer_load_dwordx4 v[156:159], v8, s[12:15], s34 offen
    s_add_u32 s33, s33, 128
    s_add_u32 s34, s34, 65536
    ds_read_b128 v[160:163], v11 offset:0
    ds_read_b128 v[164:167], v11 offset:4608
    ds_read_b64_tr_b16 v[168:169], v12 offset:0
    ds_read_b64_tr_b16 v[170:171], v12 offset:1280
    ds_read_b64_tr_b16 v[172:173], v12 offset:64
    ds_read_b64_tr_b16 v[174:175], v12 offset:1344
    ds_read_b128 v[176:179], v11 offset:32
    ds_read_b128 v[180:183], v11 offset:4640
    ds_read_b64_tr_b16 v[184:185], v12 offset:5120
    ds_read_b64_tr_b16 v[186:187], v12 offset:6400
    ds_read_b64_tr_b16 v[188:189], v12 offset:5184
    ds_read_b64_tr_b16 v[190:191], v12 offset:6464
    s_waitcnt lgkmcnt(6)
    v_mfma_f32_32x32x16_bf16 v[64:79], v[168:171], v[160:163], v[64:79]
    v_mfma_f32_32x32x16_bf16 v[80:95], v[172:175], v[160:163], v[80:95]
    v_mfma_f32_32x32x16_bf16 v[96:111], v[168:171], v[164:167], v[96:111]
    v_mfma_f32_32x32x16_bf16 v[112:127], v[172:175], v[164:167], v[112:127]
    ds_read_b128 v[160:163], v11 offset:64
    ds_read_b128 v[164:167], v11 offset:4672
    ds_read_b64_tr_b16 v[168:169], v12 offset:10240
    ds_read_b64_tr_b16 v[170:171], v12 offset:11520
    ds_read_b64_tr_b16 v[172:173], v12 offset:10304
    ds_read_b64_tr_b16 v[174:175], v12 offset:11584
    s_waitcnt lgkmcnt(6)
    v_mfma_f32_32x32x16_bf16 v[64:79], v[184:187], v[176:179], v[64:79]
    v_mfma_f32_32x32x16_bf16 v[80:95], v[188:191], v[176:179], v[80:95]
    v_mfma_f32_32x32x16_bf16 v[96:111], v[184:187], v[180:183], v[96:111]
    v_mfma_f32_32x32x16_bf16 v[112:127], v[188:191], v[180:183], v[112:127]
    ds_read_b128 v[176:179], v11 offset:96
    ds_read_b128 v[180:183], v11 offset:4704
    ds_read_b64_tr_b16 v[184:185], v12 offset:15360
    ds_read_b64_tr_b16 v[186:187], v12 offset:16640
    ds_read_b64_tr_b16 v[188:189], v12 offset:15424
    ds_read_b64_tr_b16 v[190:191], v12 offset:16704
    s_waitcnt lgkmcnt(6)
    v_mfma_f32_32x32x16_bf16 v[64:79], v[168:171], v[160:163], v[64:79]
    v_mfma_f32_32x32x16_bf16 v[80:95], v[172:175], v[160:163], v[80:95]
    v_mfma_f32_32x32x16_bf16 v[96:111], v[168:171], v[164:167], v[96:111]
    v_mfma_f32_32x32x16_bf16 v[112:127], v[172:175], v[164:167], v[112:127]
    s_waitcnt lgkmcnt(0)
    v_mfma_f32_32x32x16_bf16 v[64:79], v[184:187], v[176:179], v[64:79]
    v_mfma_f32_32x32x16_bf16 v[80:95], v[188:191], v[176:179], v[80:95]
    v_mfma_f32_32x32x16_bf16 v[96:111], v[184:187], v[180:183], v[96:111]
    v_mfma_f32_32x32x16_bf16 v[112:127], v[188:191], v[180:183], v[112:127]
    s_waitcnt vmcnt(8)
    ds_write_b128 v9, v[192:195] offset:40960
    ds_write_b128 v9, v[196:199] offset:45568
    ds_write_b128 v9, v[200:203] offset:50176
    ds_write_b128 v9, v[204:207] offset:54784
    ds_write_b128 v10, v[208:211] offset:40960
    ds_write_b128 v10, v[212:215] offset:46080
    ds_write_b128 v10, v[216:219] offset:51200
    ds_write_b128 v10, v[220:223] offset:56320
    s_waitcnt lgkmcnt(0)
    s_barrier
    buffer_load_dwordx4 v[192:195], v1, s[8:11], s33 offen
    buffer_load_dwordx4 v[196:199], v2, s[8:11], s33 offen
    buffer_load_dwordx4 v[200:203], v3, s[8:11], s33 offen
    buffer_load_dwordx4 v[204:207], v4, s[8:11], s33 offen
    buffer_load_dwordx4 v[208:211], v5, s[12:15], s34 offen
    buffer_load_dwordx4 v[212:215], v6, s[12:15], s34 offen
    buffer_load_dwordx4 v[216:219], v7, s[12:15], s34 offen
    buffer_load_dwordx4 v[220:223], v8, s[12:15], s34 offen
    s_add_u32 s33, s33, 128
    s_add_u32 s34, s34, 65536
    ds_read_b128 v[160:163], v11 offset:40960
    ds_read_b128 v[164:167], v11 offset:45568
    ds_read_b64_tr_b16 v[168:169], v12 offset:40960
    ds_read_b64_tr_b16 v[170:171], v12 offset:42240
    ds_read_b64_tr_b16 v[172:173], v12 offset:41024
    ds_read_b64_tr_b16 v[174:175], v12 offset:42304
    ds_read_b128 v[176:179], v11 offset:40992
    ds_read_b128 v[180:183], v11 offset:45600
    ds_read_b64_tr_b16 v[184:185], v12 offset:46080
    ds_read_b64_tr_b16 v[186:187], v12 offset:47360
    ds_read_b64_tr_b16 v[188:189], v12 offset:46144
    ds_read_b64_tr_b16 v[190:191], v12 offset:47424
    s_waitcnt lgkmcnt(6)
    v_mfma_f32_32x32x16_bf16 v[64:79], v[168:171], v[160:163], v[64:79]
    v_mfma_f32_32x32x16_bf16 v[80:95], v[172:175], v[160:163], v[80:95]
    v_mfma_f32_32x32x16_bf16 v[96:111], v[168:171], v[164:167], v[96:111]
    v_mfma_f32_32x32x16_bf16 v[112:127], v[172:175], v[164:167], v[112:127]
    ds_read_b128 v[160:163], v11 offset:41024
    ds_read_b128 v[164:167], v11 offset:45632
    ds_read_b64_tr_b16 v[168:169], v12 offset:51200
    ds_read_b64_tr_b16 v[170:171], v12 offset:52480
    ds_read_b64_tr_b16 v[172:173], v12 offset:51264
    ds_read_b64_tr_b16 v[174:175], v12 offset:52544
    s_waitcnt lgkmcnt(6)
    v_mfma_f32_32x32x16_bf16 v[64:79], v[184:187], v[176:179], v[64:79]
    v_mfma_f32_32x32x16_bf16 v[80:95], v[188:191], v[176:179], v[80:95]
    v_mfma_f32_32x32x16_bf16 v[96:111], v[184:187], v[180:183], v[96:111]
    v_mfma_f32_32x32x16_bf16 v[112:127], v[188:191], v[180:183], v[112:127]
    ds_read_b128 v[176:179], v11 offset:41056
    ds_read_b128 v[180:183], v11 offset:45664
    ds_read_b64_tr_b16 v[184:185], v12 offset:56320
    ds_read_b64_tr_b16 v[186:187], v12 offset:57600
    ds_read_b64_tr_b16 v[188:189], v12 offset:56384
    ds_read_b64_tr_b16 v[190:191], v12 offset:57664
    s_waitcnt lgkmcnt(6)
    v_mfma_f32_32x32x16_bf16 v[64:79], v[168:171], v[160:163], v[64:79]
    v_mfma_f32_32x32x16_bf16 v[80:95], v[172:175], v[160:163], v[80:95]
    v_mfma_f32_32x32x16_bf16 v[96:111], v[168:171], v[164:167], v[96:111]
    v_mfma_f32_32x32x16_bf16 v[112:127], v[172:175], v[164:167], v[112:127]
    s_waitcnt lgkmcnt(0)
    v_mfma_f32_32x32x16_bf16 v[64:79], v[184:187], v[176:179], v[64:79]
    v_mfma_f32_32x32x16_bf16 v[80:95], v[188:191], v[176:179], v[80:95]
    v_mfma_f32_32x32x16_bf16 v[96:111], v[184:187], v[180:183], v[96:111]
    v_mfma_f32_32x32x16_bf16 v[112:127], v[188:191], v[180:183], v[112:127]
    s_waitcnt vmcnt(8)
    ds_write_b128 v9, v[128:131] offset:0
    ds_write_b128 v9, v[132:135] offset:4608
    ds_write_b128 v9, v[136:139] offset:9216
    ds_write_b128 v9, v[140:143] offset:13824
    ds_write_b128 v10, v[144:147] offset:0
    ds_write_b128 v10, v[148:151] offset:5120
    ds_write_b128 v10, v[152:155] offset:10240
    ds_write_b128 v10, v[156:159] offset:15360
    s_waitcnt lgkmcnt(0)
    s_barrier
    buffer_load_dwordx4 v[128:131], v1, s[8:11], s33 offen
    buffer_load_dwordx4 v[132:135], v2, s[8:11], s33 offen
    buffer_load_dwordx4 v[136:139], v3, s[8:11], s33 offen
    buffer_load_dwordx4 v[140:143], v4, s[8:11], s33 offen
    buffer_load_dwordx4 v[144:147], v5, s[12:15], s34 offen
    buffer_load_dwordx4 v[148:151], v6, s[12:15], s34 offen
    buffer_load_dwordx4 v[152:155], v7, s[12:15], s34 offen
    buffer_load_dwordx4 v[156:159], v8, s[12:15], s34 offen
    s_add_u32 s33, s33, 128
    s_add_u32 s34, s34, 65536
    ds_read_b128 v[160:163], v11 offset:0
    ds_read_b128 v[164:167], v11 offset:4608
    ds_read_b64_tr_b16 v[168:169], v12 offset:0
    ds_read_b64_tr_b16 v[170:171], v12 offset:1280
    ds_read_b64_tr_b16 v[172:173], v12 offset:64
    ds_read_b64_tr_b16 v[174:175], v12 offset:1344
    ds_read_b128 v[176:179], v11 offset:32
    ds_read_b128 v[180:183], v11 offset:4640
    ds_read_b64_tr_b16 v[184:185], v12 offset:5120
    ds_read_b64_tr_b16 v[186:187], v12 offset:6400
    ds_read_b64_tr_b16 v[188:189], v12 offset:5184
    ds_read_b64_tr_b16 v[190:191], v12 offset:6464
    s_waitcnt lgkmcnt(6)
    v_mfma_f32_32x32x16_bf16 v[64:79], v[168:171], v[160:163], v[64:79]
    v_mfma_f32_32x32x16_bf16 v[80:95], v[172:175], v[160:163], v[80:95]
    v_mfma_f32_32x32x16_bf16 v[96:111], v[168:171], v[164:167], v[96:111]
    v_mfma_f32_32x32x16_bf16 v[112:127], v[172:175], v[164:167], v[112:127]
    ds_read_b128 v[160:163], v11 offset:64
    ds_read_b128 v[164:167], v11 offset:4672
    ds_read_b64_tr_b16 v[168:169], v12 offset:10240
    ds_read_b64_tr_b16 v[170:171], v12 offset:11520
    ds_read_b64_tr_b16 v[172:173], v12 offset:10304
    ds_read_b64_tr_b16 v[174:175], v12 offset:11584
    s_waitcnt lgkmcnt(6)
    v_mfma_f32_32x32x16_bf16 v[64:79], v[184:187], v[176:179], v[64:79]
    v_mfma_f32_32x32x16_bf16 v[80:95], v[188:191], v[176:179], v[80:95]
    v_mfma_f32_32x32x16_bf16 v[96:111], v[184:187], v[180:183], v[96:111]
    v_mfma_f32_32x32x16_bf16 v[112:127], v[188:191], v[180:183], v[112:127]
    ds_read_b128 v[176:179], v11 offset:96
    ds_read_b128 v[180:183], v11 offset:4704
    ds_read_b64_tr_b16 v[184:185], v12 offset:15360
    ds_read_b64_tr_b16 v[186:187], v12 offset:16640
    ds_read_b64_tr_b16 v[188:189], v12 offset:15424
    ds_read_b64_tr_b16 v[190:191], v12 offset:16704
    s_waitcnt lgkmcnt(6)
    v_mfma_f32_32x32x16_bf16 v[64:79], v[168:171], v[160:163], v[64:79]
    v_mfma_f32_32x32x16_bf16 v[80:95], v[172:175], v[160:163], v[80:95]
    v_mfma_f32_32x32x16_bf16 v[96:111], v[168:171], v[164:167], v[96:111]
    v_mfma_f32_32x32x16_bf16 v[112:127], v[172:175], v[164:167], v[112:127]
    s_waitcnt lgkmcnt(0)
    v_mfma_f32_32x32x16_bf16 v[64:79], v[184:187], v[176:179], v[64:79]
    v_mfma_f32_32x32x16_bf16 v[80:95], v[188:191], v[176:179], v[80:95]
    v_mfma_f32_32x32x16_bf16 v[96:111], v[184:187], v[180:183], v[96:111]
    v_mfma_f32_32x32x16_bf16 v[112:127], v[188:191], v[180:183], v[112:127]
    s_waitcnt vmcnt(8)
    ds_write_b128 v9, v[192:195] offset:40960
    ds_write_b128 v9, v[196:199] offset:45568
    ds_write_b128 v9, v[200:203] offset:50176
    ds_write_b128 v9, v[204:207] offset:54784
    ds_write_b128 v10, v[208:211] offset:40960
    ds_write_b128 v10, v[212:215] offset:46080
    ds_write_b128 v10, v[216:219] offset:51200
    ds_write_b128 v10, v[220:223] offset:56320
    s_waitcnt lgkmcnt(0)
    s_barrier
    buffer_load_dwordx4 v[192:195], v1, s[8:11], s33 offen
    buffer_load_dwordx4 v[196:199], v2, s[8:11], s33 offen
    buffer_load_dwordx4 v[200:203], v3, s[8:11], s33 offen
    buffer_load_dwordx4 v[204:207], v4, s[8:11], s33 offen
    buffer_load_dwordx4 v[208:211], v5, s[12:15], s34 offen
    buffer_load_dwordx4 v[212:215], v6, s[12:15], s34 offen
    buffer_load_dwordx4 v[216:219], v7, s[12:15], s34 offen
    buffer_load_dwordx4 v[220:223], v8, s[12:15], s34 offen
    s_add_u32 s33, s33, 128
    s_add_u32 s34, s34, 65536
    ds_read_b128 v[160:163], v11 offset:40960
    ds_read_b128 v[164:167], v11 offset:45568
    ds_read_b64_tr_b16 v[168:169], v12 offset:40960
    ds_read_b64_tr_b16 v[170:171], v12 offset:42240
    ds_read_b64_tr_b16 v[172:173], v12 offset:41024
    ds_read_b64_tr_b16 v[174:175], v12 offset:42304
    ds_read_b128 v[176:179], v11 offset:40992
    ds_read_b128 v[180:183], v11 offset:45600
    ds_read_b64_tr_b16 v[184:185], v12 offset:46080
    ds_read_b64_tr_b16 v[186:187], v12 offset:47360
    ds_read_b64_tr_b16 v[188:189], v12 offset:46144
    ds_read_b64_tr_b16 v[190:191], v12 offset:47424
    s_waitcnt lgkmcnt(6)
    v_mfma_f32_32x32x16_bf16 v[64:79], v[168:171], v[160:163], v[64:79]
    v_mfma_f32_32x32x16_bf16 v[80:95], v[172:175], v[160:163], v[80:95]
    v_mfma_f32_32x32x16_bf16 v[96:111], v[168:171], v[164:167], v[96:111]
    v_mfma_f32_32x32x16_bf16 v[112:127], v[172:175], v[164:167], v[112:127]
    ds_read_b128 v[160:163], v11 offset:41024
    ds_read_b128 v[164:167], v11 offset:45632
    ds_read_b64_tr_b16 v[168:169], v12 offset:51200
    ds_read_b64_tr_b16 v[170:171], v12 offset:52480
    ds_read_b64_tr_b16 v[172:173], v12 offset:51264
    ds_read_b64_tr_b16 v[174:175], v12 offset:52544
    s_waitcnt lgkmcnt(6)
    v_mfma_f32_32x32x16_bf16 v[64:79], v[184:187], v[176:179], v[64:79]
    v_mfma_f32_32x32x16_bf16 v[80:95], v[188:191], v[176:179], v[80:95]
    v_mfma_f32_32x32x16_bf16 v[96:111], v[184:187], v[180:183], v[96:111]
    v_mfma_f32_32x32x16_bf16 v[112:127], v[188:191], v[180:183], v[112:127]
    ds_read_b128 v[176:179], v11 offset:41056
    ds_read_b128 v[180:183], v11 offset:45664
    ds_read_b64_tr_b16 v[184:185], v12 offset:56320
    ds_read_b64_tr_b16 v[186:187], v12 offset:57600
    ds_read_b64_tr_b16 v[188:189], v12 offset:56384
    ds_read_b64_tr_b16 v[190:191], v12 offset:57664
    s_waitcnt lgkmcnt(6)
    v_mfma_f32_32x32x16_bf16 v[64:79], v[168:171], v[160:163], v[64:79]
    v_mfma_f32_32x32x16_bf16 v[80:95], v[172:175], v[160:163], v[80:95]
    v_mfma_f32_32x32x16_bf16 v[96:111], v[168:171], v[164:167], v[96:111]
    v_mfma_f32_32x32x16_bf16 v[112:127], v[172:175], v[164:167], v[112:127]
    s_waitcnt lgkmcnt(0)
    v_mfma_f32_32x32x16_bf16 v[64:79], v[184:187], v[176:179], v[64:79]
    v_mfma_f32_32x32x16_bf16 v[80:95], v[188:191], v[176:179], v[80:95]
    v_mfma_f32_32x32x16_bf16 v[96:111], v[184:187], v[180:183], v[96:111]
    v_mfma_f32_32x32x16_bf16 v[112:127], v[188:191], v[180:183], v[112:127]
    s_waitcnt vmcnt(8)
    ds_write_b128 v9, v[128:131] offset:0
    ds_write_b128 v9, v[132:135] offset:4608
    ds_write_b128 v9, v[136:139] offset:9216
    ds_write_b128 v9, v[140:143] offset:13824
    ds_write_b128 v10, v[144:147] offset:0
    ds_write_b128 v10, v[148:151] offset:5120
    ds_write_b128 v10, v[152:155] offset:10240
    ds_write_b128 v10, v[156:159] offset:15360
    s_waitcnt lgkmcnt(0)
    s_barrier
    buffer_load_dwordx4 v[128:131], v1, s[8:11], s33 offen
    buffer_load_dwordx4 v[132:135], v2, s[8:11], s33 offen
    buffer_load_dwordx4 v[136:139], v3, s[8:11], s33 offen
    buffer_load_dwordx4 v[140:143], v4, s[8:11], s33 offen
    buffer_load_dwordx4 v[144:147], v5, s[12:15], s34 offen
    buffer_load_dwordx4 v[148:151], v6, s[12:15], s34 offen
    buffer_load_dwordx4 v[152:155], v7, s[12:15], s34 offen
    buffer_load_dwordx4 v[156:159], v8, s[12:15], s34 offen
    s_add_u32 s33, s33, 128
    s_add_u32 s34, s34, 65536
    ds_read_b128 v[160:163], v11 offset:0
    ds_read_b128 v[164:167], v11 offset:4608
    ds_read_b64_tr_b16 v[168:169], v12 offset:0
    ds_read_b64_tr_b16 v[170:171], v12 offset:1280
    ds_read_b64_tr_b16 v[172:173], v12 offset:64
    ds_read_b64_tr_b16 v[174:175], v12 offset:1344
    ds_read_b128 v[176:179], v11 offset:32
    ds_read_b128 v[180:183], v11 offset:4640
    ds_read_b64_tr_b16 v[184:185], v12 offset:5120
    ds_read_b64_tr_b16 v[186:187], v12 offset:6400
    ds_read_b64_tr_b16 v[188:189], v12 offset:5184
    ds_read_b64_tr_b16 v[190:191], v12 offset:6464
    s_waitcnt lgkmcnt(6)
    v_mfma_f32_32x32x16_bf16 v[64:79], v[168:171], v[160:163], v[64:79]
    v_mfma_f32_32x32x16_bf16 v[80:95], v[172:175], v[160:163], v[80:95]
    v_mfma_f32_32x32x16_bf16 v[96:111], v[168:171], v[164:167], v[96:111]
    v_mfma_f32_32x32x16_bf16 v[112:127], v[172:175], v[164:167], v[112:127]
    ds_read_b128 v[160:163], v11 offset:64
    ds_read_b128 v[164:167], v11 offset:4672
    ds_read_b64_tr_b16 v[168:169], v12 offset:10240
    ds_read_b64_tr_b16 v[170:171], v12 offset:11520
    ds_read_b64_tr_b16 v[172:173], v12 offset:10304
    ds_read_b64_tr_b16 v[174:175], v12 offset:11584
    s_waitcnt lgkmcnt(6)
    v_mfma_f32_32x32x16_bf16 v[64:79], v[184:187], v[176:179], v[64:79]
    v_mfma_f32_32x32x16_bf16 v[80:95], v[188:191], v[176:179], v[80:95]
    v_mfma_f32_32x32x16_bf16 v[96:111], v[184:187], v[180:183], v[96:111]
    v_mfma_f32_32x32x16_bf16 v[112:127], v[188:191], v[180:183], v[112:127]
    ds_read_b128 v[176:179], v11 offset:96
    ds_read_b128 v[180:183], v11 offset:4704
    ds_read_b64_tr_b16 v[184:185], v12 offset:15360
    ds_read_b64_tr_b16 v[186:187], v12 offset:16640
    ds_read_b64_tr_b16 v[188:189], v12 offset:15424
    ds_read_b64_tr_b16 v[190:191], v12 offset:16704
    s_waitcnt lgkmcnt(6)
    v_mfma_f32_32x32x16_bf16 v[64:79], v[168:171], v[160:163], v[64:79]
    v_mfma_f32_32x32x16_bf16 v[80:95], v[172:175], v[160:163], v[80:95]
    v_mfma_f32_32x32x16_bf16 v[96:111], v[168:171], v[164:167], v[96:111]
    v_mfma_f32_32x32x16_bf16 v[112:127], v[172:175], v[164:167], v[112:127]
    s_waitcnt lgkmcnt(0)
    v_mfma_f32_32x32x16_bf16 v[64:79], v[184:187], v[176:179], v[64:79]
    v_mfma_f32_32x32x16_bf16 v[80:95], v[188:191], v[176:179], v[80:95]
    v_mfma_f32_32x32x16_bf16 v[96:111], v[184:187], v[180:183], v[96:111]
    v_mfma_f32_32x32x16_bf16 v[112:127], v[188:191], v[180:183], v[112:127]
    s_waitcnt vmcnt(8)
    ds_write_b128 v9, v[192:195] offset:40960
    ds_write_b128 v9, v[196:199] offset:45568
    ds_write_b128 v9, v[200:203] offset:50176
    ds_write_b128 v9, v[204:207] offset:54784
    ds_write_b128 v10, v[208:211] offset:40960
    ds_write_b128 v10, v[212:215] offset:46080
    ds_write_b128 v10, v[216:219] offset:51200
    ds_write_b128 v10, v[220:223] offset:56320
    s_waitcnt lgkmcnt(0)
    s_barrier
    buffer_load_dwordx4 v[192:195], v1, s[8:11], s33 offen
    buffer_load_dwordx4 v[196:199], v2, s[8:11], s33 offen
    buffer_load_dwordx4 v[200:203], v3, s[8:11], s33 offen
    buffer_load_dwordx4 v[204:207], v4, s[8:11], s33 offen
    buffer_load_dwordx4 v[208:211], v5, s[12:15], s34 offen
    buffer_load_dwordx4 v[212:215], v6, s[12:15], s34 offen
    buffer_load_dwordx4 v[216:219], v7, s[12:15], s34 offen
    buffer_load_dwordx4 v[220:223], v8, s[12:15], s34 offen
    s_add_u32 s33, s33, 128
    s_add_u32 s34, s34, 65536
    ds_read_b128 v[160:163], v11 offset:40960
    ds_read_b128 v[164:167], v11 offset:45568
    ds_read_b64_tr_b16 v[168:169], v12 offset:40960
    ds_read_b64_tr_b16 v[170:171], v12 offset:42240
    ds_read_b64_tr_b16 v[172:173], v12 offset:41024
    ds_read_b64_tr_b16 v[174:175], v12 offset:42304
    ds_read_b128 v[176:179], v11 offset:40992
    ds_read_b128 v[180:183], v11 offset:45600
    ds_read_b64_tr_b16 v[184:185], v12 offset:46080
    ds_read_b64_tr_b16 v[186:187], v12 offset:47360
    ds_read_b64_tr_b16 v[188:189], v12 offset:46144
    ds_read_b64_tr_b16 v[190:191], v12 offset:47424
    s_waitcnt lgkmcnt(6)
    v_mfma_f32_32x32x16_bf16 v[64:79], v[168:171], v[160:163], v[64:79]
    v_mfma_f32_32x32x16_bf16 v[80:95], v[172:175], v[160:163], v[80:95]
    v_mfma_f32_32x32x16_bf16 v[96:111], v[168:171], v[164:167], v[96:111]
    v_mfma_f32_32x32x16_bf16 v[112:127], v[172:175], v[164:167], v[112:127]
    ds_read_b128 v[160:163], v11 offset:41024
    ds_read_b128 v[164:167], v11 offset:45632
    ds_read_b64_tr_b16 v[168:169], v12 offset:51200
    ds_read_b64_tr_b16 v[170:171], v12 offset:52480
    ds_read_b64_tr_b16 v[172:173], v12 offset:51264
    ds_read_b64_tr_b16 v[174:175], v12 offset:52544
    s_waitcnt lgkmcnt(6)
    v_mfma_f32_32x32x16_bf16 v[64:79], v[184:187], v[176:179], v[64:79]
    v_mfma_f32_32x32x16_bf16 v[80:95], v[188:191], v[176:179], v[80:95]
    v_mfma_f32_32x32x16_bf16 v[96:111], v[184:187], v[180:183], v[96:111]
    v_mfma_f32_32x32x16_bf16 v[112:127], v[188:191], v[180:183], v[112:127]
    ds_read_b128 v[176:179], v11 offset:41056
    ds_read_b128 v[180:183], v11 offset:45664
    ds_read_b64_tr_b16 v[184:185], v12 offset:56320
    ds_read_b64_tr_b16 v[186:187], v12 offset:57600
    ds_read_b64_tr_b16 v[188:189], v12 offset:56384
    ds_read_b64_tr_b16 v[190:191], v12 offset:57664
    s_waitcnt lgkmcnt(6)
    v_mfma_f32_32x32x16_bf16 v[64:79], v[168:171], v[160:163], v[64:79]
    v_mfma_f32_32x32x16_bf16 v[80:95], v[172:175], v[160:163], v[80:95]
    v_mfma_f32_32x32x16_bf16 v[96:111], v[168:171], v[164:167], v[96:111]
    v_mfma_f32_32x32x16_bf16 v[112:127], v[172:175], v[164:167], v[112:127]
    s_waitcnt lgkmcnt(0)
    v_mfma_f32_32x32x16_bf16 v[64:79], v[184:187], v[176:179], v[64:79]
    v_mfma_f32_32x32x16_bf16 v[80:95], v[188:191], v[176:179], v[80:95]
    v_mfma_f32_32x32x16_bf16 v[96:111], v[184:187], v[180:183], v[96:111]
    v_mfma_f32_32x32x16_bf16 v[112:127], v[188:191], v[180:183], v[112:127]
    s_waitcnt vmcnt(8)
    ds_write_b128 v9, v[128:131] offset:0
    ds_write_b128 v9, v[132:135] offset:4608
    ds_write_b128 v9, v[136:139] offset:9216
    ds_write_b128 v9, v[140:143] offset:13824
    ds_write_b128 v10, v[144:147] offset:0
    ds_write_b128 v10, v[148:151] offset:5120
    ds_write_b128 v10, v[152:155] offset:10240
    ds_write_b128 v10, v[156:159] offset:15360
    s_waitcnt lgkmcnt(0)
    s_barrier
    buffer_load_dwordx4 v[128:131], v1, s[8:11], s33 offen
    buffer_load_dwordx4 v[132:135], v2, s[8:11], s33 offen
    buffer_load_dwordx4 v[136:139], v3, s[8:11], s33 offen
    buffer_load_dwordx4 v[140:143], v4, s[8:11], s33 offen
    buffer_load_dwordx4 v[144:147], v5, s[12:15], s34 offen
    buffer_load_dwordx4 v[148:151], v6, s[12:15], s34 offen
    buffer_load_dwordx4 v[152:155], v7, s[12:15], s34 offen
    buffer_load_dwordx4 v[156:159], v8, s[12:15], s34 offen
    s_add_u32 s33, s33, 128
    s_add_u32 s34, s34, 65536
    ds_read_b128 v[160:163], v11 offset:0
    ds_read_b128 v[164:167], v11 offset:4608
    ds_read_b64_tr_b16 v[168:169], v12 offset:0
    ds_read_b64_tr_b16 v[170:171], v12 offset:1280
    ds_read_b64_tr_b16 v[172:173], v12 offset:64
    ds_read_b64_tr_b16 v[174:175], v12 offset:1344
    ds_read_b128 v[176:179], v11 offset:32
    ds_read_b128 v[180:183], v11 offset:4640
    ds_read_b64_tr_b16 v[184:185], v12 offset:5120
    ds_read_b64_tr_b16 v[186:187], v12 offset:6400
    ds_read_b64_tr_b16 v[188:189], v12 offset:5184
    ds_read_b64_tr_b16 v[190:191], v12 offset:6464
    s_waitcnt lgkmcnt(6)
    v_mfma_f32_32x32x16_bf16 v[64:79], v[168:171], v[160:163], v[64:79]
    v_mfma_f32_32x32x16_bf16 v[80:95], v[172:175], v[160:163], v[80:95]
    v_mfma_f32_32x32x16_bf16 v[96:111], v[168:171], v[164:167], v[96:111]
    v_mfma_f32_32x32x16_bf16 v[112:127], v[172:175], v[164:167], v[112:127]
    ds_read_b128 v[160:163], v11 offset:64
    ds_read_b128 v[164:167], v11 offset:4672
    ds_read_b64_tr_b16 v[168:169], v12 offset:10240
    ds_read_b64_tr_b16 v[170:171], v12 offset:11520
    ds_read_b64_tr_b16 v[172:173], v12 offset:10304
    ds_read_b64_tr_b16 v[174:175], v12 offset:11584
    s_waitcnt lgkmcnt(6)
    v_mfma_f32_32x32x16_bf16 v[64:79], v[184:187], v[176:179], v[64:79]
    v_mfma_f32_32x32x16_bf16 v[80:95], v[188:191], v[176:179], v[80:95]
    v_mfma_f32_32x32x16_bf16 v[96:111], v[184:187], v[180:183], v[96:111]
    v_mfma_f32_32x32x16_bf16 v[112:127], v[188:191], v[180:183], v[112:127]
    ds_read_b128 v[176:179], v11 offset:96
    ds_read_b128 v[180:183], v11 offset:4704
    ds_read_b64_tr_b16 v[184:185], v12 offset:15360
    ds_read_b64_tr_b16 v[186:187], v12 offset:16640
    ds_read_b64_tr_b16 v[188:189], v12 offset:15424
    ds_read_b64_tr_b16 v[190:191], v12 offset:16704
    s_waitcnt lgkmcnt(6)
    v_mfma_f32_32x32x16_bf16 v[64:79], v[168:171], v[160:163], v[64:79]
    v_mfma_f32_32x32x16_bf16 v[80:95], v[172:175], v[160:163], v[80:95]
    v_mfma_f32_32x32x16_bf16 v[96:111], v[168:171], v[164:167], v[96:111]
    v_mfma_f32_32x32x16_bf16 v[112:127], v[172:175], v[164:167], v[112:127]
    s_waitcnt lgkmcnt(0)
    v_mfma_f32_32x32x16_bf16 v[64:79], v[184:187], v[176:179], v[64:79]
    v_mfma_f32_32x32x16_bf16 v[80:95], v[188:191], v[176:179], v[80:95]
    v_mfma_f32_32x32x16_bf16 v[96:111], v[184:187], v[180:183], v[96:111]
    v_mfma_f32_32x32x16_bf16 v[112:127], v[188:191], v[180:183], v[112:127]
    s_waitcnt vmcnt(8)
    ds_write_b128 v9, v[192:195] offset:40960
    ds_write_b128 v9, v[196:199] offset:45568
    ds_write_b128 v9, v[200:203] offset:50176
    ds_write_b128 v9, v[204:207] offset:54784
    ds_write_b128 v10, v[208:211] offset:40960
    ds_write_b128 v10, v[212:215] offset:46080
    ds_write_b128 v10, v[216:219] offset:51200
    ds_write_b128 v10, v[220:223] offset:56320
    s_waitcnt lgkmcnt(0)
    s_barrier
    buffer_load_dwordx4 v[192:195], v1, s[8:11], s33 offen
    buffer_load_dwordx4 v[196:199], v2, s[8:11], s33 offen
    buffer_load_dwordx4 v[200:203], v3, s[8:11], s33 offen
    buffer_load_dwordx4 v[204:207], v4, s[8:11], s33 offen
    buffer_load_dwordx4 v[208:211], v5, s[12:15], s34 offen
    buffer_load_dwordx4 v[212:215], v6, s[12:15], s34 offen
    buffer_load_dwordx4 v[216:219], v7, s[12:15], s34 offen
    buffer_load_dwordx4 v[220:223], v8, s[12:15], s34 offen
    s_add_u32 s33, s33, 128
    s_add_u32 s34, s34, 65536
    ds_read_b128 v[160:163], v11 offset:40960
    ds_read_b128 v[164:167], v11 offset:45568
    ds_read_b64_tr_b16 v[168:169], v12 offset:40960
    ds_read_b64_tr_b16 v[170:171], v12 offset:42240
    ds_read_b64_tr_b16 v[172:173], v12 offset:41024
    ds_read_b64_tr_b16 v[174:175], v12 offset:42304
    ds_read_b128 v[176:179], v11 offset:40992
    ds_read_b128 v[180:183], v11 offset:45600
    ds_read_b64_tr_b16 v[184:185], v12 offset:46080
    ds_read_b64_tr_b16 v[186:187], v12 offset:47360
    ds_read_b64_tr_b16 v[188:189], v12 offset:46144
    ds_read_b64_tr_b16 v[190:191], v12 offset:47424
    s_waitcnt lgkmcnt(6)
    v_mfma_f32_32x32x16_bf16 v[64:79], v[168:171], v[160:163], v[64:79]
    v_mfma_f32_32x32x16_bf16 v[80:95], v[172:175], v[160:163], v[80:95]
    v_mfma_f32_32x32x16_bf16 v[96:111], v[168:171], v[164:167], v[96:111]
    v_mfma_f32_32x32x16_bf16 v[112:127], v[172:175], v[164:167], v[112:127]
    ds_read_b128 v[160:163], v11 offset:41024
    ds_read_b128 v[164:167], v11 offset:45632
    ds_read_b64_tr_b16 v[168:169], v12 offset:51200
    ds_read_b64_tr_b16 v[170:171], v12 offset:52480
    ds_read_b64_tr_b16 v[172:173], v12 offset:51264
    ds_read_b64_tr_b16 v[174:175], v12 offset:52544
    s_waitcnt lgkmcnt(6)
    v_mfma_f32_32x32x16_bf16 v[64:79], v[184:187], v[176:179], v[64:79]
    v_mfma_f32_32x32x16_bf16 v[80:95], v[188:191], v[176:179], v[80:95]
    v_mfma_f32_32x32x16_bf16 v[96:111], v[184:187], v[180:183], v[96:111]
    v_mfma_f32_32x32x16_bf16 v[112:127], v[188:191], v[180:183], v[112:127]
    ds_read_b128 v[176:179], v11 offset:41056
    ds_read_b128 v[180:183], v11 offset:45664
    ds_read_b64_tr_b16 v[184:185], v12 offset:56320
    ds_read_b64_tr_b16 v[186:187], v12 offset:57600
    ds_read_b64_tr_b16 v[188:189], v12 offset:56384
    ds_read_b64_tr_b16 v[190:191], v12 offset:57664
    s_waitcnt lgkmcnt(6)
    v_mfma_f32_32x32x16_bf16 v[64:79], v[168:171], v[160:163], v[64:79]
    v_mfma_f32_32x32x16_bf16 v[80:95], v[172:175], v[160:163], v[80:95]
    v_mfma_f32_32x32x16_bf16 v[96:111], v[168:171], v[164:167], v[96:111]
    v_mfma_f32_32x32x16_bf16 v[112:127], v[172:175], v[164:167], v[112:127]
    s_waitcnt lgkmcnt(0)
    v_mfma_f32_32x32x16_bf16 v[64:79], v[184:187], v[176:179], v[64:79]
    v_mfma_f32_32x32x16_bf16 v[80:95], v[188:191], v[176:179], v[80:95]
    v_mfma_f32_32x32x16_bf16 v[96:111], v[184:187], v[180:183], v[96:111]
    v_mfma_f32_32x32x16_bf16 v[112:127], v[188:191], v[180:183], v[112:127]
    s_waitcnt vmcnt(8)
    ds_write_b128 v9, v[128:131] offset:0
    ds_write_b128 v9, v[132:135] offset:4608
    ds_write_b128 v9, v[136:139] offset:9216
    ds_write_b128 v9, v[140:143] offset:13824
    ds_write_b128 v10, v[144:147] offset:0
    ds_write_b128 v10, v[148:151] offset:5120
    ds_write_b128 v10, v[152:155] offset:10240
    ds_write_b128 v10, v[156:159] offset:15360
    s_waitcnt lgkmcnt(0)
    s_barrier
    buffer_load_dwordx4 v[128:131], v1, s[8:11], s33 offen
    buffer_load_dwordx4 v[132:135], v2, s[8:11], s33 offen
    buffer_load_dwordx4 v[136:139], v3, s[8:11], s33 offen
    buffer_load_dwordx4 v[140:143], v4, s[8:11], s33 offen
    buffer_load_dwordx4 v[144:147], v5, s[12:15], s34 offen
    buffer_load_dwordx4 v[148:151], v6, s[12:15], s34 offen
    buffer_load_dwordx4 v[152:155], v7, s[12:15], s34 offen
    buffer_load_dwordx4 v[156:159], v8, s[12:15], s34 offen
    s_add_u32 s33, s33, 128
    s_add_u32 s34, s34, 65536
    ds_read_b128 v[160:163], v11 offset:0
    ds_read_b128 v[164:167], v11 offset:4608
    ds_read_b64_tr_b16 v[168:169], v12 offset:0
    ds_read_b64_tr_b16 v[170:171], v12 offset:1280
    ds_read_b64_tr_b16 v[172:173], v12 offset:64
    ds_read_b64_tr_b16 v[174:175], v12 offset:1344
    ds_read_b128 v[176:179], v11 offset:32
    ds_read_b128 v[180:183], v11 offset:4640
    ds_read_b64_tr_b16 v[184:185], v12 offset:5120
    ds_read_b64_tr_b16 v[186:187], v12 offset:6400
    ds_read_b64_tr_b16 v[188:189], v12 offset:5184
    ds_read_b64_tr_b16 v[190:191], v12 offset:6464
    s_waitcnt lgkmcnt(6)
    v_mfma_f32_32x32x16_bf16 v[64:79], v[168:171], v[160:163], v[64:79]
    v_mfma_f32_32x32x16_bf16 v[80:95], v[172:175], v[160:163], v[80:95]
    v_mfma_f32_32x32x16_bf16 v[96:111], v[168:171], v[164:167], v[96:111]
    v_mfma_f32_32x32x16_bf16 v[112:127], v[172:175], v[164:167], v[112:127]
    ds_read_b128 v[160:163], v11 offset:64
    ds_read_b128 v[164:167], v11 offset:4672
    ds_read_b64_tr_b16 v[168:169], v12 offset:10240
    ds_read_b64_tr_b16 v[170:171], v12 offset:11520
    ds_read_b64_tr_b16 v[172:173], v12 offset:10304
    ds_read_b64_tr_b16 v[174:175], v12 offset:11584
    s_waitcnt lgkmcnt(6)
    v_mfma_f32_32x32x16_bf16 v[64:79], v[184:187], v[176:179], v[64:79]
    v_mfma_f32_32x32x16_bf16 v[80:95], v[188:191], v[176:179], v[80:95]
    v_mfma_f32_32x32x16_bf16 v[96:111], v[184:187], v[180:183], v[96:111]
    v_mfma_f32_32x32x16_bf16 v[112:127], v[188:191], v[180:183], v[112:127]
    ds_read_b128 v[176:179], v11 offset:96
    ds_read_b128 v[180:183], v11 offset:4704
    ds_read_b64_tr_b16 v[184:185], v12 offset:15360
    ds_read_b64_tr_b16 v[186:187], v12 offset:16640
    ds_read_b64_tr_b16 v[188:189], v12 offset:15424
    ds_read_b64_tr_b16 v[190:191], v12 offset:16704
    s_waitcnt lgkmcnt(6)
    v_mfma_f32_32x32x16_bf16 v[64:79], v[168:171], v[160:163], v[64:79]
    v_mfma_f32_32x32x16_bf16 v[80:95], v[172:175], v[160:163], v[80:95]
    v_mfma_f32_32x32x16_bf16 v[96:111], v[168:171], v[164:167], v[96:111]
    v_mfma_f32_32x32x16_bf16 v[112:127], v[172:175], v[164:167], v[112:127]
    s_waitcnt lgkmcnt(0)
    v_mfma_f32_32x32x16_bf16 v[64:79], v[184:187], v[176:179], v[64:79]
    v_mfma_f32_32x32x16_bf16 v[80:95], v[188:191], v[176:179], v[80:95]
    v_mfma_f32_32x32x16_bf16 v[96:111], v[184:187], v[180:183], v[96:111]
    v_mfma_f32_32x32x16_bf16 v[112:127], v[188:191], v[180:183], v[112:127]
    s_waitcnt vmcnt(8)
    ds_write_b128 v9, v[192:195] offset:40960
    ds_write_b128 v9, v[196:199] offset:45568
    ds_write_b128 v9, v[200:203] offset:50176
    ds_write_b128 v9, v[204:207] offset:54784
    ds_write_b128 v10, v[208:211] offset:40960
    ds_write_b128 v10, v[212:215] offset:46080
    ds_write_b128 v10, v[216:219] offset:51200
    ds_write_b128 v10, v[220:223] offset:56320
    s_waitcnt lgkmcnt(0)
    s_barrier
    buffer_load_dwordx4 v[192:195], v1, s[8:11], s33 offen
    buffer_load_dwordx4 v[196:199], v2, s[8:11], s33 offen
    buffer_load_dwordx4 v[200:203], v3, s[8:11], s33 offen
    buffer_load_dwordx4 v[204:207], v4, s[8:11], s33 offen
    buffer_load_dwordx4 v[208:211], v5, s[12:15], s34 offen
    buffer_load_dwordx4 v[212:215], v6, s[12:15], s34 offen
    buffer_load_dwordx4 v[216:219], v7, s[12:15], s34 offen
    buffer_load_dwordx4 v[220:223], v8, s[12:15], s34 offen
    s_add_u32 s33, s33, 128
    s_add_u32 s34, s34, 65536
    ds_read_b128 v[160:163], v11 offset:40960
    ds_read_b128 v[164:167], v11 offset:45568
    ds_read_b64_tr_b16 v[168:169], v12 offset:40960
    ds_read_b64_tr_b16 v[170:171], v12 offset:42240
    ds_read_b64_tr_b16 v[172:173], v12 offset:41024
    ds_read_b64_tr_b16 v[174:175], v12 offset:42304
    ds_read_b128 v[176:179], v11 offset:40992
    ds_read_b128 v[180:183], v11 offset:45600
    ds_read_b64_tr_b16 v[184:185], v12 offset:46080
    ds_read_b64_tr_b16 v[186:187], v12 offset:47360
    ds_read_b64_tr_b16 v[188:189], v12 offset:46144
    ds_read_b64_tr_b16 v[190:191], v12 offset:47424
    s_waitcnt lgkmcnt(6)
    v_mfma_f32_32x32x16_bf16 v[64:79], v[168:171], v[160:163], v[64:79]
    v_mfma_f32_32x32x16_bf16 v[80:95], v[172:175], v[160:163], v[80:95]
    v_mfma_f32_32x32x16_bf16 v[96:111], v[168:171], v[164:167], v[96:111]
    v_mfma_f32_32x32x16_bf16 v[112:127], v[172:175], v[164:167], v[112:127]
    ds_read_b128 v[160:163], v11 offset:41024
    ds_read_b128 v[164:167], v11 offset:45632
    ds_read_b64_tr_b16 v[168:169], v12 offset:51200
    ds_read_b64_tr_b16 v[170:171], v12 offset:52480
    ds_read_b64_tr_b16 v[172:173], v12 offset:51264
    ds_read_b64_tr_b16 v[174:175], v12 offset:52544
    s_waitcnt lgkmcnt(6)
    v_mfma_f32_32x32x16_bf16 v[64:79], v[184:187], v[176:179], v[64:79]
    v_mfma_f32_32x32x16_bf16 v[80:95], v[188:191], v[176:179], v[80:95]
    v_mfma_f32_32x32x16_bf16 v[96:111], v[184:187], v[180:183], v[96:111]
    v_mfma_f32_32x32x16_bf16 v[112:127], v[188:191], v[180:183], v[112:127]
    ds_read_b128 v[176:179], v11 offset:41056
    ds_read_b128 v[180:183], v11 offset:45664
    ds_read_b64_tr_b16 v[184:185], v12 offset:56320
    ds_read_b64_tr_b16 v[186:187], v12 offset:57600
    ds_read_b64_tr_b16 v[188:189], v12 offset:56384
    ds_read_b64_tr_b16 v[190:191], v12 offset:57664
    s_waitcnt lgkmcnt(6)
    v_mfma_f32_32x32x16_bf16 v[64:79], v[168:171], v[160:163], v[64:79]
    v_mfma_f32_32x32x16_bf16 v[80:95], v[172:175], v[160:163], v[80:95]
    v_mfma_f32_32x32x16_bf16 v[96:111], v[168:171], v[164:167], v[96:111]
    v_mfma_f32_32x32x16_bf16 v[112:127], v[172:175], v[164:167], v[112:127]
    s_waitcnt lgkmcnt(0)
    v_mfma_f32_32x32x16_bf16 v[64:79], v[184:187], v[176:179], v[64:79]
    v_mfma_f32_32x32x16_bf16 v[80:95], v[188:191], v[176:179], v[80:95]
    v_mfma_f32_32x32x16_bf16 v[96:111], v[184:187], v[180:183], v[96:111]
    v_mfma_f32_32x32x16_bf16 v[112:127], v[188:191], v[180:183], v[112:127]
    s_waitcnt vmcnt(8)
    ds_write_b128 v9, v[128:131] offset:0
    ds_write_b128 v9, v[132:135] offset:4608
    ds_write_b128 v9, v[136:139] offset:9216
    ds_write_b128 v9, v[140:143] offset:13824
    ds_write_b128 v10, v[144:147] offset:0
    ds_write_b128 v10, v[148:151] offset:5120
    ds_write_b128 v10, v[152:155] offset:10240
    ds_write_b128 v10, v[156:159] offset:15360
    s_waitcnt lgkmcnt(0)
    s_barrier
    ds_read_b128 v[160:163], v11 offset:0
    ds_read_b128 v[164:167], v11 offset:4608
    ds_read_b64_tr_b16 v[168:169], v12 offset:0
    ds_read_b64_tr_b16 v[170:171], v12 offset:1280
    ds_read_b64_tr_b16 v[172:173], v12 offset:64
    ds_read_b64_tr_b16 v[174:175], v12 offset:1344
    ds_read_b128 v[176:179], v11 offset:32
    ds_read_b128 v[180:183], v11 offset:4640
    ds_read_b64_tr_b16 v[184:185], v12 offset:5120
    ds_read_b64_tr_b16 v[186:187], v12 offset:6400
    ds_read_b64_tr_b16 v[188:189], v12 offset:5184
    ds_read_b64_tr_b16 v[190:191], v12 offset:6464
    s_waitcnt lgkmcnt(6)
    v_mfma_f32_32x32x16_bf16 v[64:79], v[168:171], v[160:163], v[64:79]
    v_mfma_f32_32x32x16_bf16 v[80:95], v[172:175], v[160:163], v[80:95]
    v_mfma_f32_32x32x16_bf16 v[96:111], v[168:171], v[164:167], v[96:111]
    v_mfma_f32_32x32x16_bf16 v[112:127], v[172:175], v[164:167], v[112:127]
    ds_read_b128 v[160:163], v11 offset:64
    ds_read_b128 v[164:167], v11 offset:4672
    ds_read_b64_tr_b16 v[168:169], v12 offset:10240
    ds_read_b64_tr_b16 v[170:171], v12 offset:11520
    ds_read_b64_tr_b16 v[172:173], v12 offset:10304
    ds_read_b64_tr_b16 v[174:175], v12 offset:11584
    s_waitcnt lgkmcnt(6)
    v_mfma_f32_32x32x16_bf16 v[64:79], v[184:187], v[176:179], v[64:79]
    v_mfma_f32_32x32x16_bf16 v[80:95], v[188:191], v[176:179], v[80:95]
    v_mfma_f32_32x32x16_bf16 v[96:111], v[184:187], v[180:183], v[96:111]
    v_mfma_f32_32x32x16_bf16 v[112:127], v[188:191], v[180:183], v[112:127]
    ds_read_b128 v[176:179], v11 offset:96
    ds_read_b128 v[180:183], v11 offset:4704
    ds_read_b64_tr_b16 v[184:185], v12 offset:15360
    ds_read_b64_tr_b16 v[186:187], v12 offset:16640
    ds_read_b64_tr_b16 v[188:189], v12 offset:15424
    ds_read_b64_tr_b16 v[190:191], v12 offset:16704
    s_waitcnt lgkmcnt(6)
    v_mfma_f32_32x32x16_bf16 v[64:79], v[168:171], v[160:163], v[64:79]
    v_mfma_f32_32x32x16_bf16 v[80:95], v[172:175], v[160:163], v[80:95]
    v_mfma_f32_32x32x16_bf16 v[96:111], v[168:171], v[164:167], v[96:111]
    v_mfma_f32_32x32x16_bf16 v[112:127], v[172:175], v[164:167], v[112:127]
    s_waitcnt lgkmcnt(0)
    v_mfma_f32_32x32x16_bf16 v[64:79], v[184:187], v[176:179], v[64:79]
    v_mfma_f32_32x32x16_bf16 v[80:95], v[188:191], v[176:179], v[80:95]
    v_mfma_f32_32x32x16_bf16 v[96:111], v[184:187], v[180:183], v[96:111]
    v_mfma_f32_32x32x16_bf16 v[112:127], v[188:191], v[180:183], v[112:127]
    s_waitcnt vmcnt(0)
    ds_write_b128 v9, v[192:195] offset:40960
    ds_write_b128 v9, v[196:199] offset:45568
    ds_write_b128 v9, v[200:203] offset:50176
    ds_write_b128 v9, v[204:207] offset:54784
    ds_write_b128 v10, v[208:211] offset:40960
    ds_write_b128 v10, v[212:215] offset:46080
    ds_write_b128 v10, v[216:219] offset:51200
    ds_write_b128 v10, v[220:223] offset:56320
    s_waitcnt lgkmcnt(0)
    s_barrier
    ds_read_b128 v[160:163], v11 offset:40960
    ds_read_b128 v[164:167], v11 offset:45568
    ds_read_b64_tr_b16 v[168:169], v12 offset:40960
    ds_read_b64_tr_b16 v[170:171], v12 offset:42240
    ds_read_b64_tr_b16 v[172:173], v12 offset:41024
    ds_read_b64_tr_b16 v[174:175], v12 offset:42304
    ds_read_b128 v[176:179], v11 offset:40992
    ds_read_b128 v[180:183], v11 offset:45600
    ds_read_b64_tr_b16 v[184:185], v12 offset:46080
    ds_read_b64_tr_b16 v[186:187], v12 offset:47360
    ds_read_b64_tr_b16 v[188:189], v12 offset:46144
    ds_read_b64_tr_b16 v[190:191], v12 offset:47424
    s_waitcnt lgkmcnt(6)
    v_mfma_f32_32x32x16_bf16 v[64:79], v[168:171], v[160:163], v[64:79]
    v_mfma_f32_32x32x16_bf16 v[80:95], v[172:175], v[160:163], v[80:95]
    v_mfma_f32_32x32x16_bf16 v[96:111], v[168:171], v[164:167], v[96:111]
    v_mfma_f32_32x32x16_bf16 v[112:127], v[172:175], v[164:167], v[112:127]
    ds_read_b128 v[160:163], v11 offset:41024
    ds_read_b128 v[164:167], v11 offset:45632
    ds_read_b64_tr_b16 v[168:169], v12 offset:51200
    ds_read_b64_tr_b16 v[170:171], v12 offset:52480
    ds_read_b64_tr_b16 v[172:173], v12 offset:51264
    ds_read_b64_tr_b16 v[174:175], v12 offset:52544
    s_waitcnt lgkmcnt(6)
    v_mfma_f32_32x32x16_bf16 v[64:79], v[184:187], v[176:179], v[64:79]
    v_mfma_f32_32x32x16_bf16 v[80:95], v[188:191], v[176:179], v[80:95]
    v_mfma_f32_32x32x16_bf16 v[96:111], v[184:187], v[180:183], v[96:111]
    v_mfma_f32_32x32x16_bf16 v[112:127], v[188:191], v[180:183], v[112:127]
    ds_read_b128 v[176:179], v11 offset:41056
    ds_read_b128 v[180:183], v11 offset:45664
    ds_read_b64_tr_b16 v[184:185], v12 offset:56320
    ds_read_b64_tr_b16 v[186:187], v12 offset:57600
    ds_read_b64_tr_b16 v[188:189], v12 offset:56384
    ds_read_b64_tr_b16 v[190:191], v12 offset:57664
    s_waitcnt lgkmcnt(6)
    v_mfma_f32_32x32x16_bf16 v[64:79], v[168:171], v[160:163], v[64:79]
    v_mfma_f32_32x32x16_bf16 v[80:95], v[172:175], v[160:163], v[80:95]
    v_mfma_f32_32x32x16_bf16 v[96:111], v[168:171], v[164:167], v[96:111]
    v_mfma_f32_32x32x16_bf16 v[112:127], v[172:175], v[164:167], v[112:127]
    s_waitcnt lgkmcnt(0)
    v_mfma_f32_32x32x16_bf16 v[64:79], v[184:187], v[176:179], v[64:79]
    v_mfma_f32_32x32x16_bf16 v[80:95], v[188:191], v[176:179], v[80:95]
    v_mfma_f32_32x32x16_bf16 v[96:111], v[184:187], v[180:183], v[96:111]
    v_mfma_f32_32x32x16_bf16 v[112:127], v[188:191], v[180:183], v[112:127]
    s_nop 15
    s_nop 3
    v_and_b32 v22, 31, v13
    v_lshl_add_u32 v22, v15, 6, v22
    v_add_u32 v22, s38, v22
    v_lshlrev_b32 v22, 11, v22
    v_lshrrev_b32 v23, 5, v13
    v_lshl_add_u32 v22, v23, 4, v22
    s_lshl_b32 s39, s37, 1
    v_add_u32 v22, s39, v22
    v_lshl_add_u32 v22, v16, 8, v22
    s_lshl_b32 s40, s44, 22
    s_add_u32 s40, s40, 134217728
    v_mov_b32 v23, v22
    buffer_store_dwordx4 v[64:67], v23, s[20:23], s40 offen offset:0
    buffer_store_dwordx4 v[68:71], v23, s[20:23], s40 offen offset:32
    buffer_store_dwordx4 v[72:75], v23, s[20:23], s40 offen offset:64
    buffer_store_dwordx4 v[76:79], v23, s[20:23], s40 offen offset:96
    buffer_store_dwordx4 v[80:83], v23, s[20:23], s40 offen offset:128
    buffer_store_dwordx4 v[84:87], v23, s[20:23], s40 offen offset:160
    buffer_store_dwordx4 v[88:91], v23, s[20:23], s40 offen offset:192
    buffer_store_dwordx4 v[92:95], v23, s[20:23], s40 offen offset:224
    v_add_u32 v23, 65536, v22
    buffer_store_dwordx4 v[96:99], v23, s[20:23], s40 offen offset:0
    buffer_store_dwordx4 v[100:103], v23, s[20:23], s40 offen offset:32
    buffer_store_dwordx4 v[104:107], v23, s[20:23], s40 offen offset:64
    buffer_store_dwordx4 v[108:111], v23, s[20:23], s40 offen offset:96
    buffer_store_dwordx4 v[112:115], v23, s[20:23], s40 offen offset:128
    buffer_store_dwordx4 v[116:119], v23, s[20:23], s40 offen offset:160
    buffer_store_dwordx4 v[120:123], v23, s[20:23], s40 offen offset:192
    buffer_store_dwordx4 v[124:127], v23, s[20:23], s40 offen offset:224
oproj_kernel_done1:
    s_endpgm
.globl ln2_kernel
.p2align 8
.type ln2_kernel,@function
ln2_kernel:
    s_cmp_ge_u32 s2, 512
    s_cbranch_scc1 ln2_kernel_done1
    s_load_dwordx2 s[12:13], s[0:1], 104
    s_waitcnt lgkmcnt(0)
    s_mov_b32 s14, 268435456
    s_mov_b32 s15, 0x00020000
    s_mov_b32 s8, s12
    s_mov_b32 s9, s13
    s_mov_b32 s10, s14
    s_mov_b32 s11, s15
    v_lshrrev_b32 v1, 6, v0
    v_and_b32 v2, 63, v0
    s_lshl_b32 s3, s2, 2
    v_add_u32 v1, s3, v1
    v_lshlrev_b32 v1, 10, v1
    v_lshl_add_u32 v1, v2, 4, v1
    v_lshlrev_b32 v20, 1, v1
    s_mov_b32 s16, 134217728
    buffer_load_dwordx4 v[24:27], v20, s[12:15], s16 offen
    buffer_load_dwordx4 v[28:31], v20, s[12:15], s16 offen offset:16
    s_mov_b32 s16, 138412032
    buffer_load_dwordx4 v[32:35], v20, s[12:15], s16 offen
    buffer_load_dwordx4 v[36:39], v20, s[12:15], s16 offen offset:16
    s_mov_b32 s16, 142606336
    buffer_load_dwordx4 v[40:43], v20, s[12:15], s16 offen
    buffer_load_dwordx4 v[44:47], v20, s[12:15], s16 offen offset:16
    s_mov_b32 s16, 146800640
    buffer_load_dwordx4 v[48:51], v20, s[12:15], s16 offen
    buffer_load_dwordx4 v[52:55], v20, s[12:15], s16 offen offset:16
    s_load_dwordx2 s[24:25], s[0:1], 0
    s_waitcnt lgkmcnt(0)
    s_mov_b32 s26, 2097152
    s_mov_b32 s27, 0x00020000
    buffer_load_dwordx4 v[4:7], v1, s[24:27], 0 offen
    s_waitcnt vmcnt(0)
    v_add_f32 v24, v24, v32
    v_add_f32 v40, v40, v48
    v_add_f32 v25, v25, v33
    v_add_f32 v41, v41, v49
    v_add_f32 v26, v26, v34
    v_add_f32 v42, v42, v50
    v_add_f32 v27, v27, v35
    v_add_f32 v43, v43, v51
    v_add_f32 v28, v28, v36
    v_add_f32 v44, v44, v52
    v_add_f32 v29, v29, v37
    v_add_f32 v45, v45, v53
    v_add_f32 v30, v30, v38
    v_add_f32 v46, v46, v54
    v_add_f32 v31, v31, v39
    v_add_f32 v47, v47, v55
    v_add_f32 v24, v24, v40
    v_add_f32 v25, v25, v41
    v_add_f32 v26, v26, v42
    v_add_f32 v27, v27, v43
    v_add_f32 v28, v28, v44
    v_add_f32 v29, v29, v45
    v_add_f32 v30, v30, v46
    v_add_f32 v31, v31, v47
    v_cvt_pk_bf16_f32 v32, v24, v25
    v_lshlrev_b32 v24, 16, v32
    v_and_b32 v25, 0xffff0000, v32
    v_lshlrev_b32 v40, 16, v4
    v_and_b32 v41, 0xffff0000, v4
    v_add_f32 v24, v24, v40
    v_add_f32 v25, v25, v41
    v_cvt_pk_bf16_f32 v4, v24, v25
    v_cvt_pk_bf16_f32 v33, v26, v27
    v_lshlrev_b32 v26, 16, v33
    v_and_b32 v27, 0xffff0000, v33
    v_lshlrev_b32 v42, 16, v5
    v_and_b32 v43, 0xffff0000, v5
    v_add_f32 v26, v26, v42
    v_add_f32 v27, v27, v43
    v_cvt_pk_bf16_f32 v5, v26, v27
    v_cvt_pk_bf16_f32 v34, v28, v29
    v_lshlrev_b32 v28, 16, v34
    v_and_b32 v29, 0xffff0000, v34
    v_lshlrev_b32 v44, 16, v6
    v_and_b32 v45, 0xffff0000, v6
    v_add_f32 v28, v28, v44
    v_add_f32 v29, v29, v45
    v_cvt_pk_bf16_f32 v6, v28, v29
    v_cvt_pk_bf16_f32 v35, v30, v31
    v_lshlrev_b32 v30, 16, v35
    v_and_b32 v31, 0xffff0000, v35
    v_lshlrev_b32 v46, 16, v7
    v_and_b32 v47, 0xffff0000, v7
    v_add_f32 v30, v30, v46
    v_add_f32 v31, v31, v47
    v_cvt_pk_bf16_f32 v7, v30, v31
    s_mov_b32 s16, 71303168
    buffer_store_dwordx4 v[4:7], v1, s[12:15], s16 offen
    s_waitcnt vmcnt(0)
    v_lshlrev_b32 v8, 16, v4
    v_and_b32 v9, 0xffff0000, v4
    v_lshlrev_b32 v10, 16, v5
    v_and_b32 v11, 0xffff0000, v5
    v_lshlrev_b32 v12, 16, v6
    v_and_b32 v13, 0xffff0000, v6
    v_lshlrev_b32 v14, 16, v7
    v_and_b32 v15, 0xffff0000, v7
    v_add_f32 v16, v8, v9
    v_add_f32 v16, v16, v10
    v_add_f32 v16, v16, v11
    v_add_f32 v16, v16, v12
    v_add_f32 v16, v16, v13
    v_add_f32 v16, v16, v14
    v_add_f32 v16, v16, v15
    ds_swizzle_b32 v17, v16 offset:0x41f
    s_waitcnt lgkmcnt(0)
    v_add_f32 v16, v16, v17
    ds_swizzle_b32 v17, v16 offset:0x81f
    s_waitcnt lgkmcnt(0)
    v_add_f32 v16, v16, v17
    ds_swizzle_b32 v17, v16 offset:0x101f
    s_waitcnt lgkmcnt(0)
    v_add_f32 v16, v16, v17
    ds_swizzle_b32 v17, v16 offset:0x201f
    s_waitcnt lgkmcnt(0)
    v_add_f32 v16, v16, v17
    ds_swizzle_b32 v17, v16 offset:0x401f
    s_waitcnt lgkmcnt(0)
    v_add_f32 v16, v16, v17
    s_nop 1
    v_readlane_b32 s20, v16, 0
    v_readlane_b32 s21, v16, 32
    s_nop 3
    v_mov_b32 v17, s20
    v_add_f32 v16, s21, v17
    v_mul_f32 v16, 0x3b000000, v16
    v_sub_f32 v18, v8, v16
    v_mul_f32 v19, v18, v18
    v_sub_f32 v18, v9, v16
    v_fmac_f32 v19, v18, v18
    v_sub_f32 v18, v10, v16
    v_fmac_f32 v19, v18, v18
    v_sub_f32 v18, v11, v16
    v_fmac_f32 v19, v18, v18
    v_sub_f32 v18, v12, v16
    v_fmac_f32 v19, v18, v18
    v_sub_f32 v18, v13, v16
    v_fmac_f32 v19, v18, v18
    v_sub_f32 v18, v14, v16
    v_fmac_f32 v19, v18, v18
    v_sub_f32 v18, v15, v16
    v_fmac_f32 v19, v18, v18
    ds_swizzle_b32 v17, v19 offset:0x41f
    s_waitcnt lgkmcnt(0)
    v_add_f32 v19, v19, v17
    ds_swizzle_b32 v17, v19 offset:0x81f
    s_waitcnt lgkmcnt(0)
    v_add_f32 v19, v19, v17
    ds_swizzle_b32 v17, v19 offset:0x101f
    s_waitcnt lgkmcnt(0)
    v_add_f32 v19, v19, v17
    ds_swizzle_b32 v17, v19 offset:0x201f
    s_waitcnt lgkmcnt(0)
    v_add_f32 v19, v19, v17
    ds_swizzle_b32 v17, v19 offset:0x401f
    s_waitcnt lgkmcnt(0)
    v_add_f32 v19, v19, v17
    s_nop 1
    v_readlane_b32 s20, v19, 0
    v_readlane_b32 s21, v19, 32
    s_nop 3
    v_mov_b32 v17, s20
    v_add_f32 v19, s21, v17
    v_mul_f32 v19, 0x3b000000, v19
    v_cvt_pk_bf16_f32 v16, v16, v16
    v_lshlrev_b32 v16, 16, v16
    v_cvt_pk_bf16_f32 v19, v19, v19
    v_lshlrev_b32 v19, 16, v19
    v_add_f32 v19, 0x3727c5ac, v19
    v_cvt_pk_bf16_f32 v19, v19, v19
    v_lshlrev_b32 v19, 16, v19
    v_sqrt_f32 v19, v19
    s_nop 0
    v_cvt_pk_bf16_f32 v19, v19, v19
    v_lshlrev_b32 v19, 16, v19
    v_rcp_f32 v19, v19
    s_nop 0
    v_sub_f32 v8, v8, v16
    v_cvt_pk_bf16_f32 v8, v8, v8
    v_lshlrev_b32 v8, 16, v8
    v_mul_f32 v8, v8, v19
    v_sub_f32 v9, v9, v16
    v_cvt_pk_bf16_f32 v9, v9, v9
    v_lshlrev_b32 v9, 16, v9
    v_mul_f32 v9, v9, v19
    v_sub_f32 v10, v10, v16
    v_cvt_pk_bf16_f32 v10, v10, v10
    v_lshlrev_b32 v10, 16, v10
    v_mul_f32 v10, v10, v19
    v_sub_f32 v11, v11, v16
    v_cvt_pk_bf16_f32 v11, v11, v11
    v_lshlrev_b32 v11, 16, v11
    v_mul_f32 v11, v11, v19
    v_sub_f32 v12, v12, v16
    v_cvt_pk_bf16_f32 v12, v12, v12
    v_lshlrev_b32 v12, 16, v12
    v_mul_f32 v12, v12, v19
    v_sub_f32 v13, v13, v16
    v_cvt_pk_bf16_f32 v13, v13, v13
    v_lshlrev_b32 v13, 16, v13
    v_mul_f32 v13, v13, v19
    v_sub_f32 v14, v14, v16
    v_cvt_pk_bf16_f32 v14, v14, v14
    v_lshlrev_b32 v14, 16, v14
    v_mul_f32 v14, v14, v19
    v_sub_f32 v15, v15, v16
    v_cvt_pk_bf16_f32 v15, v15, v15
    v_lshlrev_b32 v15, 16, v15
    v_mul_f32 v15, v15, v19
    v_cvt_pk_bf16_f32 v4, v8, v9
    v_cvt_pk_bf16_f32 v5, v10, v11
    v_cvt_pk_bf16_f32 v6, v12, v13
    v_cvt_pk_bf16_f32 v7, v14, v15
    s_mov_b32 s16, 73400320
    buffer_store_dwordx4 v[4:7], v1, s[12:15], s16 offen
ln2_kernel_done1:
    s_endpgm
.globl ffn1_kernel
.p2align 8
.type ffn1_kernel,@function
ffn1_kernel:
    s_cmp_ge_u32 s2, 448
    s_cbranch_scc1 ffn1_kernel_done1
    s_and_b32 s28, s2, 15
    s_lshr_b32 s29, s2, 4
    s_load_dwordx2 s[20:21], s[0:1], 104
    s_waitcnt lgkmcnt(0)
    s_mov_b32 s22, 268435456
    s_mov_b32 s23, 0x00020000
    s_mov_b32 s8, s20
    s_mov_b32 s9, s21
    s_mov_b32 s10, s22
    s_mov_b32 s11, s23
    s_load_dwordx2 s[12:13], s[0:1], 64
    s_waitcnt lgkmcnt(0)
    s_mov_b32 s14, 1835008
    s_mov_b32 s15, 0x00020000
    s_load_dwordx2 s[16:17], s[0:1], 72
    s_waitcnt lgkmcnt(0)
    s_mov_b32 s18, 1835008
    s_mov_b32 s19, 0x00020000
    s_lshl_b32 s37, s29, 7
    v_and_b32 v13, 63, v0
    v_lshrrev_b32 v14, 6, v0
    v_and_b32 v15, 1, v14
    v_lshrrev_b32 v16, 1, v14
    v_lshrrev_b32 v17, 3, v0
    v_and_b32 v18, 7, v0
    s_lshl_b32 s38, s28, 7
    v_add_u32 v19, s38, v17
    s_mov_b32 s39, 1024
    v_mul_lo_u32 v19, v19, s39
    v_lshl_add_u32 v1, v18, 4, v19
    v_add_u32 v1, 73400320, v1
    v_add_u32 v2, 32768, v1
    v_add_u32 v3, 65536, v1
    v_add_u32 v4, 98304, v1
    v_mul_u32_u24 v9, 144, v17
    v_lshl_add_u32 v9, v18, 4, v9
    s_mov_b32 s39, 3584
    v_mul_lo_u32 v19, v17, s39
    v_lshl_add_u32 v5, v18, 4, v19
    v_add_u32 v5, s37, v5
    v_add_u32 v6, 114688, v5
    v_mul_u32_u24 v10, 320, v17
    v_lshl_add_u32 v10, v18, 4, v10
    v_add_u32 v10, 18432, v10
    v_and_b32 v17, 31, v13
    v_lshl_add_u32 v17, v15, 6, v17
    v_mul_u32_u24 v11, 144, v17
    v_lshrrev_b32 v18, 5, v13
    v_lshl_add_u32 v11, v18, 4, v11
    v_and_b32 v17, 15, v13
    v_lshrrev_b32 v17, 2, v17
    v_lshl_add_u32 v17, v18, 3, v17
    v_mul_u32_u24 v12, 320, v17
    v_lshrrev_b32 v17, 4, v13
    v_and_b32 v17, 1, v17
    v_lshlrev_b32 v17, 5, v17
    v_add_u32 v12, v12, v17
    v_and_b32 v17, 3, v13
    v_lshl_add_u32 v12, v17, 3, v12
    v_lshl_add_u32 v12, v16, 6, v12
    v_add_u32 v12, 18432, v12
    v_mov_b32 v64, 0
    v_mov_b32 v65, 0
    v_mov_b32 v66, 0
    v_mov_b32 v67, 0
    v_mov_b32 v68, 0
    v_mov_b32 v69, 0
    v_mov_b32 v70, 0
    v_mov_b32 v71, 0
    v_mov_b32 v72, 0
    v_mov_b32 v73, 0
    v_mov_b32 v74, 0
    v_mov_b32 v75, 0
    v_mov_b32 v76, 0
    v_mov_b32 v77, 0
    v_mov_b32 v78, 0
    v_mov_b32 v79, 0
    v_mov_b32 v80, 0
    v_mov_b32 v81, 0
    v_mov_b32 v82, 0
    v_mov_b32 v83, 0
    v_mov_b32 v84, 0
    v_mov_b32 v85, 0
    v_mov_b32 v86, 0
    v_mov_b32 v87, 0
    v_mov_b32 v88, 0
    v_mov_b32 v89, 0
    v_mov_b32 v90, 0
    v_mov_b32 v91, 0
    v_mov_b32 v92, 0
    v_mov_b32 v93, 0
    v_mov_b32 v94, 0
    v_mov_b32 v95, 0
    v_mov_b32 v96, 0
    v_mov_b32 v97, 0
    v_mov_b32 v98, 0
    v_mov_b32 v99, 0
    v_mov_b32 v100, 0
    v_mov_b32 v101, 0
    v_mov_b32 v102, 0
    v_mov_b32 v103, 0
    v_mov_b32 v104, 0
    v_mov_b32 v105, 0
    v_mov_b32 v106, 0
    v_mov_b32 v107, 0
    v_mov_b32 v108, 0
    v_mov_b32 v109, 0
    v_mov_b32 v110, 0
    v_mov_b32 v111, 0
    v_mov_b32 v112, 0
    v_mov_b32 v113, 0
    v_mov_b32 v114, 0
    v_mov_b32 v115, 0
    v_mov_b32 v116, 0
    v_mov_b32 v117, 0
    v_mov_b32 v118, 0
    v_mov_b32 v119, 0
    v_mov_b32 v120, 0
    v_mov_b32 v121, 0
    v_mov_b32 v122, 0
    v_mov_b32 v123, 0
    v_mov_b32 v124, 0
    v_mov_b32 v125, 0
    v_mov_b32 v126, 0
    v_mov_b32 v127, 0
    s_mov_b32 s33, 0
    s_mov_b32 s34, 0
    s_mov_b32 s31, 0
    buffer_load_dwordx4 v[128:131], v1, s[8:11], s33 offen
    buffer_load_dwordx4 v[132:135], v2, s[8:11], s33 offen
    buffer_load_dwordx4 v[136:139], v3, s[8:11], s33 offen
    buffer_load_dwordx4 v[140:143], v4, s[8:11], s33 offen
    buffer_load_dwordx4 v[144:147], v5, s[12:15], s34 offen
    buffer_load_dwordx4 v[148:151], v6, s[12:15], s34 offen
    buffer_load_dwordx4 v[152:155], v5, s[16:19], s34 offen
    buffer_load_dwordx4 v[156:159], v6, s[16:19], s34 offen
    s_add_u32 s33, s33, 128
    s_add_u32 s34, s34, 229376
    buffer_load_dwordx4 v[192:195], v1, s[8:11], s33 offen
    buffer_load_dwordx4 v[196:199], v2, s[8:11], s33 offen
    buffer_load_dwordx4 v[200:203], v3, s[8:11], s33 offen
    buffer_load_dwordx4 v[204:207], v4, s[8:11], s33 offen
    buffer_load_dwordx4 v[208:211], v5, s[12:15], s34 offen
    buffer_load_dwordx4 v[212:215], v6, s[12:15], s34 offen
    buffer_load_dwordx4 v[216:219], v5, s[16:19], s34 offen
    buffer_load_dwordx4 v[220:223], v6, s[16:19], s34 offen
    s_add_u32 s33, s33, 128
    s_add_u32 s34, s34, 229376
    s_waitcnt vmcnt(8)
    ds_write_b128 v9, v[128:131] offset:0
    ds_write_b128 v9, v[132:135] offset:4608
    ds_write_b128 v9, v[136:139] offset:9216
    ds_write_b128 v9, v[140:143] offset:13824
    ds_write_b128 v10, v[144:147] offset:0
    ds_write_b128 v10, v[148:151] offset:10240
    ds_write_b128 v10, v[152:155] offset:128
    ds_write_b128 v10, v[156:159] offset:10368
    s_waitcnt lgkmcnt(0)
    s_barrier
    buffer_load_dwordx4 v[128:131], v1, s[8:11], s33 offen
    buffer_load_dwordx4 v[132:135], v2, s[8:11], s33 offen
    buffer_load_dwordx4 v[136:139], v3, s[8:11], s33 offen
    buffer_load_dwordx4 v[140:143], v4, s[8:11], s33 offen
    buffer_load_dwordx4 v[144:147], v5, s[12:15], s34 offen
    buffer_load_dwordx4 v[148:151], v6, s[12:15], s34 offen
    buffer_load_dwordx4 v[152:155], v5, s[16:19], s34 offen
    buffer_load_dwordx4 v[156:159], v6, s[16:19], s34 offen
    s_add_u32 s33, s33, 128
    s_add_u32 s34, s34, 229376
    ds_read_b128 v[160:163], v11 offset:0
    ds_read_b128 v[164:167], v11 offset:4608
    ds_read_b64_tr_b16 v[168:169], v12 offset:0
    ds_read_b64_tr_b16 v[170:171], v12 offset:1280
    ds_read_b64_tr_b16 v[172:173], v12 offset:128
    ds_read_b64_tr_b16 v[174:175], v12 offset:1408
    ds_read_b128 v[176:179], v11 offset:32
    ds_read_b128 v[180:183], v11 offset:4640
    ds_read_b64_tr_b16 v[184:185], v12 offset:5120
    ds_read_b64_tr_b16 v[186:187], v12 offset:6400
    ds_read_b64_tr_b16 v[188:189], v12 offset:5248
    ds_read_b64_tr_b16 v[190:191], v12 offset:6528
    s_waitcnt lgkmcnt(6)
    v_mfma_f32_32x32x16_bf16 v[64:79], v[168:171], v[160:163], v[64:79]
    v_mfma_f32_32x32x16_bf16 v[80:95], v[172:175], v[160:163], v[80:95]
    v_mfma_f32_32x32x16_bf16 v[96:111], v[168:171], v[164:167], v[96:111]
    v_mfma_f32_32x32x16_bf16 v[112:127], v[172:175], v[164:167], v[112:127]
    ds_read_b128 v[160:163], v11 offset:64
    ds_read_b128 v[164:167], v11 offset:4672
    ds_read_b64_tr_b16 v[168:169], v12 offset:10240
    ds_read_b64_tr_b16 v[170:171], v12 offset:11520
    ds_read_b64_tr_b16 v[172:173], v12 offset:10368
    ds_read_b64_tr_b16 v[174:175], v12 offset:11648
    s_waitcnt lgkmcnt(6)
    v_mfma_f32_32x32x16_bf16 v[64:79], v[184:187], v[176:179], v[64:79]
    v_mfma_f32_32x32x16_bf16 v[80:95], v[188:191], v[176:179], v[80:95]
    v_mfma_f32_32x32x16_bf16 v[96:111], v[184:187], v[180:183], v[96:111]
    v_mfma_f32_32x32x16_bf16 v[112:127], v[188:191], v[180:183], v[112:127]
    ds_read_b128 v[176:179], v11 offset:96
    ds_read_b128 v[180:183], v11 offset:4704
    ds_read_b64_tr_b16 v[184:185], v12 offset:15360
    ds_read_b64_tr_b16 v[186:187], v12 offset:16640
    ds_read_b64_tr_b16 v[188:189], v12 offset:15488
    ds_read_b64_tr_b16 v[190:191], v12 offset:16768
    s_waitcnt lgkmcnt(6)
    v_mfma_f32_32x32x16_bf16 v[64:79], v[168:171], v[160:163], v[64:79]
    v_mfma_f32_32x32x16_bf16 v[80:95], v[172:175], v[160:163], v[80:95]
    v_mfma_f32_32x32x16_bf16 v[96:111], v[168:171], v[164:167], v[96:111]
    v_mfma_f32_32x32x16_bf16 v[112:127], v[172:175], v[164:167], v[112:127]
    s_waitcnt lgkmcnt(0)
    v_mfma_f32_32x32x16_bf16 v[64:79], v[184:187], v[176:179], v[64:79]
    v_mfma_f32_32x32x16_bf16 v[80:95], v[188:191], v[176:179], v[80:95]
    v_mfma_f32_32x32x16_bf16 v[96:111], v[184:187], v[180:183], v[96:111]
    v_mfma_f32_32x32x16_bf16 v[112:127], v[188:191], v[180:183], v[112:127]
    s_waitcnt vmcnt(8)
    ds_write_b128 v9, v[192:195] offset:40960
    ds_write_b128 v9, v[196:199] offset:45568
    ds_write_b128 v9, v[200:203] offset:50176
    ds_write_b128 v9, v[204:207] offset:54784
    ds_write_b128 v10, v[208:211] offset:40960
    ds_write_b128 v10, v[212:215] offset:51200
    ds_write_b128 v10, v[216:219] offset:41088
    ds_write_b128 v10, v[220:223] offset:51328
    s_waitcnt lgkmcnt(0)
    s_barrier
    buffer_load_dwordx4 v[192:195], v1, s[8:11], s33 offen
    buffer_load_dwordx4 v[196:199], v2, s[8:11], s33 offen
    buffer_load_dwordx4 v[200:203], v3, s[8:11], s33 offen
    buffer_load_dwordx4 v[204:207], v4, s[8:11], s33 offen
    buffer_load_dwordx4 v[208:211], v5, s[12:15], s34 offen
    buffer_load_dwordx4 v[212:215], v6, s[12:15], s34 offen
    buffer_load_dwordx4 v[216:219], v5, s[16:19], s34 offen
    buffer_load_dwordx4 v[220:223], v6, s[16:19], s34 offen
    s_add_u32 s33, s33, 128
    s_add_u32 s34, s34, 229376
    ds_read_b128 v[160:163], v11 offset:40960
    ds_read_b128 v[164:167], v11 offset:45568
    ds_read_b64_tr_b16 v[168:169], v12 offset:40960
    ds_read_b64_tr_b16 v[170:171], v12 offset:42240
    ds_read_b64_tr_b16 v[172:173], v12 offset:41088
    ds_read_b64_tr_b16 v[174:175], v12 offset:42368
    ds_read_b128 v[176:179], v11 offset:40992
    ds_read_b128 v[180:183], v11 offset:45600
    ds_read_b64_tr_b16 v[184:185], v12 offset:46080
    ds_read_b64_tr_b16 v[186:187], v12 offset:47360
    ds_read_b64_tr_b16 v[188:189], v12 offset:46208
    ds_read_b64_tr_b16 v[190:191], v12 offset:47488
    s_waitcnt lgkmcnt(6)
    v_mfma_f32_32x32x16_bf16 v[64:79], v[168:171], v[160:163], v[64:79]
    v_mfma_f32_32x32x16_bf16 v[80:95], v[172:175], v[160:163], v[80:95]
    v_mfma_f32_32x32x16_bf16 v[96:111], v[168:171], v[164:167], v[96:111]
    v_mfma_f32_32x32x16_bf16 v[112:127], v[172:175], v[164:167], v[112:127]
    ds_read_b128 v[160:163], v11 offset:41024
    ds_read_b128 v[164:167], v11 offset:45632
    ds_read_b64_tr_b16 v[168:169], v12 offset:51200
    ds_read_b64_tr_b16 v[170:171], v12 offset:52480
    ds_read_b64_tr_b16 v[172:173], v12 offset:51328
    ds_read_b64_tr_b16 v[174:175], v12 offset:52608
    s_waitcnt lgkmcnt(6)
    v_mfma_f32_32x32x16_bf16 v[64:79], v[184:187], v[176:179], v[64:79]
    v_mfma_f32_32x32x16_bf16 v[80:95], v[188:191], v[176:179], v[80:95]
    v_mfma_f32_32x32x16_bf16 v[96:111], v[184:187], v[180:183], v[96:111]
    v_mfma_f32_32x32x16_bf16 v[112:127], v[188:191], v[180:183], v[112:127]
    ds_read_b128 v[176:179], v11 offset:41056
    ds_read_b128 v[180:183], v11 offset:45664
    ds_read_b64_tr_b16 v[184:185], v12 offset:56320
    ds_read_b64_tr_b16 v[186:187], v12 offset:57600
    ds_read_b64_tr_b16 v[188:189], v12 offset:56448
    ds_read_b64_tr_b16 v[190:191], v12 offset:57728
    s_waitcnt lgkmcnt(6)
    v_mfma_f32_32x32x16_bf16 v[64:79], v[168:171], v[160:163], v[64:79]
    v_mfma_f32_32x32x16_bf16 v[80:95], v[172:175], v[160:163], v[80:95]
    v_mfma_f32_32x32x16_bf16 v[96:111], v[168:171], v[164:167], v[96:111]
    v_mfma_f32_32x32x16_bf16 v[112:127], v[172:175], v[164:167], v[112:127]
    s_waitcnt lgkmcnt(0)
    v_mfma_f32_32x32x16_bf16 v[64:79], v[184:187], v[176:179], v[64:79]
    v_mfma_f32_32x32x16_bf16 v[80:95], v[188:191], v[176:179], v[80:95]
    v_mfma_f32_32x32x16_bf16 v[96:111], v[184:187], v[180:183], v[96:111]
    v_mfma_f32_32x32x16_bf16 v[112:127], v[188:191], v[180:183], v[112:127]
    s_waitcnt vmcnt(8)
    ds_write_b128 v9, v[128:131] offset:0
    ds_write_b128 v9, v[132:135] offset:4608
    ds_write_b128 v9, v[136:139] offset:9216
    ds_write_b128 v9, v[140:143] offset:13824
    ds_write_b128 v10, v[144:147] offset:0
    ds_write_b128 v10, v[148:151] offset:10240
    ds_write_b128 v10, v[152:155] offset:128
    ds_write_b128 v10, v[156:159] offset:10368
    s_waitcnt lgkmcnt(0)
    s_barrier
    buffer_load_dwordx4 v[128:131], v1, s[8:11], s33 offen
    buffer_load_dwordx4 v[132:135], v2, s[8:11], s33 offen
    buffer_load_dwordx4 v[136:139], v3, s[8:11], s33 offen
    buffer_load_dwordx4 v[140:143], v4, s[8:11], s33 offen
    buffer_load_dwordx4 v[144:147], v5, s[12:15], s34 offen
    buffer_load_dwordx4 v[148:151], v6, s[12:15], s34 offen
    buffer_load_dwordx4 v[152:155], v5, s[16:19], s34 offen
    buffer_load_dwordx4 v[156:159], v6, s[16:19], s34 offen
    s_add_u32 s33, s33, 128
    s_add_u32 s34, s34, 229376
    ds_read_b128 v[160:163], v11 offset:0
    ds_read_b128 v[164:167], v11 offset:4608
    ds_read_b64_tr_b16 v[168:169], v12 offset:0
    ds_read_b64_tr_b16 v[170:171], v12 offset:1280
    ds_read_b64_tr_b16 v[172:173], v12 offset:128
    ds_read_b64_tr_b16 v[174:175], v12 offset:1408
    ds_read_b128 v[176:179], v11 offset:32
    ds_read_b128 v[180:183], v11 offset:4640
    ds_read_b64_tr_b16 v[184:185], v12 offset:5120
    ds_read_b64_tr_b16 v[186:187], v12 offset:6400
    ds_read_b64_tr_b16 v[188:189], v12 offset:5248
    ds_read_b64_tr_b16 v[190:191], v12 offset:6528
    s_waitcnt lgkmcnt(6)
    v_mfma_f32_32x32x16_bf16 v[64:79], v[168:171], v[160:163], v[64:79]
    v_mfma_f32_32x32x16_bf16 v[80:95], v[172:175], v[160:163], v[80:95]
    v_mfma_f32_32x32x16_bf16 v[96:111], v[168:171], v[164:167], v[96:111]
    v_mfma_f32_32x32x16_bf16 v[112:127], v[172:175], v[164:167], v[112:127]
    ds_read_b128 v[160:163], v11 offset:64
    ds_read_b128 v[164:167], v11 offset:4672
    ds_read_b64_tr_b16 v[168:169], v12 offset:10240
    ds_read_b64_tr_b16 v[170:171], v12 offset:11520
    ds_read_b64_tr_b16 v[172:173], v12 offset:10368
    ds_read_b64_tr_b16 v[174:175], v12 offset:11648
    s_waitcnt lgkmcnt(6)
    v_mfma_f32_32x32x16_bf16 v[64:79], v[184:187], v[176:179], v[64:79]
    v_mfma_f32_32x32x16_bf16 v[80:95], v[188:191], v[176:179], v[80:95]
    v_mfma_f32_32x32x16_bf16 v[96:111], v[184:187], v[180:183], v[96:111]
    v_mfma_f32_32x32x16_bf16 v[112:127], v[188:191], v[180:183], v[112:127]
    ds_read_b128 v[176:179], v11 offset:96
    ds_read_b128 v[180:183], v11 offset:4704
    ds_read_b64_tr_b16 v[184:185], v12 offset:15360
    ds_read_b64_tr_b16 v[186:187], v12 offset:16640
    ds_read_b64_tr_b16 v[188:189], v12 offset:15488
    ds_read_b64_tr_b16 v[190:191], v12 offset:16768
    s_waitcnt lgkmcnt(6)
    v_mfma_f32_32x32x16_bf16 v[64:79], v[168:171], v[160:163], v[64:79]
    v_mfma_f32_32x32x16_bf16 v[80:95], v[172:175], v[160:163], v[80:95]
    v_mfma_f32_32x32x16_bf16 v[96:111], v[168:171], v[164:167], v[96:111]
    v_mfma_f32_32x32x16_bf16 v[112:127], v[172:175], v[164:167], v[112:127]
    s_waitcnt lgkmcnt(0)
    v_mfma_f32_32x32x16_bf16 v[64:79], v[184:187], v[176:179], v[64:79]
    v_mfma_f32_32x32x16_bf16 v[80:95], v[188:191], v[176:179], v[80:95]
    v_mfma_f32_32x32x16_bf16 v[96:111], v[184:187], v[180:183], v[96:111]
    v_mfma_f32_32x32x16_bf16 v[112:127], v[188:191], v[180:183], v[112:127]
    s_waitcnt vmcnt(8)
    ds_write_b128 v9, v[192:195] offset:40960
    ds_write_b128 v9, v[196:199] offset:45568
    ds_write_b128 v9, v[200:203] offset:50176
    ds_write_b128 v9, v[204:207] offset:54784
    ds_write_b128 v10, v[208:211] offset:40960
    ds_write_b128 v10, v[212:215] offset:51200
    ds_write_b128 v10, v[216:219] offset:41088
    ds_write_b128 v10, v[220:223] offset:51328
    s_waitcnt lgkmcnt(0)
    s_barrier
    buffer_load_dwordx4 v[192:195], v1, s[8:11], s33 offen
    buffer_load_dwordx4 v[196:199], v2, s[8:11], s33 offen
    buffer_load_dwordx4 v[200:203], v3, s[8:11], s33 offen
    buffer_load_dwordx4 v[204:207], v4, s[8:11], s33 offen
    buffer_load_dwordx4 v[208:211], v5, s[12:15], s34 offen
    buffer_load_dwordx4 v[212:215], v6, s[12:15], s34 offen
    buffer_load_dwordx4 v[216:219], v5, s[16:19], s34 offen
    buffer_load_dwordx4 v[220:223], v6, s[16:19], s34 offen
    s_add_u32 s33, s33, 128
    s_add_u32 s34, s34, 229376
    ds_read_b128 v[160:163], v11 offset:40960
    ds_read_b128 v[164:167], v11 offset:45568
    ds_read_b64_tr_b16 v[168:169], v12 offset:40960
    ds_read_b64_tr_b16 v[170:171], v12 offset:42240
    ds_read_b64_tr_b16 v[172:173], v12 offset:41088
    ds_read_b64_tr_b16 v[174:175], v12 offset:42368
    ds_read_b128 v[176:179], v11 offset:40992
    ds_read_b128 v[180:183], v11 offset:45600
    ds_read_b64_tr_b16 v[184:185], v12 offset:46080
    ds_read_b64_tr_b16 v[186:187], v12 offset:47360
    ds_read_b64_tr_b16 v[188:189], v12 offset:46208
    ds_read_b64_tr_b16 v[190:191], v12 offset:47488
    s_waitcnt lgkmcnt(6)
    v_mfma_f32_32x32x16_bf16 v[64:79], v[168:171], v[160:163], v[64:79]
    v_mfma_f32_32x32x16_bf16 v[80:95], v[172:175], v[160:163], v[80:95]
    v_mfma_f32_32x32x16_bf16 v[96:111], v[168:171], v[164:167], v[96:111]
    v_mfma_f32_32x32x16_bf16 v[112:127], v[172:175], v[164:167], v[112:127]
    ds_read_b128 v[160:163], v11 offset:41024
    ds_read_b128 v[164:167], v11 offset:45632
    ds_read_b64_tr_b16 v[168:169], v12 offset:51200
    ds_read_b64_tr_b16 v[170:171], v12 offset:52480
    ds_read_b64_tr_b16 v[172:173], v12 offset:51328
    ds_read_b64_tr_b16 v[174:175], v12 offset:52608
    s_waitcnt lgkmcnt(6)
    v_mfma_f32_32x32x16_bf16 v[64:79], v[184:187], v[176:179], v[64:79]
    v_mfma_f32_32x32x16_bf16 v[80:95], v[188:191], v[176:179], v[80:95]
    v_mfma_f32_32x32x16_bf16 v[96:111], v[184:187], v[180:183], v[96:111]
    v_mfma_f32_32x32x16_bf16 v[112:127], v[188:191], v[180:183], v[112:127]
    ds_read_b128 v[176:179], v11 offset:41056
    ds_read_b128 v[180:183], v11 offset:45664
    ds_read_b64_tr_b16 v[184:185], v12 offset:56320
    ds_read_b64_tr_b16 v[186:187], v12 offset:57600
    ds_read_b64_tr_b16 v[188:189], v12 offset:56448
    ds_read_b64_tr_b16 v[190:191], v12 offset:57728
    s_waitcnt lgkmcnt(6)
    v_mfma_f32_32x32x16_bf16 v[64:79], v[168:171], v[160:163], v[64:79]
    v_mfma_f32_32x32x16_bf16 v[80:95], v[172:175], v[160:163], v[80:95]
    v_mfma_f32_32x32x16_bf16 v[96:111], v[168:171], v[164:167], v[96:111]
    v_mfma_f32_32x32x16_bf16 v[112:127], v[172:175], v[164:167], v[112:127]
    s_waitcnt lgkmcnt(0)
    v_mfma_f32_32x32x16_bf16 v[64:79], v[184:187], v[176:179], v[64:79]
    v_mfma_f32_32x32x16_bf16 v[80:95], v[188:191], v[176:179], v[80:95]
    v_mfma_f32_32x32x16_bf16 v[96:111], v[184:187], v[180:183], v[96:111]
    v_mfma_f32_32x32x16_bf16 v[112:127], v[188:191], v[180:183], v[112:127]
    s_waitcnt vmcnt(8)
    ds_write_b128 v9, v[128:131] offset:0
    ds_write_b128 v9, v[132:135] offset:4608
    ds_write_b128 v9, v[136:139] offset:9216
    ds_write_b128 v9, v[140:143] offset:13824
    ds_write_b128 v10, v[144:147] offset:0
    ds_write_b128 v10, v[148:151] offset:10240
    ds_write_b128 v10, v[152:155] offset:128
    ds_write_b128 v10, v[156:159] offset:10368
    s_waitcnt lgkmcnt(0)
    s_barrier
    buffer_load_dwordx4 v[128:131], v1, s[8:11], s33 offen
    buffer_load_dwordx4 v[132:135], v2, s[8:11], s33 offen
    buffer_load_dwordx4 v[136:139], v3, s[8:11], s33 offen
    buffer_load_dwordx4 v[140:143], v4, s[8:11], s33 offen
    buffer_load_dwordx4 v[144:147], v5, s[12:15], s34 offen
    buffer_load_dwordx4 v[148:151], v6, s[12:15], s34 offen
    buffer_load_dwordx4 v[152:155], v5, s[16:19], s34 offen
    buffer_load_dwordx4 v[156:159], v6, s[16:19], s34 offen
    s_add_u32 s33, s33, 128
    s_add_u32 s34, s34, 229376
    ds_read_b128 v[160:163], v11 offset:0
    ds_read_b128 v[164:167], v11 offset:4608
    ds_read_b64_tr_b16 v[168:169], v12 offset:0
    ds_read_b64_tr_b16 v[170:171], v12 offset:1280
    ds_read_b64_tr_b16 v[172:173], v12 offset:128
    ds_read_b64_tr_b16 v[174:175], v12 offset:1408
    ds_read_b128 v[176:179], v11 offset:32
    ds_read_b128 v[180:183], v11 offset:4640
    ds_read_b64_tr_b16 v[184:185], v12 offset:5120
    ds_read_b64_tr_b16 v[186:187], v12 offset:6400
    ds_read_b64_tr_b16 v[188:189], v12 offset:5248
    ds_read_b64_tr_b16 v[190:191], v12 offset:6528
    s_waitcnt lgkmcnt(6)
    v_mfma_f32_32x32x16_bf16 v[64:79], v[168:171], v[160:163], v[64:79]
    v_mfma_f32_32x32x16_bf16 v[80:95], v[172:175], v[160:163], v[80:95]
    v_mfma_f32_32x32x16_bf16 v[96:111], v[168:171], v[164:167], v[96:111]
    v_mfma_f32_32x32x16_bf16 v[112:127], v[172:175], v[164:167], v[112:127]
    ds_read_b128 v[160:163], v11 offset:64
    ds_read_b128 v[164:167], v11 offset:4672
    ds_read_b64_tr_b16 v[168:169], v12 offset:10240
    ds_read_b64_tr_b16 v[170:171], v12 offset:11520
    ds_read_b64_tr_b16 v[172:173], v12 offset:10368
    ds_read_b64_tr_b16 v[174:175], v12 offset:11648
    s_waitcnt lgkmcnt(6)
    v_mfma_f32_32x32x16_bf16 v[64:79], v[184:187], v[176:179], v[64:79]
    v_mfma_f32_32x32x16_bf16 v[80:95], v[188:191], v[176:179], v[80:95]
    v_mfma_f32_32x32x16_bf16 v[96:111], v[184:187], v[180:183], v[96:111]
    v_mfma_f32_32x32x16_bf16 v[112:127], v[188:191], v[180:183], v[112:127]
    ds_read_b128 v[176:179], v11 offset:96
    ds_read_b128 v[180:183], v11 offset:4704
    ds_read_b64_tr_b16 v[184:185], v12 offset:15360
    ds_read_b64_tr_b16 v[186:187], v12 offset:16640
    ds_read_b64_tr_b16 v[188:189], v12 offset:15488
    ds_read_b64_tr_b16 v[190:191], v12 offset:16768
    s_waitcnt lgkmcnt(6)
    v_mfma_f32_32x32x16_bf16 v[64:79], v[168:171], v[160:163], v[64:79]
    v_mfma_f32_32x32x16_bf16 v[80:95], v[172:175], v[160:163], v[80:95]
    v_mfma_f32_32x32x16_bf16 v[96:111], v[168:171], v[164:167], v[96:111]
    v_mfma_f32_32x32x16_bf16 v[112:127], v[172:175], v[164:167], v[112:127]
    s_waitcnt lgkmcnt(0)
    v_mfma_f32_32x32x16_bf16 v[64:79], v[184:187], v[176:179], v[64:79]
    v_mfma_f32_32x32x16_bf16 v[80:95], v[188:191], v[176:179], v[80:95]
    v_mfma_f32_32x32x16_bf16 v[96:111], v[184:187], v[180:183], v[96:111]
    v_mfma_f32_32x32x16_bf16 v[112:127], v[188:191], v[180:183], v[112:127]
    s_waitcnt vmcnt(8)
    ds_write_b128 v9, v[192:195] offset:40960
    ds_write_b128 v9, v[196:199] offset:45568
    ds_write_b128 v9, v[200:203] offset:50176
    ds_write_b128 v9, v[204:207] offset:54784
    ds_write_b128 v10, v[208:211] offset:40960
    ds_write_b128 v10, v[212:215] offset:51200
    ds_write_b128 v10, v[216:219] offset:41088
    ds_write_b128 v10, v[220:223] offset:51328
    s_waitcnt lgkmcnt(0)
    s_barrier
    buffer_load_dwordx4 v[192:195], v1, s[8:11], s33 offen
    buffer_load_dwordx4 v[196:199], v2, s[8:11], s33 offen
    buffer_load_dwordx4 v[200:203], v3, s[8:11], s33 offen
    buffer_load_dwordx4 v[204:207], v4, s[8:11], s33 offen
    buffer_load_dwordx4 v[208:211], v5, s[12:15], s34 offen
    buffer_load_dwordx4 v[212:215], v6, s[12:15], s34 offen
    buffer_load_dwordx4 v[216:219], v5, s[16:19], s34 offen
    buffer_load_dwordx4 v[220:223], v6, s[16:19], s34 offen
    s_add_u32 s33, s33, 128
    s_add_u32 s34, s34, 229376
    ds_read_b128 v[160:163], v11 offset:40960
    ds_read_b128 v[164:167], v11 offset:45568
    ds_read_b64_tr_b16 v[168:169], v12 offset:40960
    ds_read_b64_tr_b16 v[170:171], v12 offset:42240
    ds_read_b64_tr_b16 v[172:173], v12 offset:41088
    ds_read_b64_tr_b16 v[174:175], v12 offset:42368
    ds_read_b128 v[176:179], v11 offset:40992
    ds_read_b128 v[180:183], v11 offset:45600
    ds_read_b64_tr_b16 v[184:185], v12 offset:46080
    ds_read_b64_tr_b16 v[186:187], v12 offset:47360
    ds_read_b64_tr_b16 v[188:189], v12 offset:46208
    ds_read_b64_tr_b16 v[190:191], v12 offset:47488
    s_waitcnt lgkmcnt(6)
    v_mfma_f32_32x32x16_bf16 v[64:79], v[168:171], v[160:163], v[64:79]
    v_mfma_f32_32x32x16_bf16 v[80:95], v[172:175], v[160:163], v[80:95]
    v_mfma_f32_32x32x16_bf16 v[96:111], v[168:171], v[164:167], v[96:111]
    v_mfma_f32_32x32x16_bf16 v[112:127], v[172:175], v[164:167], v[112:127]
    ds_read_b128 v[160:163], v11 offset:41024
    ds_read_b128 v[164:167], v11 offset:45632
    ds_read_b64_tr_b16 v[168:169], v12 offset:51200
    ds_read_b64_tr_b16 v[170:171], v12 offset:52480
    ds_read_b64_tr_b16 v[172:173], v12 offset:51328
    ds_read_b64_tr_b16 v[174:175], v12 offset:52608
    s_waitcnt lgkmcnt(6)
    v_mfma_f32_32x32x16_bf16 v[64:79], v[184:187], v[176:179], v[64:79]
    v_mfma_f32_32x32x16_bf16 v[80:95], v[188:191], v[176:179], v[80:95]
    v_mfma_f32_32x32x16_bf16 v[96:111], v[184:187], v[180:183], v[96:111]
    v_mfma_f32_32x32x16_bf16 v[112:127], v[188:191], v[180:183], v[112:127]
    ds_read_b128 v[176:179], v11 offset:41056
    ds_read_b128 v[180:183], v11 offset:45664
    ds_read_b64_tr_b16 v[184:185], v12 offset:56320
    ds_read_b64_tr_b16 v[186:187], v12 offset:57600
    ds_read_b64_tr_b16 v[188:189], v12 offset:56448
    ds_read_b64_tr_b16 v[190:191], v12 offset:57728
    s_waitcnt lgkmcnt(6)
    v_mfma_f32_32x32x16_bf16 v[64:79], v[168:171], v[160:163], v[64:79]
    v_mfma_f32_32x32x16_bf16 v[80:95], v[172:175], v[160:163], v[80:95]
    v_mfma_f32_32x32x16_bf16 v[96:111], v[168:171], v[164:167], v[96:111]
    v_mfma_f32_32x32x16_bf16 v[112:127], v[172:175], v[164:167], v[112:127]
    s_waitcnt lgkmcnt(0)
    v_mfma_f32_32x32x16_bf16 v[64:79], v[184:187], v[176:179], v[64:79]
    v_mfma_f32_32x32x16_bf16 v[80:95], v[188:191], v[176:179], v[80:95]
    v_mfma_f32_32x32x16_bf16 v[96:111], v[184:187], v[180:183], v[96:111]
    v_mfma_f32_32x32x16_bf16 v[112:127], v[188:191], v[180:183], v[112:127]
    s_waitcnt vmcnt(8)
    ds_write_b128 v9, v[128:131] offset:0
    ds_write_b128 v9, v[132:135] offset:4608
    ds_write_b128 v9, v[136:139] offset:9216
    ds_write_b128 v9, v[140:143] offset:13824
    ds_write_b128 v10, v[144:147] offset:0
    ds_write_b128 v10, v[148:151] offset:10240
    ds_write_b128 v10, v[152:155] offset:128
    ds_write_b128 v10, v[156:159] offset:10368
    s_waitcnt lgkmcnt(0)
    s_barrier
    ds_read_b128 v[160:163], v11 offset:0
    ds_read_b128 v[164:167], v11 offset:4608
    ds_read_b64_tr_b16 v[168:169], v12 offset:0
    ds_read_b64_tr_b16 v[170:171], v12 offset:1280
    ds_read_b64_tr_b16 v[172:173], v12 offset:128
    ds_read_b64_tr_b16 v[174:175], v12 offset:1408
    ds_read_b128 v[176:179], v11 offset:32
    ds_read_b128 v[180:183], v11 offset:4640
    ds_read_b64_tr_b16 v[184:185], v12 offset:5120
    ds_read_b64_tr_b16 v[186:187], v12 offset:6400
    ds_read_b64_tr_b16 v[188:189], v12 offset:5248
    ds_read_b64_tr_b16 v[190:191], v12 offset:6528
    s_waitcnt lgkmcnt(6)
    v_mfma_f32_32x32x16_bf16 v[64:79], v[168:171], v[160:163], v[64:79]
    v_mfma_f32_32x32x16_bf16 v[80:95], v[172:175], v[160:163], v[80:95]
    v_mfma_f32_32x32x16_bf16 v[96:111], v[168:171], v[164:167], v[96:111]
    v_mfma_f32_32x32x16_bf16 v[112:127], v[172:175], v[164:167], v[112:127]
    ds_read_b128 v[160:163], v11 offset:64
    ds_read_b128 v[164:167], v11 offset:4672
    ds_read_b64_tr_b16 v[168:169], v12 offset:10240
    ds_read_b64_tr_b16 v[170:171], v12 offset:11520
    ds_read_b64_tr_b16 v[172:173], v12 offset:10368
    ds_read_b64_tr_b16 v[174:175], v12 offset:11648
    s_waitcnt lgkmcnt(6)
    v_mfma_f32_32x32x16_bf16 v[64:79], v[184:187], v[176:179], v[64:79]
    v_mfma_f32_32x32x16_bf16 v[80:95], v[188:191], v[176:179], v[80:95]
    v_mfma_f32_32x32x16_bf16 v[96:111], v[184:187], v[180:183], v[96:111]
    v_mfma_f32_32x32x16_bf16 v[112:127], v[188:191], v[180:183], v[112:127]
    ds_read_b128 v[176:179], v11 offset:96
    ds_read_b128 v[180:183], v11 offset:4704
    ds_read_b64_tr_b16 v[184:185], v12 offset:15360
    ds_read_b64_tr_b16 v[186:187], v12 offset:16640
    ds_read_b64_tr_b16 v[188:189], v12 offset:15488
    ds_read_b64_tr_b16 v[190:191], v12 offset:16768
    s_waitcnt lgkmcnt(6)
    v_mfma_f32_32x32x16_bf16 v[64:79], v[168:171], v[160:163], v[64:79]
    v_mfma_f32_32x32x16_bf16 v[80:95], v[172:175], v[160:163], v[80:95]
    v_mfma_f32_32x32x16_bf16 v[96:111], v[168:171], v[164:167], v[96:111]
    v_mfma_f32_32x32x16_bf16 v[112:127], v[172:175], v[164:167], v[112:127]
    s_waitcnt lgkmcnt(0)
    v_mfma_f32_32x32x16_bf16 v[64:79], v[184:187], v[176:179], v[64:79]
    v_mfma_f32_32x32x16_bf16 v[80:95], v[188:191], v[176:179], v[80:95]
    v_mfma_f32_32x32x16_bf16 v[96:111], v[184:187], v[180:183], v[96:111]
    v_mfma_f32_32x32x16_bf16 v[112:127], v[188:191], v[180:183], v[112:127]
    s_waitcnt vmcnt(0)
    ds_write_b128 v9, v[192:195] offset:40960
    ds_write_b128 v9, v[196:199] offset:45568
    ds_write_b128 v9, v[200:203] offset:50176
    ds_write_b128 v9, v[204:207] offset:54784
    ds_write_b128 v10, v[208:211] offset:40960
    ds_write_b128 v10, v[212:215] offset:51200
    ds_write_b128 v10, v[216:219] offset:41088
    ds_write_b128 v10, v[220:223] offset:51328
    s_waitcnt lgkmcnt(0)
    s_barrier
    ds_read_b128 v[160:163], v11 offset:40960
    ds_read_b128 v[164:167], v11 offset:45568
    ds_read_b64_tr_b16 v[168:169], v12 offset:40960
    ds_read_b64_tr_b16 v[170:171], v12 offset:42240
    ds_read_b64_tr_b16 v[172:173], v12 offset:41088
    ds_read_b64_tr_b16 v[174:175], v12 offset:42368
    ds_read_b128 v[176:179], v11 offset:40992
    ds_read_b128 v[180:183], v11 offset:45600
    ds_read_b64_tr_b16 v[184:185], v12 offset:46080
    ds_read_b64_tr_b16 v[186:187], v12 offset:47360
    ds_read_b64_tr_b16 v[188:189], v12 offset:46208
    ds_read_b64_tr_b16 v[190:191], v12 offset:47488
    s_waitcnt lgkmcnt(6)
    v_mfma_f32_32x32x16_bf16 v[64:79], v[168:171], v[160:163], v[64:79]
    v_mfma_f32_32x32x16_bf16 v[80:95], v[172:175], v[160:163], v[80:95]
    v_mfma_f32_32x32x16_bf16 v[96:111], v[168:171], v[164:167], v[96:111]
    v_mfma_f32_32x32x16_bf16 v[112:127], v[172:175], v[164:167], v[112:127]
    ds_read_b128 v[160:163], v11 offset:41024
    ds_read_b128 v[164:167], v11 offset:45632
    ds_read_b64_tr_b16 v[168:169], v12 offset:51200
    ds_read_b64_tr_b16 v[170:171], v12 offset:52480
    ds_read_b64_tr_b16 v[172:173], v12 offset:51328
    ds_read_b64_tr_b16 v[174:175], v12 offset:52608
    s_waitcnt lgkmcnt(6)
    v_mfma_f32_32x32x16_bf16 v[64:79], v[184:187], v[176:179], v[64:79]
    v_mfma_f32_32x32x16_bf16 v[80:95], v[188:191], v[176:179], v[80:95]
    v_mfma_f32_32x32x16_bf16 v[96:111], v[184:187], v[180:183], v[96:111]
    v_mfma_f32_32x32x16_bf16 v[112:127], v[188:191], v[180:183], v[112:127]
    ds_read_b128 v[176:179], v11 offset:41056
    ds_read_b128 v[180:183], v11 offset:45664
    ds_read_b64_tr_b16 v[184:185], v12 offset:56320
    ds_read_b64_tr_b16 v[186:187], v12 offset:57600
    ds_read_b64_tr_b16 v[188:189], v12 offset:56448
    ds_read_b64_tr_b16 v[190:191], v12 offset:57728
    s_waitcnt lgkmcnt(6)
    v_mfma_f32_32x32x16_bf16 v[64:79], v[168:171], v[160:163], v[64:79]
    v_mfma_f32_32x32x16_bf16 v[80:95], v[172:175], v[160:163], v[80:95]
    v_mfma_f32_32x32x16_bf16 v[96:111], v[168:171], v[164:167], v[96:111]
    v_mfma_f32_32x32x16_bf16 v[112:127], v[172:175], v[164:167], v[112:127]
    s_waitcnt lgkmcnt(0)
    v_mfma_f32_32x32x16_bf16 v[64:79], v[184:187], v[176:179], v[64:79]
    v_mfma_f32_32x32x16_bf16 v[80:95], v[188:191], v[176:179], v[80:95]
    v_mfma_f32_32x32x16_bf16 v[96:111], v[184:187], v[180:183], v[96:111]
    v_mfma_f32_32x32x16_bf16 v[112:127], v[188:191], v[180:183], v[112:127]
    s_nop 15
    s_nop 3
    v_and_b32 v22, 31, v13
    v_lshl_add_u32 v22, v15, 6, v22
    v_add_u32 v22, s38, v22
    s_mov_b32 s39, 3584
    v_mul_lo_u32 v22, v22, s39
    v_lshrrev_b32 v23, 5, v13
    v_lshl_add_u32 v22, v23, 3, v22
    v_add_u32 v22, s37, v22
    v_mul_u32_u24 v23, 64, v16
    v_add_u32 v22, v22, v23
    s_mov_b32 s40, 75497472
    s_mov_b32 s42, 0x3d372713
    s_mov_b32 s43, 0xc0135761
    v_mov_b32 v23, v22
    v_cvt_pk_bf16_f32 v64, v64, v64
    v_lshlrev_b32 v64, 16, v64
    v_cvt_pk_bf16_f32 v80, v80, v80
    v_lshlrev_b32 v80, 16, v80
    v_mul_f32 v30, v64, v64
    v_fma_f32 v30, v30, s42, 1.0
    v_mul_f32 v30, v30, v64
    v_mul_f32 v30, s43, v30
    v_exp_f32 v30, v30
    s_nop 0
    v_add_f32 v30, 1.0, v30
    v_rcp_f32 v30, v30
    s_nop 0
    v_mul_f32 v30, v30, v64
    v_cvt_pk_bf16_f32 v30, v30, v30
    v_lshlrev_b32 v30, 16, v30
    v_mul_f32 v26, v30, v80
    v_cvt_pk_bf16_f32 v65, v65, v65
    v_lshlrev_b32 v65, 16, v65
    v_cvt_pk_bf16_f32 v81, v81, v81
    v_lshlrev_b32 v81, 16, v81
    v_mul_f32 v30, v65, v65
    v_fma_f32 v30, v30, s42, 1.0
    v_mul_f32 v30, v30, v65
    v_mul_f32 v30, s43, v30
    v_exp_f32 v30, v30
    s_nop 0
    v_add_f32 v30, 1.0, v30
    v_rcp_f32 v30, v30
    s_nop 0
    v_mul_f32 v30, v30, v65
    v_cvt_pk_bf16_f32 v30, v30, v30
    v_lshlrev_b32 v30, 16, v30
    v_mul_f32 v27, v30, v81
    v_cvt_pk_bf16_f32 v66, v66, v66
    v_lshlrev_b32 v66, 16, v66
    v_cvt_pk_bf16_f32 v82, v82, v82
    v_lshlrev_b32 v82, 16, v82
    v_mul_f32 v30, v66, v66
    v_fma_f32 v30, v30, s42, 1.0
    v_mul_f32 v30, v30, v66
    v_mul_f32 v30, s43, v30
    v_exp_f32 v30, v30
    s_nop 0
    v_add_f32 v30, 1.0, v30
    v_rcp_f32 v30, v30
    s_nop 0
    v_mul_f32 v30, v30, v66
    v_cvt_pk_bf16_f32 v30, v30, v30
    v_lshlrev_b32 v30, 16, v30
    v_mul_f32 v28, v30, v82
    v_cvt_pk_bf16_f32 v67, v67, v67
    v_lshlrev_b32 v67, 16, v67
    v_cvt_pk_bf16_f32 v83, v83, v83
    v_lshlrev_b32 v83, 16, v83
    v_mul_f32 v30, v67, v67
    v_fma_f32 v30, v30, s42, 1.0
    v_mul_f32 v30, v30, v67
    v_mul_f32 v30, s43, v30
    v_exp_f32 v30, v30
    s_nop 0
    v_add_f32 v30, 1.0, v30
    v_rcp_f32 v30, v30
    s_nop 0
    v_mul_f32 v30, v30, v67
    v_cvt_pk_bf16_f32 v30, v30, v30
    v_lshlrev_b32 v30, 16, v30
    v_mul_f32 v29, v30, v83
    v_cvt_pk_bf16_f32 v24, v26, v27
    v_cvt_pk_bf16_f32 v25, v28, v29
    buffer_store_dwordx2 v[24:25], v23, s[20:23], s40 offen offset:0
    s_nop 1
    v_cvt_pk_bf16_f32 v68, v68, v68
    v_lshlrev_b32 v68, 16, v68
    v_cvt_pk_bf16_f32 v84, v84, v84
    v_lshlrev_b32 v84, 16, v84
    v_mul_f32 v30, v68, v68
    v_fma_f32 v30, v30, s42, 1.0
    v_mul_f32 v30, v30, v68
    v_mul_f32 v30, s43, v30
    v_exp_f32 v30, v30
    s_nop 0
    v_add_f32 v30, 1.0, v30
    v_rcp_f32 v30, v30
    s_nop 0
    v_mul_f32 v30, v30, v68
    v_cvt_pk_bf16_f32 v30, v30, v30
    v_lshlrev_b32 v30, 16, v30
    v_mul_f32 v26, v30, v84
    v_cvt_pk_bf16_f32 v69, v69, v69
    v_lshlrev_b32 v69, 16, v69
    v_cvt_pk_bf16_f32 v85, v85, v85
    v_lshlrev_b32 v85, 16, v85
    v_mul_f32 v30, v69, v69
    v_fma_f32 v30, v30, s42, 1.0
    v_mul_f32 v30, v30, v69
    v_mul_f32 v30, s43, v30
    v_exp_f32 v30, v30
    s_nop 0
    v_add_f32 v30, 1.0, v30
    v_rcp_f32 v30, v30
    s_nop 0
    v_mul_f32 v30, v30, v69
    v_cvt_pk_bf16_f32 v30, v30, v30
    v_lshlrev_b32 v30, 16, v30
    v_mul_f32 v27, v30, v85
    v_cvt_pk_bf16_f32 v70, v70, v70
    v_lshlrev_b32 v70, 16, v70
    v_cvt_pk_bf16_f32 v86, v86, v86
    v_lshlrev_b32 v86, 16, v86
    v_mul_f32 v30, v70, v70
    v_fma_f32 v30, v30, s42, 1.0
    v_mul_f32 v30, v30, v70
    v_mul_f32 v30, s43, v30
    v_exp_f32 v30, v30
    s_nop 0
    v_add_f32 v30, 1.0, v30
    v_rcp_f32 v30, v30
    s_nop 0
    v_mul_f32 v30, v30, v70
    v_cvt_pk_bf16_f32 v30, v30, v30
    v_lshlrev_b32 v30, 16, v30
    v_mul_f32 v28, v30, v86
    v_cvt_pk_bf16_f32 v71, v71, v71
    v_lshlrev_b32 v71, 16, v71
    v_cvt_pk_bf16_f32 v87, v87, v87
    v_lshlrev_b32 v87, 16, v87
    v_mul_f32 v30, v71, v71
    v_fma_f32 v30, v30, s42, 1.0
    v_mul_f32 v30, v30, v71
    v_mul_f32 v30, s43, v30
    v_exp_f32 v30, v30
    s_nop 0
    v_add_f32 v30, 1.0, v30
    v_rcp_f32 v30, v30
    s_nop 0
    v_mul_f32 v30, v30, v71
    v_cvt_pk_bf16_f32 v30, v30, v30
    v_lshlrev_b32 v30, 16, v30
    v_mul_f32 v29, v30, v87
    v_cvt_pk_bf16_f32 v24, v26, v27
    v_cvt_pk_bf16_f32 v25, v28, v29
    buffer_store_dwordx2 v[24:25], v23, s[20:23], s40 offen offset:16
    s_nop 1
    v_cvt_pk_bf16_f32 v72, v72, v72
    v_lshlrev_b32 v72, 16, v72
    v_cvt_pk_bf16_f32 v88, v88, v88
    v_lshlrev_b32 v88, 16, v88
    v_mul_f32 v30, v72, v72
    v_fma_f32 v30, v30, s42, 1.0
    v_mul_f32 v30, v30, v72
    v_mul_f32 v30, s43, v30
    v_exp_f32 v30, v30
    s_nop 0
    v_add_f32 v30, 1.0, v30
    v_rcp_f32 v30, v30
    s_nop 0
    v_mul_f32 v30, v30, v72
    v_cvt_pk_bf16_f32 v30, v30, v30
    v_lshlrev_b32 v30, 16, v30
    v_mul_f32 v26, v30, v88
    v_cvt_pk_bf16_f32 v73, v73, v73
    v_lshlrev_b32 v73, 16, v73
    v_cvt_pk_bf16_f32 v89, v89, v89
    v_lshlrev_b32 v89, 16, v89
    v_mul_f32 v30, v73, v73
    v_fma_f32 v30, v30, s42, 1.0
    v_mul_f32 v30, v30, v73
    v_mul_f32 v30, s43, v30
    v_exp_f32 v30, v30
    s_nop 0
    v_add_f32 v30, 1.0, v30
    v_rcp_f32 v30, v30
    s_nop 0
    v_mul_f32 v30, v30, v73
    v_cvt_pk_bf16_f32 v30, v30, v30
    v_lshlrev_b32 v30, 16, v30
    v_mul_f32 v27, v30, v89
    v_cvt_pk_bf16_f32 v74, v74, v74
    v_lshlrev_b32 v74, 16, v74
    v_cvt_pk_bf16_f32 v90, v90, v90
    v_lshlrev_b32 v90, 16, v90
    v_mul_f32 v30, v74, v74
    v_fma_f32 v30, v30, s42, 1.0
    v_mul_f32 v30, v30, v74
    v_mul_f32 v30, s43, v30
    v_exp_f32 v30, v30
    s_nop 0
    v_add_f32 v30, 1.0, v30
    v_rcp_f32 v30, v30
    s_nop 0
    v_mul_f32 v30, v30, v74
    v_cvt_pk_bf16_f32 v30, v30, v30
    v_lshlrev_b32 v30, 16, v30
    v_mul_f32 v28, v30, v90
    v_cvt_pk_bf16_f32 v75, v75, v75
    v_lshlrev_b32 v75, 16, v75
    v_cvt_pk_bf16_f32 v91, v91, v91
    v_lshlrev_b32 v91, 16, v91
    v_mul_f32 v30, v75, v75
    v_fma_f32 v30, v30, s42, 1.0
    v_mul_f32 v30, v30, v75
    v_mul_f32 v30, s43, v30
    v_exp_f32 v30, v30
    s_nop 0
    v_add_f32 v30, 1.0, v30
    v_rcp_f32 v30, v30
    s_nop 0
    v_mul_f32 v30, v30, v75
    v_cvt_pk_bf16_f32 v30, v30, v30
    v_lshlrev_b32 v30, 16, v30
    v_mul_f32 v29, v30, v91
    v_cvt_pk_bf16_f32 v24, v26, v27
    v_cvt_pk_bf16_f32 v25, v28, v29
    buffer_store_dwordx2 v[24:25], v23, s[20:23], s40 offen offset:32
    s_nop 1
    v_cvt_pk_bf16_f32 v76, v76, v76
    v_lshlrev_b32 v76, 16, v76
    v_cvt_pk_bf16_f32 v92, v92, v92
    v_lshlrev_b32 v92, 16, v92
    v_mul_f32 v30, v76, v76
    v_fma_f32 v30, v30, s42, 1.0
    v_mul_f32 v30, v30, v76
    v_mul_f32 v30, s43, v30
    v_exp_f32 v30, v30
    s_nop 0
    v_add_f32 v30, 1.0, v30
    v_rcp_f32 v30, v30
    s_nop 0
    v_mul_f32 v30, v30, v76
    v_cvt_pk_bf16_f32 v30, v30, v30
    v_lshlrev_b32 v30, 16, v30
    v_mul_f32 v26, v30, v92
    v_cvt_pk_bf16_f32 v77, v77, v77
    v_lshlrev_b32 v77, 16, v77
    v_cvt_pk_bf16_f32 v93, v93, v93
    v_lshlrev_b32 v93, 16, v93
    v_mul_f32 v30, v77, v77
    v_fma_f32 v30, v30, s42, 1.0
    v_mul_f32 v30, v30, v77
    v_mul_f32 v30, s43, v30
    v_exp_f32 v30, v30
    s_nop 0
    v_add_f32 v30, 1.0, v30
    v_rcp_f32 v30, v30
    s_nop 0
    v_mul_f32 v30, v30, v77
    v_cvt_pk_bf16_f32 v30, v30, v30
    v_lshlrev_b32 v30, 16, v30
    v_mul_f32 v27, v30, v93
    v_cvt_pk_bf16_f32 v78, v78, v78
    v_lshlrev_b32 v78, 16, v78
    v_cvt_pk_bf16_f32 v94, v94, v94
    v_lshlrev_b32 v94, 16, v94
    v_mul_f32 v30, v78, v78
    v_fma_f32 v30, v30, s42, 1.0
    v_mul_f32 v30, v30, v78
    v_mul_f32 v30, s43, v30
    v_exp_f32 v30, v30
    s_nop 0
    v_add_f32 v30, 1.0, v30
    v_rcp_f32 v30, v30
    s_nop 0
    v_mul_f32 v30, v30, v78
    v_cvt_pk_bf16_f32 v30, v30, v30
    v_lshlrev_b32 v30, 16, v30
    v_mul_f32 v28, v30, v94
    v_cvt_pk_bf16_f32 v79, v79, v79
    v_lshlrev_b32 v79, 16, v79
    v_cvt_pk_bf16_f32 v95, v95, v95
    v_lshlrev_b32 v95, 16, v95
    v_mul_f32 v30, v79, v79
    v_fma_f32 v30, v30, s42, 1.0
    v_mul_f32 v30, v30, v79
    v_mul_f32 v30, s43, v30
    v_exp_f32 v30, v30
    s_nop 0
    v_add_f32 v30, 1.0, v30
    v_rcp_f32 v30, v30
    s_nop 0
    v_mul_f32 v30, v30, v79
    v_cvt_pk_bf16_f32 v30, v30, v30
    v_lshlrev_b32 v30, 16, v30
    v_mul_f32 v29, v30, v95
    v_cvt_pk_bf16_f32 v24, v26, v27
    v_cvt_pk_bf16_f32 v25, v28, v29
    buffer_store_dwordx2 v[24:25], v23, s[20:23], s40 offen offset:48
    s_nop 1
    v_add_u32 v23, 114688, v22
    v_cvt_pk_bf16_f32 v96, v96, v96
    v_lshlrev_b32 v96, 16, v96
    v_cvt_pk_bf16_f32 v112, v112, v112
    v_lshlrev_b32 v112, 16, v112
    v_mul_f32 v30, v96, v96
    v_fma_f32 v30, v30, s42, 1.0
    v_mul_f32 v30, v30, v96
    v_mul_f32 v30, s43, v30
    v_exp_f32 v30, v30
    s_nop 0
    v_add_f32 v30, 1.0, v30
    v_rcp_f32 v30, v30
    s_nop 0
    v_mul_f32 v30, v30, v96
    v_cvt_pk_bf16_f32 v30, v30, v30
    v_lshlrev_b32 v30, 16, v30
    v_mul_f32 v26, v30, v112
    v_cvt_pk_bf16_f32 v97, v97, v97
    v_lshlrev_b32 v97, 16, v97
    v_cvt_pk_bf16_f32 v113, v113, v113
    v_lshlrev_b32 v113, 16, v113
    v_mul_f32 v30, v97, v97
    v_fma_f32 v30, v30, s42, 1.0
    v_mul_f32 v30, v30, v97
    v_mul_f32 v30, s43, v30
    v_exp_f32 v30, v30
    s_nop 0
    v_add_f32 v30, 1.0, v30
    v_rcp_f32 v30, v30
    s_nop 0
    v_mul_f32 v30, v30, v97
    v_cvt_pk_bf16_f32 v30, v30, v30
    v_lshlrev_b32 v30, 16, v30
    v_mul_f32 v27, v30, v113
    v_cvt_pk_bf16_f32 v98, v98, v98
    v_lshlrev_b32 v98, 16, v98
    v_cvt_pk_bf16_f32 v114, v114, v114
    v_lshlrev_b32 v114, 16, v114
    v_mul_f32 v30, v98, v98
    v_fma_f32 v30, v30, s42, 1.0
    v_mul_f32 v30, v30, v98
    v_mul_f32 v30, s43, v30
    v_exp_f32 v30, v30
    s_nop 0
    v_add_f32 v30, 1.0, v30
    v_rcp_f32 v30, v30
    s_nop 0
    v_mul_f32 v30, v30, v98
    v_cvt_pk_bf16_f32 v30, v30, v30
    v_lshlrev_b32 v30, 16, v30
    v_mul_f32 v28, v30, v114
    v_cvt_pk_bf16_f32 v99, v99, v99
    v_lshlrev_b32 v99, 16, v99
    v_cvt_pk_bf16_f32 v115, v115, v115
    v_lshlrev_b32 v115, 16, v115
    v_mul_f32 v30, v99, v99
    v_fma_f32 v30, v30, s42, 1.0
    v_mul_f32 v30, v30, v99
    v_mul_f32 v30, s43, v30
    v_exp_f32 v30, v30
    s_nop 0
    v_add_f32 v30, 1.0, v30
    v_rcp_f32 v30, v30
    s_nop 0
    v_mul_f32 v30, v30, v99
    v_cvt_pk_bf16_f32 v30, v30, v30
    v_lshlrev_b32 v30, 16, v30
    v_mul_f32 v29, v30, v115
    v_cvt_pk_bf16_f32 v24, v26, v27
    v_cvt_pk_bf16_f32 v25, v28, v29
    buffer_store_dwordx2 v[24:25], v23, s[20:23], s40 offen offset:0
    s_nop 1
    v_cvt_pk_bf16_f32 v100, v100, v100
    v_lshlrev_b32 v100, 16, v100
    v_cvt_pk_bf16_f32 v116, v116, v116
    v_lshlrev_b32 v116, 16, v116
    v_mul_f32 v30, v100, v100
    v_fma_f32 v30, v30, s42, 1.0
    v_mul_f32 v30, v30, v100
    v_mul_f32 v30, s43, v30
    v_exp_f32 v30, v30
    s_nop 0
    v_add_f32 v30, 1.0, v30
    v_rcp_f32 v30, v30
    s_nop 0
    v_mul_f32 v30, v30, v100
    v_cvt_pk_bf16_f32 v30, v30, v30
    v_lshlrev_b32 v30, 16, v30
    v_mul_f32 v26, v30, v116
    v_cvt_pk_bf16_f32 v101, v101, v101
    v_lshlrev_b32 v101, 16, v101
    v_cvt_pk_bf16_f32 v117, v117, v117
    v_lshlrev_b32 v117, 16, v117
    v_mul_f32 v30, v101, v101
    v_fma_f32 v30, v30, s42, 1.0
    v_mul_f32 v30, v30, v101
    v_mul_f32 v30, s43, v30
    v_exp_f32 v30, v30
    s_nop 0
    v_add_f32 v30, 1.0, v30
    v_rcp_f32 v30, v30
    s_nop 0
    v_mul_f32 v30, v30, v101
    v_cvt_pk_bf16_f32 v30, v30, v30
    v_lshlrev_b32 v30, 16, v30
    v_mul_f32 v27, v30, v117
    v_cvt_pk_bf16_f32 v102, v102, v102
    v_lshlrev_b32 v102, 16, v102
    v_cvt_pk_bf16_f32 v118, v118, v118
    v_lshlrev_b32 v118, 16, v118
    v_mul_f32 v30, v102, v102
    v_fma_f32 v30, v30, s42, 1.0
    v_mul_f32 v30, v30, v102
    v_mul_f32 v30, s43, v30
    v_exp_f32 v30, v30
    s_nop 0
    v_add_f32 v30, 1.0, v30
    v_rcp_f32 v30, v30
    s_nop 0
    v_mul_f32 v30, v30, v102
    v_cvt_pk_bf16_f32 v30, v30, v30
    v_lshlrev_b32 v30, 16, v30
    v_mul_f32 v28, v30, v118
    v_cvt_pk_bf16_f32 v103, v103, v103
    v_lshlrev_b32 v103, 16, v103
    v_cvt_pk_bf16_f32 v119, v119, v119
    v_lshlrev_b32 v119, 16, v119
    v_mul_f32 v30, v103, v103
    v_fma_f32 v30, v30, s42, 1.0
    v_mul_f32 v30, v30, v103
    v_mul_f32 v30, s43, v30
    v_exp_f32 v30, v30
    s_nop 0
    v_add_f32 v30, 1.0, v30
    v_rcp_f32 v30, v30
    s_nop 0
    v_mul_f32 v30, v30, v103
    v_cvt_pk_bf16_f32 v30, v30, v30
    v_lshlrev_b32 v30, 16, v30
    v_mul_f32 v29, v30, v119
    v_cvt_pk_bf16_f32 v24, v26, v27
    v_cvt_pk_bf16_f32 v25, v28, v29
    buffer_store_dwordx2 v[24:25], v23, s[20:23], s40 offen offset:16
    s_nop 1
    v_cvt_pk_bf16_f32 v104, v104, v104
    v_lshlrev_b32 v104, 16, v104
    v_cvt_pk_bf16_f32 v120, v120, v120
    v_lshlrev_b32 v120, 16, v120
    v_mul_f32 v30, v104, v104
    v_fma_f32 v30, v30, s42, 1.0
    v_mul_f32 v30, v30, v104
    v_mul_f32 v30, s43, v30
    v_exp_f32 v30, v30
    s_nop 0
    v_add_f32 v30, 1.0, v30
    v_rcp_f32 v30, v30
    s_nop 0
    v_mul_f32 v30, v30, v104
    v_cvt_pk_bf16_f32 v30, v30, v30
    v_lshlrev_b32 v30, 16, v30
    v_mul_f32 v26, v30, v120
    v_cvt_pk_bf16_f32 v105, v105, v105
    v_lshlrev_b32 v105, 16, v105
    v_cvt_pk_bf16_f32 v121, v121, v121
    v_lshlrev_b32 v121, 16, v121
    v_mul_f32 v30, v105, v105
    v_fma_f32 v30, v30, s42, 1.0
    v_mul_f32 v30, v30, v105
    v_mul_f32 v30, s43, v30
    v_exp_f32 v30, v30
    s_nop 0
    v_add_f32 v30, 1.0, v30
    v_rcp_f32 v30, v30
    s_nop 0
    v_mul_f32 v30, v30, v105
    v_cvt_pk_bf16_f32 v30, v30, v30
    v_lshlrev_b32 v30, 16, v30
    v_mul_f32 v27, v30, v121
    v_cvt_pk_bf16_f32 v106, v106, v106
    v_lshlrev_b32 v106, 16, v106
    v_cvt_pk_bf16_f32 v122, v122, v122
    v_lshlrev_b32 v122, 16, v122
    v_mul_f32 v30, v106, v106
    v_fma_f32 v30, v30, s42, 1.0
    v_mul_f32 v30, v30, v106
    v_mul_f32 v30, s43, v30
    v_exp_f32 v30, v30
    s_nop 0
    v_add_f32 v30, 1.0, v30
    v_rcp_f32 v30, v30
    s_nop 0
    v_mul_f32 v30, v30, v106
    v_cvt_pk_bf16_f32 v30, v30, v30
    v_lshlrev_b32 v30, 16, v30
    v_mul_f32 v28, v30, v122
    v_cvt_pk_bf16_f32 v107, v107, v107
    v_lshlrev_b32 v107, 16, v107
    v_cvt_pk_bf16_f32 v123, v123, v123
    v_lshlrev_b32 v123, 16, v123
    v_mul_f32 v30, v107, v107
    v_fma_f32 v30, v30, s42, 1.0
    v_mul_f32 v30, v30, v107
    v_mul_f32 v30, s43, v30
    v_exp_f32 v30, v30
    s_nop 0
    v_add_f32 v30, 1.0, v30
    v_rcp_f32 v30, v30
    s_nop 0
    v_mul_f32 v30, v30, v107
    v_cvt_pk_bf16_f32 v30, v30, v30
    v_lshlrev_b32 v30, 16, v30
    v_mul_f32 v29, v30, v123
    v_cvt_pk_bf16_f32 v24, v26, v27
    v_cvt_pk_bf16_f32 v25, v28, v29
    buffer_store_dwordx2 v[24:25], v23, s[20:23], s40 offen offset:32
    s_nop 1
    v_cvt_pk_bf16_f32 v108, v108, v108
    v_lshlrev_b32 v108, 16, v108
    v_cvt_pk_bf16_f32 v124, v124, v124
    v_lshlrev_b32 v124, 16, v124
    v_mul_f32 v30, v108, v108
    v_fma_f32 v30, v30, s42, 1.0
    v_mul_f32 v30, v30, v108
    v_mul_f32 v30, s43, v30
    v_exp_f32 v30, v30
    s_nop 0
    v_add_f32 v30, 1.0, v30
    v_rcp_f32 v30, v30
    s_nop 0
    v_mul_f32 v30, v30, v108
    v_cvt_pk_bf16_f32 v30, v30, v30
    v_lshlrev_b32 v30, 16, v30
    v_mul_f32 v26, v30, v124
    v_cvt_pk_bf16_f32 v109, v109, v109
    v_lshlrev_b32 v109, 16, v109
    v_cvt_pk_bf16_f32 v125, v125, v125
    v_lshlrev_b32 v125, 16, v125
    v_mul_f32 v30, v109, v109
    v_fma_f32 v30, v30, s42, 1.0
    v_mul_f32 v30, v30, v109
    v_mul_f32 v30, s43, v30
    v_exp_f32 v30, v30
    s_nop 0
    v_add_f32 v30, 1.0, v30
    v_rcp_f32 v30, v30
    s_nop 0
    v_mul_f32 v30, v30, v109
    v_cvt_pk_bf16_f32 v30, v30, v30
    v_lshlrev_b32 v30, 16, v30
    v_mul_f32 v27, v30, v125
    v_cvt_pk_bf16_f32 v110, v110, v110
    v_lshlrev_b32 v110, 16, v110
    v_cvt_pk_bf16_f32 v126, v126, v126
    v_lshlrev_b32 v126, 16, v126
    v_mul_f32 v30, v110, v110
    v_fma_f32 v30, v30, s42, 1.0
    v_mul_f32 v30, v30, v110
    v_mul_f32 v30, s43, v30
    v_exp_f32 v30, v30
    s_nop 0
    v_add_f32 v30, 1.0, v30
    v_rcp_f32 v30, v30
    s_nop 0
    v_mul_f32 v30, v30, v110
    v_cvt_pk_bf16_f32 v30, v30, v30
    v_lshlrev_b32 v30, 16, v30
    v_mul_f32 v28, v30, v126
    v_cvt_pk_bf16_f32 v111, v111, v111
    v_lshlrev_b32 v111, 16, v111
    v_cvt_pk_bf16_f32 v127, v127, v127
    v_lshlrev_b32 v127, 16, v127
    v_mul_f32 v30, v111, v111
    v_fma_f32 v30, v30, s42, 1.0
    v_mul_f32 v30, v30, v111
    v_mul_f32 v30, s43, v30
    v_exp_f32 v30, v30
    s_nop 0
    v_add_f32 v30, 1.0, v30
    v_rcp_f32 v30, v30
    s_nop 0
    v_mul_f32 v30, v30, v111
    v_cvt_pk_bf16_f32 v30, v30, v30
    v_lshlrev_b32 v30, 16, v30
    v_mul_f32 v29, v30, v127
    v_cvt_pk_bf16_f32 v24, v26, v27
    v_cvt_pk_bf16_f32 v25, v28, v29
    buffer_store_dwordx2 v[24:25], v23, s[20:23], s40 offen offset:48
    s_nop 1
ffn1_kernel_done1:
    s_endpgm
.globl ffn2_kernel
.p2align 8
.type ffn2_kernel,@function
ffn2_kernel:
    s_cmp_ge_u32 s2, 256
    s_cbranch_scc1 ffn2_kernel_done1
    s_and_b32 s28, s2, 15
    s_lshr_b32 s29, s2, 4
    s_lshr_b32 s44, s29, 2
    s_and_b32 s29, s29, 3
    s_load_dwordx2 s[20:21], s[0:1], 104
    s_waitcnt lgkmcnt(0)
    s_mov_b32 s22, 268435456
    s_mov_b32 s23, 0x00020000
    s_mov_b32 s8, s20
    s_mov_b32 s9, s21
    s_mov_b32 s10, s22
    s_mov_b32 s11, s23
    s_load_dwordx2 s[12:13], s[0:1], 80
    s_waitcnt lgkmcnt(0)
    s_mov_b32 s14, 1835008
    s_mov_b32 s15, 0x00020000
    s_load_dwordx2 s[24:25], s[0:1], 88
    s_waitcnt lgkmcnt(0)
    s_mov_b32 s26, 2097152
    s_mov_b32 s27, 0x00020000
    s_lshl_b32 s37, s29, 8
    v_and_b32 v13, 63, v0
    v_lshrrev_b32 v14, 6, v0
    v_and_b32 v15, 1, v14
    v_lshrrev_b32 v16, 1, v14
    v_lshrrev_b32 v17, 3, v0
    v_and_b32 v18, 7, v0
    s_lshl_b32 s38, s28, 7
    v_add_u32 v19, s38, v17
    s_mov_b32 s39, 3584
    v_mul_lo_u32 v19, v19, s39
    v_lshl_add_u32 v1, v18, 4, v19
    v_add_u32 v1, 75497472, v1
    v_add_u32 v2, 114688, v1
    v_add_u32 v3, 229376, v1
    v_add_u32 v4, 344064, v1
    v_mul_u32_u24 v9, 144, v17
    v_lshl_add_u32 v9, v18, 4, v9
    v_lshrrev_b32 v17, 4, v0
    v_and_b32 v18, 15, v0
    s_mov_b32 s39, 1024
    v_mul_lo_u32 v19, v17, s39
    v_lshl_add_u32 v5, v18, 4, v19
    v_add_u32 v5, s37, v5
    v_add_u32 v6, 16384, v5
    v_add_u32 v7, 32768, v5
    v_add_u32 v8, 49152, v5
    v_mul_u32_u24 v10, 320, v17
    v_lshl_add_u32 v10, v18, 4, v10
    v_add_u32 v10, 18432, v10
    v_and_b32 v17, 31, v13
    v_lshl_add_u32 v17, v15, 6, v17
    v_mul_u32_u24 v11, 144, v17
    v_lshrrev_b32 v18, 5, v13
    v_lshl_add_u32 v11, v18, 4, v11
    v_and_b32 v17, 15, v13
    v_lshrrev_b32 v17, 2, v17
    v_lshl_add_u32 v17, v18, 3, v17
    v_mul_u32_u24 v12, 320, v17
    v_lshrrev_b32 v17, 4, v13
    v_and_b32 v17, 1, v17
    v_lshlrev_b32 v17, 5, v17
    v_add_u32 v12, v12, v17
    v_and_b32 v17, 3, v13
    v_lshl_add_u32 v12, v17, 3, v12
    v_lshl_add_u32 v12, v16, 7, v12
    v_add_u32 v12, 18432, v12
    v_mov_b32 v64, 0
    v_mov_b32 v65, 0
    v_mov_b32 v66, 0
    v_mov_b32 v67, 0
    v_mov_b32 v68, 0
    v_mov_b32 v69, 0
    v_mov_b32 v70, 0
    v_mov_b32 v71, 0
    v_mov_b32 v72, 0
    v_mov_b32 v73, 0
    v_mov_b32 v74, 0
    v_mov_b32 v75, 0
    v_mov_b32 v76, 0
    v_mov_b32 v77, 0
    v_mov_b32 v78, 0
    v_mov_b32 v79, 0
    v_mov_b32 v80, 0
    v_mov_b32 v81, 0
    v_mov_b32 v82, 0
    v_mov_b32 v83, 0
    v_mov_b32 v84, 0
    v_mov_b32 v85, 0
    v_mov_b32 v86, 0
    v_mov_b32 v87, 0
    v_mov_b32 v88, 0
    v_mov_b32 v89, 0
    v_mov_b32 v90, 0
    v_mov_b32 v91, 0
    v_mov_b32 v92, 0
    v_mov_b32 v93, 0
    v_mov_b32 v94, 0
    v_mov_b32 v95, 0
    v_mov_b32 v96, 0
    v_mov_b32 v97, 0
    v_mov_b32 v98, 0
    v_mov_b32 v99, 0
    v_mov_b32 v100, 0
    v_mov_b32 v101, 0
    v_mov_b32 v102, 0
    v_mov_b32 v103, 0
    v_mov_b32 v104, 0
    v_mov_b32 v105, 0
    v_mov_b32 v106, 0
    v_mov_b32 v107, 0
    v_mov_b32 v108, 0
    v_mov_b32 v109, 0
    v_mov_b32 v110, 0
    v_mov_b32 v111, 0
    v_mov_b32 v112, 0
    v_mov_b32 v113, 0
    v_mov_b32 v114, 0
    v_mov_b32 v115, 0
    v_mov_b32 v116, 0
    v_mov_b32 v117, 0
    v_mov_b32 v118, 0
    v_mov_b32 v119, 0
    v_mov_b32 v120, 0
    v_mov_b32 v121, 0
    v_mov_b32 v122, 0
    v_mov_b32 v123, 0
    v_mov_b32 v124, 0
    v_mov_b32 v125, 0
    v_mov_b32 v126, 0
    v_mov_b32 v127, 0
    s_mul_i32 s33, s44, 896
    s_mul_i32 s34, s44, 458752
    s_mov_b32 s31, 0
    buffer_load_dwordx4 v[128:131], v1, s[8:11], s33 offen
    buffer_load_dwordx4 v[132:135], v2, s[8:11], s33 offen
    buffer_load_dwordx4 v[136:139], v3, s[8:11], s33 offen
    buffer_load_dwordx4 v[140:143], v4, s[8:11], s33 offen
    buffer_load_dwordx4 v[144:147], v5, s[12:15], s34 offen
    buffer_load_dwordx4 v[148:151], v6, s[12:15], s34 offen
    buffer_load_dwordx4 v[152:155], v7, s[12:15], s34 offen
    buffer_load_dwordx4 v[156:159], v8, s[12:15], s34 offen
    s_add_u32 s33, s33, 128
    s_add_u32 s34, s34, 65536
    buffer_load_dwordx4 v[192:195], v1, s[8:11], s33 offen
    buffer_load_dwordx4 v[196:199], v2, s[8:11], s33 offen
    buffer_load_dwordx4 v[200:203], v3, s[8:11], s33 offen
    buffer_load_dwordx4 v[204:207], v4, s[8:11], s33 offen
    buffer_load_dwordx4 v[208:211], v5, s[12:15], s34 offen
    buffer_load_dwordx4 v[212:215], v6, s[12:15], s34 offen
    buffer_load_dwordx4 v[216:219], v7, s[12:15], s34 offen
    buffer_load_dwordx4 v[220:223], v8, s[12:15], s34 offen
    s_add_u32 s33, s33, 128
    s_add_u32 s34, s34, 65536
    s_waitcnt vmcnt(8)
    ds_write_b128 v9, v[128:131] offset:0
    ds_write_b128 v9, v[132:135] offset:4608
    ds_write_b128 v9, v[136:139] offset:9216
    ds_write_b128 v9, v[140:143] offset:13824
    ds_write_b128 v10, v[144:147] offset:0
    ds_write_b128 v10, v[148:151] offset:5120
    ds_write_b128 v10, v[152:155] offset:10240
    ds_write_b128 v10, v[156:159] offset:15360
    s_waitcnt lgkmcnt(0)
    s_barrier
    buffer_load_dwordx4 v[128:131], v1, s[8:11], s33 offen
    buffer_load_dwordx4 v[132:135], v2, s[8:11], s33 offen
    buffer_load_dwordx4 v[136:139], v3, s[8:11], s33 offen
    buffer_load_dwordx4 v[140:143], v4, s[8:11], s33 offen
    buffer_load_dwordx4 v[144:147], v5, s[12:15], s34 offen
    buffer_load_dwordx4 v[148:151], v6, s[12:15], s34 offen
    buffer_load_dwordx4 v[152:155], v7, s[12:15], s34 offen
    buffer_load_dwordx4 v[156:159], v8, s[12:15], s34 offen
    s_add_u32 s33, s33, 128
    s_add_u32 s34, s34, 65536
    ds_read_b128 v[160:163], v11 offset:0
    ds_read_b128 v[164:167], v11 offset:4608
    ds_read_b64_tr_b16 v[168:169], v12 offset:0
    ds_read_b64_tr_b16 v[170:171], v12 offset:1280
    ds_read_b64_tr_b16 v[172:173], v12 offset:64
    ds_read_b64_tr_b16 v[174:175], v12 offset:1344
    ds_read_b128 v[176:179], v11 offset:32
    ds_read_b128 v[180:183], v11 offset:4640
    ds_read_b64_tr_b16 v[184:185], v12 offset:5120
    ds_read_b64_tr_b16 v[186:187], v12 offset:6400
    ds_read_b64_tr_b16 v[188:189], v12 offset:5184
    ds_read_b64_tr_b16 v[190:191], v12 offset:6464
    s_waitcnt lgkmcnt(6)
    v_mfma_f32_32x32x16_bf16 v[64:79], v[168:171], v[160:163], v[64:79]
    v_mfma_f32_32x32x16_bf16 v[80:95], v[172:175], v[160:163], v[80:95]
    v_mfma_f32_32x32x16_bf16 v[96:111], v[168:171], v[164:167], v[96:111]
    v_mfma_f32_32x32x16_bf16 v[112:127], v[172:175], v[164:167], v[112:127]
    ds_read_b128 v[160:163], v11 offset:64
    ds_read_b128 v[164:167], v11 offset:4672
    ds_read_b64_tr_b16 v[168:169], v12 offset:10240
    ds_read_b64_tr_b16 v[170:171], v12 offset:11520
    ds_read_b64_tr_b16 v[172:173], v12 offset:10304
    ds_read_b64_tr_b16 v[174:175], v12 offset:11584
    s_waitcnt lgkmcnt(6)
    v_mfma_f32_32x32x16_bf16 v[64:79], v[184:187], v[176:179], v[64:79]
    v_mfma_f32_32x32x16_bf16 v[80:95], v[188:191], v[176:179], v[80:95]
    v_mfma_f32_32x32x16_bf16 v[96:111], v[184:187], v[180:183], v[96:111]
    v_mfma_f32_32x32x16_bf16 v[112:127], v[188:191], v[180:183], v[112:127]
    ds_read_b128 v[176:179], v11 offset:96
    ds_read_b128 v[180:183], v11 offset:4704
    ds_read_b64_tr_b16 v[184:185], v12 offset:15360
    ds_read_b64_tr_b16 v[186:187], v12 offset:16640
    ds_read_b64_tr_b16 v[188:189], v12 offset:15424
    ds_read_b64_tr_b16 v[190:191], v12 offset:16704
    s_waitcnt lgkmcnt(6)
    v_mfma_f32_32x32x16_bf16 v[64:79], v[168:171], v[160:163], v[64:79]
    v_mfma_f32_32x32x16_bf16 v[80:95], v[172:175], v[160:163], v[80:95]
    v_mfma_f32_32x32x16_bf16 v[96:111], v[168:171], v[164:167], v[96:111]
    v_mfma_f32_32x32x16_bf16 v[112:127], v[172:175], v[164:167], v[112:127]
    s_waitcnt lgkmcnt(0)
    v_mfma_f32_32x32x16_bf16 v[64:79], v[184:187], v[176:179], v[64:79]
    v_mfma_f32_32x32x16_bf16 v[80:95], v[188:191], v[176:179], v[80:95]
    v_mfma_f32_32x32x16_bf16 v[96:111], v[184:187], v[180:183], v[96:111]
    v_mfma_f32_32x32x16_bf16 v[112:127], v[188:191], v[180:183], v[112:127]
    s_waitcnt vmcnt(8)
    ds_write_b128 v9, v[192:195] offset:40960
    ds_write_b128 v9, v[196:199] offset:45568
    ds_write_b128 v9, v[200:203] offset:50176
    ds_write_b128 v9, v[204:207] offset:54784
    ds_write_b128 v10, v[208:211] offset:40960
    ds_write_b128 v10, v[212:215] offset:46080
    ds_write_b128 v10, v[216:219] offset:51200
    ds_write_b128 v10, v[220:223] offset:56320
    s_waitcnt lgkmcnt(0)
    s_barrier
    buffer_load_dwordx4 v[192:195], v1, s[8:11], s33 offen
    buffer_load_dwordx4 v[196:199], v2, s[8:11], s33 offen
    buffer_load_dwordx4 v[200:203], v3, s[8:11], s33 offen
    buffer_load_dwordx4 v[204:207], v4, s[8:11], s33 offen
    buffer_load_dwordx4 v[208:211], v5, s[12:15], s34 offen
    buffer_load_dwordx4 v[212:215], v6, s[12:15], s34 offen
    buffer_load_dwordx4 v[216:219], v7, s[12:15], s34 offen
    buffer_load_dwordx4 v[220:223], v8, s[12:15], s34 offen
    s_add_u32 s33, s33, 128
    s_add_u32 s34, s34, 65536
    ds_read_b128 v[160:163], v11 offset:40960
    ds_read_b128 v[164:167], v11 offset:45568
    ds_read_b64_tr_b16 v[168:169], v12 offset:40960
    ds_read_b64_tr_b16 v[170:171], v12 offset:42240
    ds_read_b64_tr_b16 v[172:173], v12 offset:41024
    ds_read_b64_tr_b16 v[174:175], v12 offset:42304
    ds_read_b128 v[176:179], v11 offset:40992
    ds_read_b128 v[180:183], v11 offset:45600
    ds_read_b64_tr_b16 v[184:185], v12 offset:46080
    ds_read_b64_tr_b16 v[186:187], v12 offset:47360
    ds_read_b64_tr_b16 v[188:189], v12 offset:46144
    ds_read_b64_tr_b16 v[190:191], v12 offset:47424
    s_waitcnt lgkmcnt(6)
    v_mfma_f32_32x32x16_bf16 v[64:79], v[168:171], v[160:163], v[64:79]
    v_mfma_f32_32x32x16_bf16 v[80:95], v[172:175], v[160:163], v[80:95]
    v_mfma_f32_32x32x16_bf16 v[96:111], v[168:171], v[164:167], v[96:111]
    v_mfma_f32_32x32x16_bf16 v[112:127], v[172:175], v[164:167], v[112:127]
    ds_read_b128 v[160:163], v11 offset:41024
    ds_read_b128 v[164:167], v11 offset:45632
    ds_read_b64_tr_b16 v[168:169], v12 offset:51200
    ds_read_b64_tr_b16 v[170:171], v12 offset:52480
    ds_read_b64_tr_b16 v[172:173], v12 offset:51264
    ds_read_b64_tr_b16 v[174:175], v12 offset:52544
    s_waitcnt lgkmcnt(6)
    v_mfma_f32_32x32x16_bf16 v[64:79], v[184:187], v[176:179], v[64:79]
    v_mfma_f32_32x32x16_bf16 v[80:95], v[188:191], v[176:179], v[80:95]
    v_mfma_f32_32x32x16_bf16 v[96:111], v[184:187], v[180:183], v[96:111]
    v_mfma_f32_32x32x16_bf16 v[112:127], v[188:191], v[180:183], v[112:127]
    ds_read_b128 v[176:179], v11 offset:41056
    ds_read_b128 v[180:183], v11 offset:45664
    ds_read_b64_tr_b16 v[184:185], v12 offset:56320
    ds_read_b64_tr_b16 v[186:187], v12 offset:57600
    ds_read_b64_tr_b16 v[188:189], v12 offset:56384
    ds_read_b64_tr_b16 v[190:191], v12 offset:57664
    s_waitcnt lgkmcnt(6)
    v_mfma_f32_32x32x16_bf16 v[64:79], v[168:171], v[160:163], v[64:79]
    v_mfma_f32_32x32x16_bf16 v[80:95], v[172:175], v[160:163], v[80:95]
    v_mfma_f32_32x32x16_bf16 v[96:111], v[168:171], v[164:167], v[96:111]
    v_mfma_f32_32x32x16_bf16 v[112:127], v[172:175], v[164:167], v[112:127]
    s_waitcnt lgkmcnt(0)
    v_mfma_f32_32x32x16_bf16 v[64:79], v[184:187], v[176:179], v[64:79]
    v_mfma_f32_32x32x16_bf16 v[80:95], v[188:191], v[176:179], v[80:95]
    v_mfma_f32_32x32x16_bf16 v[96:111], v[184:187], v[180:183], v[96:111]
    v_mfma_f32_32x32x16_bf16 v[112:127], v[188:191], v[180:183], v[112:127]
    s_waitcnt vmcnt(8)
    ds_write_b128 v9, v[128:131] offset:0
    ds_write_b128 v9, v[132:135] offset:4608
    ds_write_b128 v9, v[136:139] offset:9216
    ds_write_b128 v9, v[140:143] offset:13824
    ds_write_b128 v10, v[144:147] offset:0
    ds_write_b128 v10, v[148:151] offset:5120
    ds_write_b128 v10, v[152:155] offset:10240
    ds_write_b128 v10, v[156:159] offset:15360
    s_waitcnt lgkmcnt(0)
    s_barrier
    buffer_load_dwordx4 v[128:131], v1, s[8:11], s33 offen
    buffer_load_dwordx4 v[132:135], v2, s[8:11], s33 offen
    buffer_load_dwordx4 v[136:139], v3, s[8:11], s33 offen
    buffer_load_dwordx4 v[140:143], v4, s[8:11], s33 offen
    buffer_load_dwordx4 v[144:147], v5, s[12:15], s34 offen
    buffer_load_dwordx4 v[148:151], v6, s[12:15], s34 offen
    buffer_load_dwordx4 v[152:155], v7, s[12:15], s34 offen
    buffer_load_dwordx4 v[156:159], v8, s[12:15], s34 offen
    s_add_u32 s33, s33, 128
    s_add_u32 s34, s34, 65536
    ds_read_b128 v[160:163], v11 offset:0
    ds_read_b128 v[164:167], v11 offset:4608
    ds_read_b64_tr_b16 v[168:169], v12 offset:0
    ds_read_b64_tr_b16 v[170:171], v12 offset:1280
    ds_read_b64_tr_b16 v[172:173], v12 offset:64
    ds_read_b64_tr_b16 v[174:175], v12 offset:1344
    ds_read_b128 v[176:179], v11 offset:32
    ds_read_b128 v[180:183], v11 offset:4640
    ds_read_b64_tr_b16 v[184:185], v12 offset:5120
    ds_read_b64_tr_b16 v[186:187], v12 offset:6400
    ds_read_b64_tr_b16 v[188:189], v12 offset:5184
    ds_read_b64_tr_b16 v[190:191], v12 offset:6464
    s_waitcnt lgkmcnt(6)
    v_mfma_f32_32x32x16_bf16 v[64:79], v[168:171], v[160:163], v[64:79]
    v_mfma_f32_32x32x16_bf16 v[80:95], v[172:175], v[160:163], v[80:95]
    v_mfma_f32_32x32x16_bf16 v[96:111], v[168:171], v[164:167], v[96:111]
    v_mfma_f32_32x32x16_bf16 v[112:127], v[172:175], v[164:167], v[112:127]
    ds_read_b128 v[160:163], v11 offset:64
    ds_read_b128 v[164:167], v11 offset:4672
    ds_read_b64_tr_b16 v[168:169], v12 offset:10240
    ds_read_b64_tr_b16 v[170:171], v12 offset:11520
    ds_read_b64_tr_b16 v[172:173], v12 offset:10304
    ds_read_b64_tr_b16 v[174:175], v12 offset:11584
    s_waitcnt lgkmcnt(6)
    v_mfma_f32_32x32x16_bf16 v[64:79], v[184:187], v[176:179], v[64:79]
    v_mfma_f32_32x32x16_bf16 v[80:95], v[188:191], v[176:179], v[80:95]
    v_mfma_f32_32x32x16_bf16 v[96:111], v[184:187], v[180:183], v[96:111]
    v_mfma_f32_32x32x16_bf16 v[112:127], v[188:191], v[180:183], v[112:127]
    ds_read_b128 v[176:179], v11 offset:96
    ds_read_b128 v[180:183], v11 offset:4704
    ds_read_b64_tr_b16 v[184:185], v12 offset:15360
    ds_read_b64_tr_b16 v[186:187], v12 offset:16640
    ds_read_b64_tr_b16 v[188:189], v12 offset:15424
    ds_read_b64_tr_b16 v[190:191], v12 offset:16704
    s_waitcnt lgkmcnt(6)
    v_mfma_f32_32x32x16_bf16 v[64:79], v[168:171], v[160:163], v[64:79]
    v_mfma_f32_32x32x16_bf16 v[80:95], v[172:175], v[160:163], v[80:95]
    v_mfma_f32_32x32x16_bf16 v[96:111], v[168:171], v[164:167], v[96:111]
    v_mfma_f32_32x32x16_bf16 v[112:127], v[172:175], v[164:167], v[112:127]
    s_waitcnt lgkmcnt(0)
    v_mfma_f32_32x32x16_bf16 v[64:79], v[184:187], v[176:179], v[64:79]
    v_mfma_f32_32x32x16_bf16 v[80:95], v[188:191], v[176:179], v[80:95]
    v_mfma_f32_32x32x16_bf16 v[96:111], v[184:187], v[180:183], v[96:111]
    v_mfma_f32_32x32x16_bf16 v[112:127], v[188:191], v[180:183], v[112:127]
    s_waitcnt vmcnt(8)
    ds_write_b128 v9, v[192:195] offset:40960
    ds_write_b128 v9, v[196:199] offset:45568
    ds_write_b128 v9, v[200:203] offset:50176
    ds_write_b128 v9, v[204:207] offset:54784
    ds_write_b128 v10, v[208:211] offset:40960
    ds_write_b128 v10, v[212:215] offset:46080
    ds_write_b128 v10, v[216:219] offset:51200
    ds_write_b128 v10, v[220:223] offset:56320
    s_waitcnt lgkmcnt(0)
    s_barrier
    buffer_load_dwordx4 v[192:195], v1, s[8:11], s33 offen
    buffer_load_dwordx4 v[196:199], v2, s[8:11], s33 offen
    buffer_load_dwordx4 v[200:203], v3, s[8:11], s33 offen
    buffer_load_dwordx4 v[204:207], v4, s[8:11], s33 offen
    buffer_load_dwordx4 v[208:211], v5, s[12:15], s34 offen
    buffer_load_dwordx4 v[212:215], v6, s[12:15], s34 offen
    buffer_load_dwordx4 v[216:219], v7, s[12:15], s34 offen
    buffer_load_dwordx4 v[220:223], v8, s[12:15], s34 offen
    s_add_u32 s33, s33, 128
    s_add_u32 s34, s34, 65536
    ds_read_b128 v[160:163], v11 offset:40960
    ds_read_b128 v[164:167], v11 offset:45568
    ds_read_b64_tr_b16 v[168:169], v12 offset:40960
    ds_read_b64_tr_b16 v[170:171], v12 offset:42240
    ds_read_b64_tr_b16 v[172:173], v12 offset:41024
    ds_read_b64_tr_b16 v[174:175], v12 offset:42304
    ds_read_b128 v[176:179], v11 offset:40992
    ds_read_b128 v[180:183], v11 offset:45600
    ds_read_b64_tr_b16 v[184:185], v12 offset:46080
    ds_read_b64_tr_b16 v[186:187], v12 offset:47360
    ds_read_b64_tr_b16 v[188:189], v12 offset:46144
    ds_read_b64_tr_b16 v[190:191], v12 offset:47424
    s_waitcnt lgkmcnt(6)
    v_mfma_f32_32x32x16_bf16 v[64:79], v[168:171], v[160:163], v[64:79]
    v_mfma_f32_32x32x16_bf16 v[80:95], v[172:175], v[160:163], v[80:95]
    v_mfma_f32_32x32x16_bf16 v[96:111], v[168:171], v[164:167], v[96:111]
    v_mfma_f32_32x32x16_bf16 v[112:127], v[172:175], v[164:167], v[112:127]
    ds_read_b128 v[160:163], v11 offset:41024
    ds_read_b128 v[164:167], v11 offset:45632
    ds_read_b64_tr_b16 v[168:169], v12 offset:51200
    ds_read_b64_tr_b16 v[170:171], v12 offset:52480
    ds_read_b64_tr_b16 v[172:173], v12 offset:51264
    ds_read_b64_tr_b16 v[174:175], v12 offset:52544
    s_waitcnt lgkmcnt(6)
    v_mfma_f32_32x32x16_bf16 v[64:79], v[184:187], v[176:179], v[64:79]
    v_mfma_f32_32x32x16_bf16 v[80:95], v[188:191], v[176:179], v[80:95]
    v_mfma_f32_32x32x16_bf16 v[96:111], v[184:187], v[180:183], v[96:111]
    v_mfma_f32_32x32x16_bf16 v[112:127], v[188:191], v[180:183], v[112:127]
    ds_read_b128 v[176:179], v11 offset:41056
    ds_read_b128 v[180:183], v11 offset:45664
    ds_read_b64_tr_b16 v[184:185], v12 offset:56320
    ds_read_b64_tr_b16 v[186:187], v12 offset:57600
    ds_read_b64_tr_b16 v[188:189], v12 offset:56384
    ds_read_b64_tr_b16 v[190:191], v12 offset:57664
    s_waitcnt lgkmcnt(6)
    v_mfma_f32_32x32x16_bf16 v[64:79], v[168:171], v[160:163], v[64:79]
    v_mfma_f32_32x32x16_bf16 v[80:95], v[172:175], v[160:163], v[80:95]
    v_mfma_f32_32x32x16_bf16 v[96:111], v[168:171], v[164:167], v[96:111]
    v_mfma_f32_32x32x16_bf16 v[112:127], v[172:175], v[164:167], v[112:127]
    s_waitcnt lgkmcnt(0)
    v_mfma_f32_32x32x16_bf16 v[64:79], v[184:187], v[176:179], v[64:79]
    v_mfma_f32_32x32x16_bf16 v[80:95], v[188:191], v[176:179], v[80:95]
    v_mfma_f32_32x32x16_bf16 v[96:111], v[184:187], v[180:183], v[96:111]
    v_mfma_f32_32x32x16_bf16 v[112:127], v[188:191], v[180:183], v[112:127]
    s_waitcnt vmcnt(8)
    ds_write_b128 v9, v[128:131] offset:0
    ds_write_b128 v9, v[132:135] offset:4608
    ds_write_b128 v9, v[136:139] offset:9216
    ds_write_b128 v9, v[140:143] offset:13824
    ds_write_b128 v10, v[144:147] offset:0
    ds_write_b128 v10, v[148:151] offset:5120
    ds_write_b128 v10, v[152:155] offset:10240
    ds_write_b128 v10, v[156:159] offset:15360
    s_waitcnt lgkmcnt(0)
    s_barrier
    buffer_load_dwordx4 v[128:131], v1, s[8:11], s33 offen
    buffer_load_dwordx4 v[132:135], v2, s[8:11], s33 offen
    buffer_load_dwordx4 v[136:139], v3, s[8:11], s33 offen
    buffer_load_dwordx4 v[140:143], v4, s[8:11], s33 offen
    buffer_load_dwordx4 v[144:147], v5, s[12:15], s34 offen
    buffer_load_dwordx4 v[148:151], v6, s[12:15], s34 offen
    buffer_load_dwordx4 v[152:155], v7, s[12:15], s34 offen
    buffer_load_dwordx4 v[156:159], v8, s[12:15], s34 offen
    s_add_u32 s33, s33, 128
    s_add_u32 s34, s34, 65536
    ds_read_b128 v[160:163], v11 offset:0
    ds_read_b128 v[164:167], v11 offset:4608
    ds_read_b64_tr_b16 v[168:169], v12 offset:0
    ds_read_b64_tr_b16 v[170:171], v12 offset:1280
    ds_read_b64_tr_b16 v[172:173], v12 offset:64
    ds_read_b64_tr_b16 v[174:175], v12 offset:1344
    ds_read_b128 v[176:179], v11 offset:32
    ds_read_b128 v[180:183], v11 offset:4640
    ds_read_b64_tr_b16 v[184:185], v12 offset:5120
    ds_read_b64_tr_b16 v[186:187], v12 offset:6400
    ds_read_b64_tr_b16 v[188:189], v12 offset:5184
    ds_read_b64_tr_b16 v[190:191], v12 offset:6464
    s_waitcnt lgkmcnt(6)
    v_mfma_f32_32x32x16_bf16 v[64:79], v[168:171], v[160:163], v[64:79]
    v_mfma_f32_32x32x16_bf16 v[80:95], v[172:175], v[160:163], v[80:95]
    v_mfma_f32_32x32x16_bf16 v[96:111], v[168:171], v[164:167], v[96:111]
    v_mfma_f32_32x32x16_bf16 v[112:127], v[172:175], v[164:167], v[112:127]
    ds_read_b128 v[160:163], v11 offset:64
    ds_read_b128 v[164:167], v11 offset:4672
    ds_read_b64_tr_b16 v[168:169], v12 offset:10240
    ds_read_b64_tr_b16 v[170:171], v12 offset:11520
    ds_read_b64_tr_b16 v[172:173], v12 offset:10304
    ds_read_b64_tr_b16 v[174:175], v12 offset:11584
    s_waitcnt lgkmcnt(6)
    v_mfma_f32_32x32x16_bf16 v[64:79], v[184:187], v[176:179], v[64:79]
    v_mfma_f32_32x32x16_bf16 v[80:95], v[188:191], v[176:179], v[80:95]
    v_mfma_f32_32x32x16_bf16 v[96:111], v[184:187], v[180:183], v[96:111]
    v_mfma_f32_32x32x16_bf16 v[112:127], v[188:191], v[180:183], v[112:127]
    ds_read_b128 v[176:179], v11 offset:96
    ds_read_b128 v[180:183], v11 offset:4704
    ds_read_b64_tr_b16 v[184:185], v12 offset:15360
    ds_read_b64_tr_b16 v[186:187], v12 offset:16640
    ds_read_b64_tr_b16 v[188:189], v12 offset:15424
    ds_read_b64_tr_b16 v[190:191], v12 offset:16704
    s_waitcnt lgkmcnt(6)
    v_mfma_f32_32x32x16_bf16 v[64:79], v[168:171], v[160:163], v[64:79]
    v_mfma_f32_32x32x16_bf16 v[80:95], v[172:175], v[160:163], v[80:95]
    v_mfma_f32_32x32x16_bf16 v[96:111], v[168:171], v[164:167], v[96:111]
    v_mfma_f32_32x32x16_bf16 v[112:127], v[172:175], v[164:167], v[112:127]
    s_waitcnt lgkmcnt(0)
    v_mfma_f32_32x32x16_bf16 v[64:79], v[184:187], v[176:179], v[64:79]
    v_mfma_f32_32x32x16_bf16 v[80:95], v[188:191], v[176:179], v[80:95]
    v_mfma_f32_32x32x16_bf16 v[96:111], v[184:187], v[180:183], v[96:111]
    v_mfma_f32_32x32x16_bf16 v[112:127], v[188:191], v[180:183], v[112:127]
    s_waitcnt vmcnt(8)
    ds_write_b128 v9, v[192:195] offset:40960
    ds_write_b128 v9, v[196:199] offset:45568
    ds_write_b128 v9, v[200:203] offset:50176
    ds_write_b128 v9, v[204:207] offset:54784
    ds_write_b128 v10, v[208:211] offset:40960
    ds_write_b128 v10, v[212:215] offset:46080
    ds_write_b128 v10, v[216:219] offset:51200
    ds_write_b128 v10, v[220:223] offset:56320
    s_waitcnt lgkmcnt(0)
    s_barrier
    ds_read_b128 v[160:163], v11 offset:40960
    ds_read_b128 v[164:167], v11 offset:45568
    ds_read_b64_tr_b16 v[168:169], v12 offset:40960
    ds_read_b64_tr_b16 v[170:171], v12 offset:42240
    ds_read_b64_tr_b16 v[172:173], v12 offset:41024
    ds_read_b64_tr_b16 v[174:175], v12 offset:42304
    ds_read_b128 v[176:179], v11 offset:40992
    ds_read_b128 v[180:183], v11 offset:45600
    ds_read_b64_tr_b16 v[184:185], v12 offset:46080
    ds_read_b64_tr_b16 v[186:187], v12 offset:47360
    ds_read_b64_tr_b16 v[188:189], v12 offset:46144
    ds_read_b64_tr_b16 v[190:191], v12 offset:47424
    s_waitcnt lgkmcnt(6)
    v_mfma_f32_32x32x16_bf16 v[64:79], v[168:171], v[160:163], v[64:79]
    v_mfma_f32_32x32x16_bf16 v[80:95], v[172:175], v[160:163], v[80:95]
    v_mfma_f32_32x32x16_bf16 v[96:111], v[168:171], v[164:167], v[96:111]
    v_mfma_f32_32x32x16_bf16 v[112:127], v[172:175], v[164:167], v[112:127]
    ds_read_b128 v[160:163], v11 offset:41024
    ds_read_b128 v[164:167], v11 offset:45632
    ds_read_b64_tr_b16 v[168:169], v12 offset:51200
    ds_read_b64_tr_b16 v[170:171], v12 offset:52480
    ds_read_b64_tr_b16 v[172:173], v12 offset:51264
    ds_read_b64_tr_b16 v[174:175], v12 offset:52544
    s_waitcnt lgkmcnt(6)
    v_mfma_f32_32x32x16_bf16 v[64:79], v[184:187], v[176:179], v[64:79]
    v_mfma_f32_32x32x16_bf16 v[80:95], v[188:191], v[176:179], v[80:95]
    v_mfma_f32_32x32x16_bf16 v[96:111], v[184:187], v[180:183], v[96:111]
    v_mfma_f32_32x32x16_bf16 v[112:127], v[188:191], v[180:183], v[112:127]
    ds_read_b128 v[176:179], v11 offset:41056
    ds_read_b128 v[180:183], v11 offset:45664
    ds_read_b64_tr_b16 v[184:185], v12 offset:56320
    ds_read_b64_tr_b16 v[186:187], v12 offset:57600
    ds_read_b64_tr_b16 v[188:189], v12 offset:56384
    ds_read_b64_tr_b16 v[190:191], v12 offset:57664
    s_waitcnt lgkmcnt(6)
    v_mfma_f32_32x32x16_bf16 v[64:79], v[168:171], v[160:163], v[64:79]
    v_mfma_f32_32x32x16_bf16 v[80:95], v[172:175], v[160:163], v[80:95]
    v_mfma_f32_32x32x16_bf16 v[96:111], v[168:171], v[164:167], v[96:111]
    v_mfma_f32_32x32x16_bf16 v[112:127], v[172:175], v[164:167], v[112:127]
    s_waitcnt lgkmcnt(0)
    v_mfma_f32_32x32x16_bf16 v[64:79], v[184:187], v[176:179], v[64:79]
    v_mfma_f32_32x32x16_bf16 v[80:95], v[188:191], v[176:179], v[80:95]
    v_mfma_f32_32x32x16_bf16 v[96:111], v[184:187], v[180:183], v[96:111]
    v_mfma_f32_32x32x16_bf16 v[112:127], v[188:191], v[180:183], v[112:127]
    s_waitcnt vmcnt(0)
    ds_write_b128 v9, v[128:131] offset:0
    ds_write_b128 v9, v[132:135] offset:4608
    ds_write_b128 v9, v[136:139] offset:9216
    ds_write_b128 v9, v[140:143] offset:13824
    ds_write_b128 v10, v[144:147] offset:0
    ds_write_b128 v10, v[148:151] offset:5120
    ds_write_b128 v10, v[152:155] offset:10240
    ds_write_b128 v10, v[156:159] offset:15360
    s_waitcnt lgkmcnt(0)
    s_barrier
    ds_read_b128 v[160:163], v11 offset:0
    ds_read_b128 v[164:167], v11 offset:4608
    ds_read_b64_tr_b16 v[168:169], v12 offset:0
    ds_read_b64_tr_b16 v[170:171], v12 offset:1280
    ds_read_b64_tr_b16 v[172:173], v12 offset:64
    ds_read_b64_tr_b16 v[174:175], v12 offset:1344
    ds_read_b128 v[176:179], v11 offset:32
    ds_read_b128 v[180:183], v11 offset:4640
    ds_read_b64_tr_b16 v[184:185], v12 offset:5120
    ds_read_b64_tr_b16 v[186:187], v12 offset:6400
    ds_read_b64_tr_b16 v[188:189], v12 offset:5184
    ds_read_b64_tr_b16 v[190:191], v12 offset:6464
    s_waitcnt lgkmcnt(6)
    v_mfma_f32_32x32x16_bf16 v[64:79], v[168:171], v[160:163], v[64:79]
    v_mfma_f32_32x32x16_bf16 v[80:95], v[172:175], v[160:163], v[80:95]
    v_mfma_f32_32x32x16_bf16 v[96:111], v[168:171], v[164:167], v[96:111]
    v_mfma_f32_32x32x16_bf16 v[112:127], v[172:175], v[164:167], v[112:127]
    ds_read_b128 v[160:163], v11 offset:64
    ds_read_b128 v[164:167], v11 offset:4672
    ds_read_b64_tr_b16 v[168:169], v12 offset:10240
    ds_read_b64_tr_b16 v[170:171], v12 offset:11520
    ds_read_b64_tr_b16 v[172:173], v12 offset:10304
    ds_read_b64_tr_b16 v[174:175], v12 offset:11584
    s_waitcnt lgkmcnt(6)
    v_mfma_f32_32x32x16_bf16 v[64:79], v[184:187], v[176:179], v[64:79]
    v_mfma_f32_32x32x16_bf16 v[80:95], v[188:191], v[176:179], v[80:95]
    v_mfma_f32_32x32x16_bf16 v[96:111], v[184:187], v[180:183], v[96:111]
    v_mfma_f32_32x32x16_bf16 v[112:127], v[188:191], v[180:183], v[112:127]
    ds_read_b128 v[176:179], v11 offset:96
    ds_read_b128 v[180:183], v11 offset:4704
    ds_read_b64_tr_b16 v[184:185], v12 offset:15360
    ds_read_b64_tr_b16 v[186:187], v12 offset:16640
    ds_read_b64_tr_b16 v[188:189], v12 offset:15424
    ds_read_b64_tr_b16 v[190:191], v12 offset:16704
    s_waitcnt lgkmcnt(6)
    v_mfma_f32_32x32x16_bf16 v[64:79], v[168:171], v[160:163], v[64:79]
    v_mfma_f32_32x32x16_bf16 v[80:95], v[172:175], v[160:163], v[80:95]
    v_mfma_f32_32x32x16_bf16 v[96:111], v[168:171], v[164:167], v[96:111]
    v_mfma_f32_32x32x16_bf16 v[112:127], v[172:175], v[164:167], v[112:127]
    s_waitcnt lgkmcnt(0)
    v_mfma_f32_32x32x16_bf16 v[64:79], v[184:187], v[176:179], v[64:79]
    v_mfma_f32_32x32x16_bf16 v[80:95], v[188:191], v[176:179], v[80:95]
    v_mfma_f32_32x32x16_bf16 v[96:111], v[184:187], v[180:183], v[96:111]
    v_mfma_f32_32x32x16_bf16 v[112:127], v[188:191], v[180:183], v[112:127]
    s_nop 15
    s_nop 3
    v_and_b32 v22, 31, v13
    v_lshl_add_u32 v22, v15, 6, v22
    v_add_u32 v22, s38, v22
    v_lshlrev_b32 v22, 11, v22
    v_lshrrev_b32 v23, 5, v13
    v_lshl_add_u32 v22, v23, 4, v22
    s_lshl_b32 s39, s37, 1
    v_add_u32 v22, s39, v22
    v_lshl_add_u32 v22, v16, 8, v22
    s_lshl_b32 s40, s44, 22
    s_add_u32 s40, s40, 134217728
    v_mov_b32 v23, v22
    buffer_store_dwordx4 v[64:67], v23, s[20:23], s40 offen offset:0
    buffer_store_dwordx4 v[68:71], v23, s[20:23], s40 offen offset:32
    buffer_store_dwordx4 v[72:75], v23, s[20:23], s40 offen offset:64
    buffer_store_dwordx4 v[76:79], v23, s[20:23], s40 offen offset:96
    buffer_store_dwordx4 v[80:83], v23, s[20:23], s40 offen offset:128
    buffer_store_dwordx4 v[84:87], v23, s[20:23], s40 offen offset:160
    buffer_store_dwordx4 v[88:91], v23, s[20:23], s40 offen offset:192
    buffer_store_dwordx4 v[92:95], v23, s[20:23], s40 offen offset:224
    v_add_u32 v23, 65536, v22
    buffer_store_dwordx4 v[96:99], v23, s[20:23], s40 offen offset:0
    buffer_store_dwordx4 v[100:103], v23, s[20:23], s40 offen offset:32
    buffer_store_dwordx4 v[104:107], v23, s[20:23], s40 offen offset:64
    buffer_store_dwordx4 v[108:111], v23, s[20:23], s40 offen offset:96
    buffer_store_dwordx4 v[112:115], v23, s[20:23], s40 offen offset:128
    buffer_store_dwordx4 v[116:119], v23, s[20:23], s40 offen offset:160
    buffer_store_dwordx4 v[120:123], v23, s[20:23], s40 offen offset:192
    buffer_store_dwordx4 v[124:127], v23, s[20:23], s40 offen offset:224
ffn2_kernel_done1:
    s_endpgm
.globl fin_kernel
.p2align 8
.type fin_kernel,@function
fin_kernel:
    s_cmp_ge_u32 s2, 512
    s_cbranch_scc1 fin_kernel_done1
    s_load_dwordx2 s[12:13], s[0:1], 104
    s_waitcnt lgkmcnt(0)
    s_mov_b32 s14, 268435456
    s_mov_b32 s15, 0x00020000
    s_load_dwordx2 s[8:9], s[0:1], 88
    s_waitcnt lgkmcnt(0)
    s_mov_b32 s10, 2097152
    s_mov_b32 s11, 0x00020000
    s_lshl_b32 s3, s2, 12
    v_lshl_add_u32 v1, v0, 4, s3
    v_lshlrev_b32 v20, 1, v1
    s_mov_b32 s16, 134217728
    buffer_load_dwordx4 v[24:27], v20, s[12:15], s16 offen
    buffer_load_dwordx4 v[28:31], v20, s[12:15], s16 offen offset:16
    s_mov_b32 s16, 138412032
    buffer_load_dwordx4 v[32:35], v20, s[12:15], s16 offen
    buffer_load_dwordx4 v[36:39], v20, s[12:15], s16 offen offset:16
    s_mov_b32 s16, 142606336
    buffer_load_dwordx4 v[40:43], v20, s[12:15], s16 offen
    buffer_load_dwordx4 v[44:47], v20, s[12:15], s16 offen offset:16
    s_mov_b32 s16, 146800640
    buffer_load_dwordx4 v[48:51], v20, s[12:15], s16 offen
    buffer_load_dwordx4 v[52:55], v20, s[12:15], s16 offen offset:16
    s_mov_b32 s16, 71303168
    buffer_load_dwordx4 v[4:7], v1, s[12:15], s16 offen
    s_waitcnt vmcnt(0)
    v_add_f32 v24, v24, v32
    v_add_f32 v40, v40, v48
    v_add_f32 v25, v25, v33
    v_add_f32 v41, v41, v49
    v_add_f32 v26, v26, v34
    v_add_f32 v42, v42, v50
    v_add_f32 v27, v27, v35
    v_add_f32 v43, v43, v51
    v_add_f32 v28, v28, v36
    v_add_f32 v44, v44, v52
    v_add_f32 v29, v29, v37
    v_add_f32 v45, v45, v53
    v_add_f32 v30, v30, v38
    v_add_f32 v46, v46, v54
    v_add_f32 v31, v31, v39
    v_add_f32 v47, v47, v55
    v_add_f32 v24, v24, v40
    v_add_f32 v25, v25, v41
    v_add_f32 v26, v26, v42
    v_add_f32 v27, v27, v43
    v_add_f32 v28, v28, v44
    v_add_f32 v29, v29, v45
    v_add_f32 v30, v30, v46
    v_add_f32 v31, v31, v47
    v_cvt_pk_bf16_f32 v32, v24, v25
    v_lshlrev_b32 v24, 16, v32
    v_and_b32 v25, 0xffff0000, v32
    v_lshlrev_b32 v40, 16, v4
    v_and_b32 v41, 0xffff0000, v4
    v_add_f32 v24, v24, v40
    v_add_f32 v25, v25, v41
    v_cvt_pk_bf16_f32 v4, v24, v25
    v_cvt_pk_bf16_f32 v33, v26, v27
    v_lshlrev_b32 v26, 16, v33
    v_and_b32 v27, 0xffff0000, v33
    v_lshlrev_b32 v42, 16, v5
    v_and_b32 v43, 0xffff0000, v5
    v_add_f32 v26, v26, v42
    v_add_f32 v27, v27, v43
    v_cvt_pk_bf16_f32 v5, v26, v27
    v_cvt_pk_bf16_f32 v34, v28, v29
    v_lshlrev_b32 v28, 16, v34
    v_and_b32 v29, 0xffff0000, v34
    v_lshlrev_b32 v44, 16, v6
    v_and_b32 v45, 0xffff0000, v6
    v_add_f32 v28, v28, v44
    v_add_f32 v29, v29, v45
    v_cvt_pk_bf16_f32 v6, v28, v29
    v_cvt_pk_bf16_f32 v35, v30, v31
    v_lshlrev_b32 v30, 16, v35
    v_and_b32 v31, 0xffff0000, v35
    v_lshlrev_b32 v46, 16, v7
    v_and_b32 v47, 0xffff0000, v7
    v_add_f32 v30, v30, v46
    v_add_f32 v31, v31, v47
    v_cvt_pk_bf16_f32 v7, v30, v31
    s_mov_b32 s16, 0
    buffer_store_dwordx4 v[4:7], v1, s[8:11], s16 offen
fin_kernel_done1:
    s_endpgm
.section .rodata,"a"
.p2align 6
.p2align 6
.amdhsa_kernel ln1_kernel
  .amdhsa_next_free_vgpr 64
  .amdhsa_next_free_sgpr 32
  .amdhsa_accum_offset 64
  .amdhsa_group_segment_fixed_size 0
  .amdhsa_kernarg_size 112
  .amdhsa_user_sgpr_count 2
  .amdhsa_user_sgpr_kernarg_segment_ptr 1
  .amdhsa_system_sgpr_workgroup_id_x 1
.end_amdhsa_kernel
.p2align 6
.amdhsa_kernel chain_kernel
  .amdhsa_next_free_vgpr 512
  .amdhsa_next_free_sgpr 96
  .amdhsa_accum_offset 256
  .amdhsa_group_segment_fixed_size 0
  .amdhsa_kernarg_size 112
  .amdhsa_user_sgpr_count 2
  .amdhsa_user_sgpr_kernarg_segment_ptr 1
  .amdhsa_system_sgpr_workgroup_id_x 1
.end_amdhsa_kernel
.p2align 6
.amdhsa_kernel attn_kernel
  .amdhsa_next_free_vgpr 208
  .amdhsa_next_free_sgpr 48
  .amdhsa_accum_offset 208
  .amdhsa_group_segment_fixed_size 0
  .amdhsa_kernarg_size 112
  .amdhsa_user_sgpr_count 2
  .amdhsa_user_sgpr_kernarg_segment_ptr 1
  .amdhsa_system_sgpr_workgroup_id_x 1
.end_amdhsa_kernel
.p2align 6
.amdhsa_kernel oproj_kernel
  .amdhsa_next_free_vgpr 224
  .amdhsa_next_free_sgpr 64
  .amdhsa_accum_offset 224
  .amdhsa_group_segment_fixed_size 0
  .amdhsa_kernarg_size 112
  .amdhsa_user_sgpr_count 2
  .amdhsa_user_sgpr_kernarg_segment_ptr 1
  .amdhsa_system_sgpr_workgroup_id_x 1
.end_amdhsa_kernel
.p2align 6
.amdhsa_kernel ln2_kernel
  .amdhsa_next_free_vgpr 64
  .amdhsa_next_free_sgpr 32
  .amdhsa_accum_offset 64
  .amdhsa_group_segment_fixed_size 0
  .amdhsa_kernarg_size 112
  .amdhsa_user_sgpr_count 2
  .amdhsa_user_sgpr_kernarg_segment_ptr 1
  .amdhsa_system_sgpr_workgroup_id_x 1
.end_amdhsa_kernel
.p2align 6
.amdhsa_kernel ffn1_kernel
  .amdhsa_next_free_vgpr 224
  .amdhsa_next_free_sgpr 64
  .amdhsa_accum_offset 224
  .amdhsa_group_segment_fixed_size 0
  .amdhsa_kernarg_size 112
  .amdhsa_user_sgpr_count 2
  .amdhsa_user_sgpr_kernarg_segment_ptr 1
  .amdhsa_system_sgpr_workgroup_id_x 1
.end_amdhsa_kernel
.p2align 6
.amdhsa_kernel ffn2_kernel
  .amdhsa_next_free_vgpr 224
  .amdhsa_next_free_sgpr 64
  .amdhsa_accum_offset 224
  .amdhsa_group_segment_fixed_size 0
  .amdhsa_kernarg_size 112
  .amdhsa_user_sgpr_count 2
  .amdhsa_user_sgpr_kernarg_segment_ptr 1
  .amdhsa_system_sgpr_workgroup_id_x 1
.end_amdhsa_kernel
.p2align 6
.amdhsa_kernel fin_kernel
  .amdhsa_next_free_vgpr 64
  .amdhsa_next_free_sgpr 32
  .amdhsa_accum_offset 64
  .amdhsa_group_segment_fixed_size 0
  .amdhsa_kernarg_size 112
  .amdhsa_user_sgpr_count 2
  .amdhsa_user_sgpr_kernarg_segment_ptr 1
  .amdhsa_system_sgpr_workgroup_id_x 1
.end_amdhsa_kernel
```
